```python
import torch

def _softmax(x, axis=-1):
    return torch.softmax(x, dim=axis)
def _gelu(x):
    return torch.nn.functional.gelu(x, approximate="tanh")
def _silu(x):
    return torch.nn.functional.silu(x)
def _sigmoid(x):
    return torch.sigmoid(x)
def _layernorm(x, axis=-1, eps=1e-5):
    m = x.mean(dim=axis, keepdim=True)
    v = x.var(dim=axis, keepdim=True, unbiased=False)
    return (x - m) / torch.sqrt(v + eps)
def _scatter_add(tgt, idx, src, axis=0):
    return tgt.clone().index_add_(axis, idx, src)
def _segment_sum(src, seg, n):
    out = torch.zeros((n,) + src.shape[1:], dtype=src.dtype)
    return out.index_add_(0, seg, src)
def _pad(x, pw):
    flat = tuple(v for pair in reversed(pw) for v in pair)
    return torch.nn.functional.pad(x, flat)

kernel_name = 'parallel_sum__ssm_conv_s5__dense_activation_relu__prompt'

def setup_inputs():

    _w = (lambda a: (lambda t: t.to(torch.bfloat16) if t.is_floating_point() else t)(torch.as_tensor(a)))
    def _A_setup():
        B, S, D = 1, 2048, 640
        P = D
        Lambda_re = -0.5 * (lambda _x: torch.exp(torch.as_tensor(_x)))((lambda *s: torch.randn(*s, dtype=torch.bfloat16) * 0.8)(P))
        Lambda_im = (lambda *s: torch.randn(*s, dtype=torch.bfloat16) * 0.8)(P) * 1.0
        B_re = (lambda *s: torch.randn(*s, dtype=torch.bfloat16) * 0.8)(P, D) * (D ** -0.5)
        B_im = (lambda *s: torch.randn(*s, dtype=torch.bfloat16) * 0.8)(P, D) * (D ** -0.5)
        C_re = (lambda *s: torch.randn(*s, dtype=torch.bfloat16) * 0.8)(D, P) * (P ** -0.5)
        C_im = (lambda *s: torch.randn(*s, dtype=torch.bfloat16) * 0.8)(D, P) * (P ** -0.5)
        log_dt = (lambda *s: torch.randn(*s, dtype=torch.bfloat16) * 0.8)(P) * 0.3 - 2.0
        Dskip = (lambda *s: torch.randn(*s, dtype=torch.bfloat16) * 0.8)(D)
        return {
            "x": _w((lambda *s: torch.randn(*s, dtype=torch.bfloat16) * 0.05)(B, S, D)),
            "Lambda_re": _w(Lambda_re),
            "Lambda_im": _w(Lambda_im),
            "B_re": _w(B_re),
            "B_im": _w(B_im),
            "C_re": _w(C_re),
            "C_im": _w(C_im),
            "log_dt": _w(log_dt),
            "Dskip": _w(Dskip),
        }
    _A_in = _A_setup()

    def _B_setup():
        B, S, D, Dff = 1, 2048, 640, 1536
        return {
            "x": _w((lambda *s: torch.randn(*s, dtype=torch.bfloat16) * 0.05)(B, S, D)),
            "w1": _w((lambda *s: torch.randn(*s, dtype=torch.bfloat16) * 0.05)(D, Dff)),
            "w2": _w((lambda *s: torch.randn(*s, dtype=torch.bfloat16) * 0.05)(Dff, D)),
        }
    _B_in = _B_setup()

    return {
        "A_x": _A_in["x"],
        "A_Lambda_re": _A_in["Lambda_re"],
        "A_Lambda_im": _A_in["Lambda_im"],
        "A_B_re": _A_in["B_re"],
        "A_B_im": _A_in["B_im"],
        "A_C_re": _A_in["C_re"],
        "A_C_im": _A_in["C_im"],
        "A_log_dt": _A_in["log_dt"],
        "A_Dskip": _A_in["Dskip"],
        "B_x": _B_in["x"],
        "B_w1": _B_in["w1"],
        "B_w2": _B_in["w2"],
    }

def reference(A_x, A_Lambda_re, A_Lambda_im, A_B_re, A_B_im, A_C_re, A_C_im, A_log_dt, A_Dskip, B_x, B_w1, B_w2):
    def _A_ref(x, Lambda_re, Lambda_im, B_re, B_im, C_re, C_im, log_dt, Dskip):
        Bsz, L, H = x.shape
        Lam = Lambda_re + 1j * Lambda_im
        Bmat = B_re + 1j * B_im
        Cmat = C_re + 1j * C_im
        dt = torch.exp(log_dt)
        Lam_bar = torch.exp(dt * Lam)
        B_bar = ((Lam_bar - 1.0) / Lam)[:, None] * Bmat
        Bu = torch.einsum("bld,pd->blp", x + 0j, B_bar)
        h = torch.zeros_like(Bu[:, 0, :])
        hs = []
        for t in range(L):
            h = Lam_bar[None, :] * h + Bu[:, t, :]
            hs.append(h)
        hseq = torch.stack(hs, 1)
        y = 2.0 * torch.einsum("blp,dp->bld", hseq, Cmat).real + x * Dskip[None, None, :]
        return y

    def _B_ref(x, w1, w2):
        h = torch.einsum("bsd,df->bsf", x, w1)
        zero = torch.zeros_like(h)
        h = torch.maximum(h, zero)
        return torch.einsum("bsf,fd->bsd", h, w2)

    x = A_x
    xn = _layernorm(x, axis=-1)
    return x + _A_ref(xn, A_Lambda_re, A_Lambda_im, A_B_re, A_B_im, A_C_re, A_C_im, A_log_dt, A_Dskip) + _B_ref(xn, B_w1, B_w2)
```

```asm
; @launch grid=(256,1,1) block=(256,1,1) lds=163840
.amdgcn_target "amdgcn-amd-amdhsa--gfx950"
.text
.globl parallel_sum__ssm_conv_s5__dense_activation_relu__prompt_kernel
.p2align 8
.type parallel_sum__ssm_conv_s5__dense_activation_relu__prompt_kernel,@function
parallel_sum__ssm_conv_s5__dense_activation_relu__prompt_kernel:
    s_cmp_ge_u32 s2, 256
    s_cbranch_scc1 L_end
    s_load_dwordx2 s[44:45], s[0:1], 112
    s_load_dwordx16 s[16:31], s[0:1], 0
    s_load_dwordx8 s[32:39], s[0:1], 64
    s_load_dwordx4 s[40:43], s[0:1], 96
    s_lshr_b32 s11, s2, 3
    s_and_b32 s8, s2, 1
    s_xor_b32 s8, s8, 1
    s_getpc_b64 s[88:89]
L_pc_2:
    s_cmp_eq_u32 s8, 0
    s_cselect_b32 s12, 0, L_mlp-L_pc_2
    s_mov_b32 s13, L_end-L_pc_2
    s_cselect_b32 s13, L_mlp-L_pc_2, s13
    s_lshl_b32 s14, s11, 7
    s_add_u32 s14, s14, s12
    v_lshl_add_u32 v12, v0, 12, s14
    v_cmp_gt_u32 vcc, s13, v12
    s_nop 0
    s_and_saveexec_b64 s[90:91], vcc
    s_cbranch_execz L_nopf_1
    v_mov_b32 v13, s89
    v_add_co_u32 v12, vcc, s88, v12
    s_nop 1
    v_addc_co_u32 v13, vcc, 0, v13, vcc
    global_load_dword v255, v[12:13], off
L_nopf_1:
    s_mov_b64 exec, -1
    s_and_b32 s4, s11, 7
    s_lshr_b32 s11, s11, 3
    s_bfe_u32 s12, s2, 0x20001
    s_lshr_b32 s13, s12, 1
    s_xor_b32 s12, s12, s13
    s_lshl_b32 s12, s12, 2
    s_add_u32 s3, s12, s11
    v_lshrrev_b32 v8, 5, v0
    v_and_b32 v9, 31, v0
    v_and_b32 v10, 1, v8
    v_lshlrev_b32 v10, 2, v10
    v_bfe_u32 v11, v8, 1, 1
    v_add_u32 v10, v10, v11
    v_lshrrev_b32 v11, 2, v8
    v_lshl_add_u32 v10, v11, 3, v10
    v_mul_u32_u24 v10, 0x500, v10
    v_lshl_add_u32 v10, v9, 4, v10
    s_and_b32 s12, s4, 1
    s_lshl_b32 s13, s8, 3
    s_add_u32 s12, s12, s13
    s_lshl_b32 s12, s12, 1
    s_lshr_b32 s11, s4, 1
    s_lshl_b32 s11, s11, 5
    s_add_u32 s11, s11, s12
    s_lshl_b32 s12, s3, 7
    s_add_u32 s11, s11, s12
    s_mul_i32 s11, s11, 1280
    s_mov_b32 s50, 2621440
    s_mov_b32 s51, 0x20000
    s_mov_b32 s94, 0xffff
    s_mov_b32 s95, 0xffff
    s_waitcnt lgkmcnt(0)
    s_mov_b32 s48, s16
    s_mov_b32 s49, s17
    buffer_load_dwordx4 v[96:99], v10, s[48:51], s11 offen offset:0
    buffer_load_dwordx4 v[100:103], v10, s[48:51], s11 offen offset:512
    s_mov_b64 exec, s[94:95]
    buffer_load_dwordx4 v[104:107], v10, s[48:51], s11 offen offset:1024
    s_mov_b64 exec, -1
    v_lshrrev_b32 v7, 6, v0
    v_and_b32 v1, 63, v0
    v_readfirstlane_b32 s5, v7
    v_lshlrev_b32 v2, 4, v1
    s_lshl_b32 s9, s8, 4
    s_add_u32 s9, s9, s3
    s_lshl_b32 s9, s9, 3
    s_add_u32 s9, s9, s4
    s_lshl_b32 s9, s9, 10
    s_mov_b32 s10, 32768
    s_mov_b32 s52, s44
    s_mov_b32 s53, s45
    s_mov_b32 s54, 25165824
    s_mov_b32 s55, 0x20000
    s_lshl_b32 s47, s8, 3
    s_add_u32 s47, s47, s4
    s_lshl_b32 s11, s3, 13
    v_and_b32 v11, 7, v1
    v_lshl_add_u32 v4, v11, 10, s11
    v_bfe_u32 v11, v1, 3, 1
    v_lshl_add_u32 v4, v11, 17, v4
    s_add_u32 s12, s4, 120
    s_lshl_b32 s12, s12, 10
    v_mov_b32 v11, s12
    v_cmp_gt_u32 vcc, 16, v1
    s_nop 1
    v_cndmask_b32 v4, v11, v4, vcc
    buffer_load_dword v3, v4, s[52:55], 0 offen sc1
    v_and_b32 v11, 7, v1
    v_lshlrev_b32 v11, 7, v11
    buffer_load_dword v255, v11, s[52:55], s9 offen
    s_cmp_eq_u32 s8, 0
    s_cbranch_scc0 L_mlp
    s_and_b32 s11, s5, 1
    v_lshl_add_u32 v45, s11, 6, v1
    s_mul_i32 s11, s4, 160
    v_lshl_add_u32 v12, v45, 1, s11
    s_mov_b32 s76, s18
    s_mov_b32 s77, s19
    s_mov_b32 s78, 1280
    s_mov_b32 s79, 0x20000
    buffer_load_ushort v196, v12, s[76:79], 0 offen
    s_mov_b32 s76, s20
    s_mov_b32 s77, s21
    s_mov_b32 s78, 1280
    s_mov_b32 s79, 0x20000
    buffer_load_ushort v197, v12, s[76:79], 0 offen
    s_mov_b32 s76, s30
    s_mov_b32 s77, s31
    s_mov_b32 s78, 1280
    s_mov_b32 s79, 0x20000
    buffer_load_ushort v198, v12, s[76:79], 0 offen
    s_lshl_b32 s12, s4, 4
    s_sub_u32 s12, s12, s3
    s_mul_i32 s12, s12, 1280
    s_add_u32 s12, s12, 281344
    v_min_u32 v12, 9, v1
    v_lshlrev_b32 v12, 7, v12
    buffer_load_dword v255, v12, s[52:55], s12 offen
    s_cmp_lt_u32 s5, 2
    s_cselect_b32 s56, s22, s24
    s_cselect_b32 s57, s23, s25
    s_mov_b32 s58, 819200
    s_mov_b32 s59, 0x20000
    s_cselect_b32 s60, s24, s22
    s_cselect_b32 s61, s25, s23
    s_mov_b32 s62, 819200
    s_mov_b32 s63, 0x20000
    s_cselect_b32 s64, s26, s28
    s_cselect_b32 s65, s27, s29
    s_mov_b32 s66, 819200
    s_mov_b32 s67, 0x20000
    s_cselect_b32 s68, s28, s26
    s_cselect_b32 s69, s29, s27
    s_mov_b32 s70, 819200
    s_mov_b32 s71, 0x20000
    s_and_b32 s11, s5, 1
    s_lshr_b32 s12, s5, 1
    s_mul_i32 s86, s12, 10240
    s_mul_i32 s13, s11, 3072
    s_add_u32 s86, s86, s13
    s_xor_b32 s12, s12, 1
    s_mul_i32 s87, s12, 10240
    s_lshl_b32 s13, s11, 11
    s_add_u32 s87, s87, s13
    s_add_u32 s87, s87, 6144
    v_lshrrev_b32 v12, 3, v1
    v_and_b32 v13, 7, v1
    v_lshrrev_b32 v14, 1, v12
    v_xor_b32 v13, v13, v14
    v_lshlrev_b32 v13, 4, v13
    v_mul_u32_u24 v12, 0x500, v12
    v_add_u32 v12, v12, v13
    s_mul_i32 s12, s11, 3
    s_add_u32 s12, s12, 0
    s_and_b32 s13, s12, 1
    s_lshl_b32 s13, s13, 6
    v_xor_b32 v13, s13, v12
    s_mul_i32 s13, s4, 10
    s_add_u32 s13, s13, s12
    s_mul_i32 s13, s13, 10240
    s_sub_u32 s13, s13, 0
    v_add_u32 v16, s13, v13
    s_lshl_b32 s13, s4, 3
    s_add_u32 s13, s13, s12
    s_lshl_b32 s14, s4, 1
    s_add_u32 s14, s14, s12
    s_add_u32 s14, s14, 56
    s_cmp_lt_u32 s12, 8
    s_cselect_b32 s13, s13, s14
    s_mul_i32 s13, s13, 10240
    s_sub_u32 s13, s13, 0
    v_add_u32 v21, s13, v13
    s_mul_i32 s12, s11, 3
    s_add_u32 s12, s12, 1
    s_and_b32 s13, s12, 1
    s_lshl_b32 s13, s13, 6
    v_xor_b32 v13, s13, v12
    s_mul_i32 s13, s4, 10
    s_add_u32 s13, s13, s12
    s_mul_i32 s13, s13, 10240
    s_sub_u32 s13, s13, 1024
    v_add_u32 v17, s13, v13
    s_lshl_b32 s13, s4, 3
    s_add_u32 s13, s13, s12
    s_lshl_b32 s14, s4, 1
    s_add_u32 s14, s14, s12
    s_add_u32 s14, s14, 56
    s_cmp_lt_u32 s12, 8
    s_cselect_b32 s13, s13, s14
    s_mul_i32 s13, s13, 10240
    s_sub_u32 s13, s13, 1024
    v_add_u32 v22, s13, v13
    s_mul_i32 s12, s11, 3
    s_add_u32 s12, s12, 2
    s_and_b32 s13, s12, 1
    s_lshl_b32 s13, s13, 6
    v_xor_b32 v13, s13, v12
    s_mul_i32 s13, s4, 10
    s_add_u32 s13, s13, s12
    s_mul_i32 s13, s13, 10240
    s_sub_u32 s13, s13, 2048
    v_add_u32 v18, s13, v13
    s_lshl_b32 s13, s4, 3
    s_add_u32 s13, s13, s12
    s_lshl_b32 s14, s4, 1
    s_add_u32 s14, s14, s12
    s_add_u32 s14, s14, 56
    s_cmp_lt_u32 s12, 8
    s_cselect_b32 s13, s13, s14
    s_mul_i32 s13, s13, 10240
    s_sub_u32 s13, s13, 2048
    v_add_u32 v23, s13, v13
    s_lshl_b32 s12, s11, 1
    s_add_u32 s12, s12, 6
    s_and_b32 s13, s12, 1
    s_lshl_b32 s13, s13, 6
    v_xor_b32 v13, s13, v12
    s_mul_i32 s13, s4, 10
    s_add_u32 s13, s13, s12
    s_mul_i32 s13, s13, 10240
    s_sub_u32 s13, s13, 0
    v_add_u32 v19, s13, v13
    s_lshl_b32 s13, s4, 3
    s_add_u32 s13, s13, s12
    s_lshl_b32 s14, s4, 1
    s_add_u32 s14, s14, s12
    s_add_u32 s14, s14, 56
    s_cmp_lt_u32 s12, 8
    s_cselect_b32 s13, s13, s14
    s_mul_i32 s13, s13, 10240
    s_sub_u32 s13, s13, 0
    v_add_u32 v24, s13, v13
    s_lshl_b32 s12, s11, 1
    s_add_u32 s12, s12, 7
    s_and_b32 s13, s12, 1
    s_lshl_b32 s13, s13, 6
    v_xor_b32 v13, s13, v12
    s_mul_i32 s13, s4, 10
    s_add_u32 s13, s13, s12
    s_mul_i32 s13, s13, 10240
    s_sub_u32 s13, s13, 1024
    v_add_u32 v20, s13, v13
    s_lshl_b32 s13, s4, 3
    s_add_u32 s13, s13, s12
    s_lshl_b32 s14, s4, 1
    s_add_u32 s14, s14, s12
    s_add_u32 s14, s14, 56
    s_cmp_lt_u32 s12, 8
    s_cselect_b32 s13, s13, s14
    s_mul_i32 s13, s13, 10240
    s_sub_u32 s13, s13, 1024
    v_add_u32 v25, s13, v13
    s_and_b32 s11, s3, 3
    s_mul_i32 s11, s11, 10
    s_lshr_b32 s11, s11, 2
    s_lshr_b32 s12, s3, 2
    s_add_u32 s11, s11, s12
    s_mul_i32 s12, s4, 10
    s_lshr_b32 s12, s12, 3
    s_add_u32 s11, s11, s12
    s_mul_hi_u32 s12, s11, 429496730
    s_mul_i32 s12, s12, 10
    s_sub_u32 s11, s11, s12
    s_mul_i32 s80, s11, 128
    s_and_b32 s11, s3, 3
    s_mul_i32 s11, s11, 10
    s_lshr_b32 s11, s11, 2
    s_lshr_b32 s12, s3, 2
    s_add_u32 s11, s11, s12
    s_mul_hi_u32 s12, s11, 429496730
    s_mul_i32 s12, s12, 10
    s_sub_u32 s11, s11, s12
    s_mul_i32 s81, s11, 128
    s_add_u32 m0, s86, 0
    s_nop 0
    buffer_load_dwordx4 v16, s[56:59], s80 offen offset:0 lds
    buffer_load_dwordx4 v17, s[56:59], s80 offen offset:1024 lds
    buffer_load_dwordx4 v18, s[56:59], s80 offen offset:2048 lds
    s_add_u32 m0, s87, 0
    s_nop 0
    buffer_load_dwordx4 v19, s[60:63], s80 offen offset:0 lds
    buffer_load_dwordx4 v20, s[60:63], s80 offen offset:1024 lds
    s_add_u32 s80, s80, 128
    s_cmp_eq_u32 s80, 1280
    s_cselect_b32 s80, 0, s80
    v_and_b32 v12, 15, v1
    v_lshrrev_b32 v13, 4, v1
    v_lshrrev_b32 v14, 1, v12
    v_xor_b32 v15, v13, v14
    v_lshlrev_b32 v15, 4, v15
    v_lshl_add_u32 v15, v12, 7, v15
    v_add_u32 v26, 0, v15
    v_xor_b32 v27, 64, v26
    v_add_u32 v28, 61440, v15
    v_xor_b32 v29, 64, v28
    v_add_u32 v30, 122880, v15
    v_xor_b32 v31, 64, v30
    v_and_b32 v15, 1, v13
    v_xor_b32 v15, v15, v14
    v_lshlrev_b32 v15, 4, v15
    v_lshl_add_u32 v15, v12, 7, v15
    v_lshrrev_b32 v14, 1, v13
    v_mul_u32_u24 v14, 0x2800, v14
    v_add_u32 v15, v15, v14
    v_add_u32 v32, 0, v15
    v_xor_b32 v33, 32, v32
    v_xor_b32 v34, 64, v32
    v_xor_b32 v35, 96, v32
    v_add_u32 v36, 61440, v15
    v_xor_b32 v37, 32, v36
    v_xor_b32 v38, 64, v36
    v_xor_b32 v39, 96, v36
    v_add_u32 v40, 122880, v15
    v_xor_b32 v41, 32, v40
    v_xor_b32 v42, 64, v40
    v_xor_b32 v43, 96, v40
    v_lshlrev_b32 v46, 3, v12
    v_add_u32 v46, 143360, v46
    v_lshl_add_u32 v14, s5, 2, v13
    v_mul_u32_u24 v14, 0x280, v14
    v_add_u32 v47, v14, v46
    v_add_u32 v44, 20480, v2
    s_mul_i32 s84, s3, 163840
    s_mul_i32 s11, s5, 40960
    s_add_u32 s84, s84, s11
    s_add_u32 s84, s84, 3145728
    s_add_u32 s85, s84, 20480
    s_and_b32 s11, s3, 3
    s_mul_i32 s11, s11, 10
    s_lshr_b32 s11, s11, 2
    s_lshr_b32 s12, s3, 2
    s_add_u32 s11, s11, s12
    s_mul_i32 s12, s4, 10
    s_lshr_b32 s12, s12, 3
    s_add_u32 s11, s11, s12
    s_mul_hi_u32 s12, s11, 429496730
    s_mul_i32 s12, s12, 10
    s_sub_u32 s11, s11, s12
    s_mul_i32 s83, s11, 2048
    s_add_u32 s83, s83, s84
    v_and_b32 v10, 7, v9
    v_xor_b32 v10, v8, v10
    v_lshlrev_b32 v10, 4, v10
    v_lshl_add_u32 v10, v9, 7, v10
    v_add_u32 v10, 122880, v10
    v_lshrrev_b32 v8, 3, v0
    v_and_b32 v9, 7, v0
    v_xor_b32 v11, v8, v9
    v_and_b32 v11, 7, v11
    v_lshlrev_b32 v11, 4, v11
    v_lshl_add_u32 v11, v8, 7, v11
    v_add_u32 v11, 122880, v11
    v_lshlrev_b32 v9, 4, v9
    v_lshl_add_u32 v9, v8, 8, v9
    s_mul_i32 s13, s3, 163840
    s_mul_i32 s12, s4, 20480
    s_add_u32 s13, s13, s12
    s_lshl_b32 s12, s8, 7
    s_add_u32 s13, s13, s12
    s_add_u32 s92, s13, 3145728
    s_waitcnt vmcnt(13)
    v_lshlrev_b32 v116, 16, v96
    v_and_b32 v117, 0xffff0000, v96
    v_lshlrev_b32 v118, 16, v97
    v_and_b32 v119, 0xffff0000, v97
    v_pk_add_f32 v[12:13], v[116:117], v[118:119]
    v_lshlrev_b32 v120, 16, v98
    v_and_b32 v121, 0xffff0000, v98
    v_pk_add_f32 v[12:13], v[12:13], v[120:121]
    v_lshlrev_b32 v122, 16, v99
    v_and_b32 v123, 0xffff0000, v99
    v_pk_add_f32 v[12:13], v[12:13], v[122:123]
    s_waitcnt vmcnt(12)
    v_lshlrev_b32 v124, 16, v100
    v_and_b32 v125, 0xffff0000, v100
    v_pk_add_f32 v[12:13], v[12:13], v[124:125]
    v_lshlrev_b32 v126, 16, v101
    v_and_b32 v127, 0xffff0000, v101
    v_pk_add_f32 v[12:13], v[12:13], v[126:127]
    v_lshlrev_b32 v128, 16, v102
    v_and_b32 v129, 0xffff0000, v102
    v_pk_add_f32 v[12:13], v[12:13], v[128:129]
    v_lshlrev_b32 v130, 16, v103
    v_and_b32 v131, 0xffff0000, v103
    v_pk_add_f32 v[12:13], v[12:13], v[130:131]
    s_mov_b64 exec, s[94:95]
    s_waitcnt vmcnt(11)
    v_lshlrev_b32 v132, 16, v104
    v_and_b32 v133, 0xffff0000, v104
    v_pk_add_f32 v[12:13], v[12:13], v[132:133]
    v_lshlrev_b32 v134, 16, v105
    v_and_b32 v135, 0xffff0000, v105
    v_pk_add_f32 v[12:13], v[12:13], v[134:135]
    v_lshlrev_b32 v136, 16, v106
    v_and_b32 v137, 0xffff0000, v106
    v_pk_add_f32 v[12:13], v[12:13], v[136:137]
    v_lshlrev_b32 v138, 16, v107
    v_and_b32 v139, 0xffff0000, v107
    v_pk_add_f32 v[12:13], v[12:13], v[138:139]
    s_mov_b64 exec, -1
    v_add_f32 v12, v12, v13
    s_nop 1
    v_add_f32_dpp v12, v12, v12 row_ror:8 row_mask:0xf bank_mask:0xf
    s_nop 1
    v_add_f32_dpp v12, v12, v12 row_ror:4 row_mask:0xf bank_mask:0xf
    s_nop 1
    v_add_f32_dpp v12, v12, v12 row_ror:2 row_mask:0xf bank_mask:0xf
    s_nop 1
    v_add_f32_dpp v12, v12, v12 row_ror:1 row_mask:0xf bank_mask:0xf
    v_mov_b32 v13, v12
    s_nop 1
    v_permlane16_swap_b32 v12, v13
    v_add_f32 v12, v12, v13
    v_mul_f32 v12, 0x3acccccd, v12
    v_mov_b32 v14, v12
    v_cvt_pk_bf16_f32 v14, v14, v14
    v_lshlrev_b32 v14, 16, v14
    v_sub_f32 v15, v12, v14
    v_pk_add_f32 v[116:117], v[116:117], v[14:15] op_sel_hi:[1,0] neg_lo:[0,1] neg_hi:[0,1]
    v_pk_add_f32 v[118:119], v[118:119], v[14:15] op_sel_hi:[1,0] neg_lo:[0,1] neg_hi:[0,1]
    v_pk_add_f32 v[120:121], v[120:121], v[14:15] op_sel_hi:[1,0] neg_lo:[0,1] neg_hi:[0,1]
    v_pk_add_f32 v[122:123], v[122:123], v[14:15] op_sel_hi:[1,0] neg_lo:[0,1] neg_hi:[0,1]
    v_pk_add_f32 v[124:125], v[124:125], v[14:15] op_sel_hi:[1,0] neg_lo:[0,1] neg_hi:[0,1]
    v_pk_add_f32 v[126:127], v[126:127], v[14:15] op_sel_hi:[1,0] neg_lo:[0,1] neg_hi:[0,1]
    v_pk_add_f32 v[128:129], v[128:129], v[14:15] op_sel_hi:[1,0] neg_lo:[0,1] neg_hi:[0,1]
    v_pk_add_f32 v[130:131], v[130:131], v[14:15] op_sel_hi:[1,0] neg_lo:[0,1] neg_hi:[0,1]
    v_pk_mul_f32 v[12:13], v[116:117], v[116:117]
    v_pk_fma_f32 v[12:13], v[118:119], v[118:119], v[12:13]
    v_pk_fma_f32 v[12:13], v[120:121], v[120:121], v[12:13]
    v_pk_fma_f32 v[12:13], v[122:123], v[122:123], v[12:13]
    v_pk_fma_f32 v[12:13], v[124:125], v[124:125], v[12:13]
    v_pk_fma_f32 v[12:13], v[126:127], v[126:127], v[12:13]
    v_pk_fma_f32 v[12:13], v[128:129], v[128:129], v[12:13]
    v_pk_fma_f32 v[12:13], v[130:131], v[130:131], v[12:13]
    s_mov_b64 exec, s[94:95]
    v_pk_add_f32 v[132:133], v[132:133], v[14:15] op_sel_hi:[1,0] neg_lo:[0,1] neg_hi:[0,1]
    v_pk_add_f32 v[134:135], v[134:135], v[14:15] op_sel_hi:[1,0] neg_lo:[0,1] neg_hi:[0,1]
    v_pk_add_f32 v[136:137], v[136:137], v[14:15] op_sel_hi:[1,0] neg_lo:[0,1] neg_hi:[0,1]
    v_pk_add_f32 v[138:139], v[138:139], v[14:15] op_sel_hi:[1,0] neg_lo:[0,1] neg_hi:[0,1]
    v_pk_fma_f32 v[12:13], v[132:133], v[132:133], v[12:13]
    v_pk_fma_f32 v[12:13], v[134:135], v[134:135], v[12:13]
    v_pk_fma_f32 v[12:13], v[136:137], v[136:137], v[12:13]
    v_pk_fma_f32 v[12:13], v[138:139], v[138:139], v[12:13]
    s_mov_b64 exec, -1
    v_add_f32 v12, v12, v13
    s_nop 1
    v_add_f32_dpp v12, v12, v12 row_ror:8 row_mask:0xf bank_mask:0xf
    s_nop 1
    v_add_f32_dpp v12, v12, v12 row_ror:4 row_mask:0xf bank_mask:0xf
    s_nop 1
    v_add_f32_dpp v12, v12, v12 row_ror:2 row_mask:0xf bank_mask:0xf
    s_nop 1
    v_add_f32_dpp v12, v12, v12 row_ror:1 row_mask:0xf bank_mask:0xf
    v_mov_b32 v13, v12
    s_nop 1
    v_permlane16_swap_b32 v12, v13
    v_add_f32 v12, v12, v13
    v_mul_f32 v12, 0x3acccccd, v12
    v_fma_f32 v12, -v15, v15, v12
    v_max_f32 v12, 0, v12
    v_cvt_pk_bf16_f32 v12, v12, v12
    v_lshlrev_b32 v12, 16, v12
    v_add_f32 v12, 0x3727c5ac, v12
    v_cvt_pk_bf16_f32 v12, v12, v12
    v_lshlrev_b32 v12, 16, v12
    v_sqrt_f32 v12, v12
    s_nop 0
    v_cvt_pk_bf16_f32 v12, v12, v12
    v_lshlrev_b32 v12, 16, v12
    v_rcp_f32 v12, v12
    s_nop 0
    v_pk_mul_f32 v[116:117], v[116:117], v[12:13] op_sel_hi:[1,0]
    v_cvt_pk_bf16_f32 v96, v116, v117
    v_pk_mul_f32 v[118:119], v[118:119], v[12:13] op_sel_hi:[1,0]
    v_cvt_pk_bf16_f32 v97, v118, v119
    v_pk_mul_f32 v[120:121], v[120:121], v[12:13] op_sel_hi:[1,0]
    v_cvt_pk_bf16_f32 v98, v120, v121
    v_pk_mul_f32 v[122:123], v[122:123], v[12:13] op_sel_hi:[1,0]
    v_cvt_pk_bf16_f32 v99, v122, v123
    ds_write_b128 v10, v[96:99] offset:0
    v_pk_mul_f32 v[124:125], v[124:125], v[12:13] op_sel_hi:[1,0]
    v_cvt_pk_bf16_f32 v100, v124, v125
    v_pk_mul_f32 v[126:127], v[126:127], v[12:13] op_sel_hi:[1,0]
    v_cvt_pk_bf16_f32 v101, v126, v127
    v_pk_mul_f32 v[128:129], v[128:129], v[12:13] op_sel_hi:[1,0]
    v_cvt_pk_bf16_f32 v102, v128, v129
    v_pk_mul_f32 v[130:131], v[130:131], v[12:13] op_sel_hi:[1,0]
    v_cvt_pk_bf16_f32 v103, v130, v131
    ds_write_b128 v10, v[100:103] offset:4096
    s_mov_b64 exec, s[94:95]
    v_pk_mul_f32 v[132:133], v[132:133], v[12:13] op_sel_hi:[1,0]
    v_cvt_pk_bf16_f32 v104, v132, v133
    v_pk_mul_f32 v[134:135], v[134:135], v[12:13] op_sel_hi:[1,0]
    v_cvt_pk_bf16_f32 v105, v134, v135
    v_pk_mul_f32 v[136:137], v[136:137], v[12:13] op_sel_hi:[1,0]
    v_cvt_pk_bf16_f32 v106, v136, v137
    v_pk_mul_f32 v[138:139], v[138:139], v[12:13] op_sel_hi:[1,0]
    v_cvt_pk_bf16_f32 v107, v138, v139
    ds_write_b128 v10, v[104:107] offset:8192
    s_mov_b64 exec, -1
    s_waitcnt lgkmcnt(0)
    s_barrier
    ds_read_b128 v[96:99], v11 offset:0
    ds_read_b128 v[100:103], v11 offset:4096
    ds_read_b128 v[104:107], v11 offset:8192
    s_waitcnt lgkmcnt(2)
    buffer_store_dwordx4 v[96:99], v9, s[52:55], s92 offen sc1
    s_add_u32 s13, s92, 8192
    s_add_u32 s14, s92, 16384
    s_waitcnt lgkmcnt(1)
    buffer_store_dwordx4 v[100:103], v9, s[52:55], s13 offen sc1
    s_waitcnt lgkmcnt(0)
    s_cmp_gt_u32 s5, 1
    s_cbranch_scc1 L_third_3
    buffer_store_dwordx4 v[104:107], v9, s[52:55], s14 offen sc1
L_third_3:
    s_waitcnt vmcnt(12)
    v_readlane_b32 s7, v3, s47
    v_readlane_b32 s6, v3, 16
    s_add_u32 m0, s86, 20480
    s_nop 0
    buffer_load_dwordx4 v16, s[56:59], s80 offen offset:0 lds
    buffer_load_dwordx4 v17, s[56:59], s80 offen offset:1024 lds
    buffer_load_dwordx4 v18, s[56:59], s80 offen offset:2048 lds
    s_add_u32 m0, s87, 20480
    s_nop 0
    buffer_load_dwordx4 v19, s[60:63], s80 offen offset:0 lds
    buffer_load_dwordx4 v20, s[60:63], s80 offen offset:1024 lds
    s_add_u32 s80, s80, 128
    s_cmp_eq_u32 s80, 1280
    s_cselect_b32 s80, 0, s80
    v_lshlrev_b32 v45, 3, v45
    v_add_u32 v45, 143360, v45
    s_bitcmp0_b32 s5, 0
    s_cselect_b32 s88, -1, 0xffff
    s_cselect_b32 s89, -1, 0
    s_cmp_gt_u32 s5, 1
    s_cbranch_scc1 L_noconst_4
    s_mov_b64 exec, s[88:89]
    s_waitcnt vmcnt(15)
    v_lshlrev_b32 v196, 16, v196
    s_waitcnt vmcnt(14)
    v_lshlrev_b32 v197, 16, v197
    s_waitcnt vmcnt(13)
    v_lshlrev_b32 v198, 16, v198
    v_mul_f32 v198, 0x3fb8aa3b, v198
    v_exp_f32 v198, v198
    s_nop 0
    v_cvt_pk_bf16_f32 v198, v198, v198
    v_lshlrev_b32 v198, 16, v198
    v_mul_f32 v200, v198, v196
    v_mul_f32 v201, v198, v197
    v_mul_f32 v200, 0x3fb8aa3b, v200
    v_exp_f32 v200, v200
    v_mul_f32 v201, 0.15915494, v201
    v_rndne_f32 v202, v201
    v_sub_f32 v201, v201, v202
    v_cos_f32 v202, v201
    v_sin_f32 v203, v201
    v_mul_f32 v204, v200, v202
    v_mul_f32 v205, v200, v203
    v_mul_f32 v200, v196, v196
    v_fma_f32 v200, v197, v197, v200
    v_rcp_f32 v200, v200
    v_add_f32 v201, -1.0, v204
    v_add_f32 v200, v200, v200
    v_mul_f32 v202, v201, v196
    v_fma_f32 v202, v205, v197, v202
    v_mul_f32 v203, v205, v196
    v_fma_f32 v203, -v201, v197, v203
    v_mul_f32 v92, v202, v200
    v_mul_f32 v93, v203, v200
    v_pk_mul_f32 v[206:207], v[204:205], v[204:205] op_sel:[0,0] op_sel_hi:[0,1]
    v_pk_fma_f32 v[206:207], v[204:205], v[204:205], v[206:207] op_sel:[1,1,0] op_sel_hi:[1,0,1] neg_lo:[1,0,0]
    v_pk_mul_f32 v[208:209], v[206:207], v[206:207] op_sel:[0,0] op_sel_hi:[0,1]
    v_pk_fma_f32 v[208:209], v[206:207], v[206:207], v[208:209] op_sel:[1,1,0] op_sel_hi:[1,0,1] neg_lo:[1,0,0]
    v_pk_mul_f32 v[88:89], v[208:209], v[208:209] op_sel:[0,0] op_sel_hi:[0,1]
    v_pk_fma_f32 v[88:89], v[208:209], v[208:209], v[88:89] op_sel:[1,1,0] op_sel_hi:[1,0,1] neg_lo:[1,0,0]
    ds_write_b64 v45, v[204:205] offset:10240
    ds_write_b64 v45, v[208:209] offset:10880
    ds_write_b64 v45, v[92:93] offset:11520
    ds_write_b64 v45, v[92:93]
    v_pk_mul_f32 v[212:213], v[88:89], v[92:93] op_sel:[0,0] op_sel_hi:[0,1]
    v_pk_fma_f32 v[212:213], v[88:89], v[92:93], v[212:213] op_sel:[1,1,0] op_sel_hi:[1,0,1] neg_lo:[1,0,0]
    ds_write_b64 v45, v[212:213] offset:640
    v_pk_mul_f32 v[210:211], v[88:89], v[212:213] op_sel:[0,0] op_sel_hi:[0,1]
    v_pk_fma_f32 v[210:211], v[88:89], v[212:213], v[210:211] op_sel:[1,1,0] op_sel_hi:[1,0,1] neg_lo:[1,0,0]
    ds_write_b64 v45, v[210:211] offset:1280
    v_pk_mul_f32 v[212:213], v[88:89], v[210:211] op_sel:[0,0] op_sel_hi:[0,1]
    v_pk_fma_f32 v[212:213], v[88:89], v[210:211], v[212:213] op_sel:[1,1,0] op_sel_hi:[1,0,1] neg_lo:[1,0,0]
    ds_write_b64 v45, v[212:213] offset:1920
    v_pk_mul_f32 v[210:211], v[88:89], v[212:213] op_sel:[0,0] op_sel_hi:[0,1]
    v_pk_fma_f32 v[210:211], v[88:89], v[212:213], v[210:211] op_sel:[1,1,0] op_sel_hi:[1,0,1] neg_lo:[1,0,0]
    ds_write_b64 v45, v[210:211] offset:2560
    v_pk_mul_f32 v[212:213], v[88:89], v[210:211] op_sel:[0,0] op_sel_hi:[0,1]
    v_pk_fma_f32 v[212:213], v[88:89], v[210:211], v[212:213] op_sel:[1,1,0] op_sel_hi:[1,0,1] neg_lo:[1,0,0]
    ds_write_b64 v45, v[212:213] offset:3200
    v_pk_mul_f32 v[210:211], v[88:89], v[212:213] op_sel:[0,0] op_sel_hi:[0,1]
    v_pk_fma_f32 v[210:211], v[88:89], v[212:213], v[210:211] op_sel:[1,1,0] op_sel_hi:[1,0,1] neg_lo:[1,0,0]
    ds_write_b64 v45, v[210:211] offset:3840
    v_pk_mul_f32 v[212:213], v[88:89], v[210:211] op_sel:[0,0] op_sel_hi:[0,1]
    v_pk_fma_f32 v[212:213], v[88:89], v[210:211], v[212:213] op_sel:[1,1,0] op_sel_hi:[1,0,1] neg_lo:[1,0,0]
    ds_write_b64 v45, v[212:213] offset:4480
    v_pk_mul_f32 v[210:211], v[88:89], v[212:213] op_sel:[0,0] op_sel_hi:[0,1]
    v_pk_fma_f32 v[210:211], v[88:89], v[212:213], v[210:211] op_sel:[1,1,0] op_sel_hi:[1,0,1] neg_lo:[1,0,0]
    ds_write_b64 v45, v[210:211] offset:5120
    v_pk_mul_f32 v[212:213], v[88:89], v[210:211] op_sel:[0,0] op_sel_hi:[0,1]
    v_pk_fma_f32 v[212:213], v[88:89], v[210:211], v[212:213] op_sel:[1,1,0] op_sel_hi:[1,0,1] neg_lo:[1,0,0]
    ds_write_b64 v45, v[212:213] offset:5760
    v_pk_mul_f32 v[210:211], v[88:89], v[212:213] op_sel:[0,0] op_sel_hi:[0,1]
    v_pk_fma_f32 v[210:211], v[88:89], v[212:213], v[210:211] op_sel:[1,1,0] op_sel_hi:[1,0,1] neg_lo:[1,0,0]
    ds_write_b64 v45, v[210:211] offset:6400
    v_pk_mul_f32 v[212:213], v[88:89], v[210:211] op_sel:[0,0] op_sel_hi:[0,1]
    v_pk_fma_f32 v[212:213], v[88:89], v[210:211], v[212:213] op_sel:[1,1,0] op_sel_hi:[1,0,1] neg_lo:[1,0,0]
    ds_write_b64 v45, v[212:213] offset:7040
    v_pk_mul_f32 v[210:211], v[88:89], v[212:213] op_sel:[0,0] op_sel_hi:[0,1]
    v_pk_fma_f32 v[210:211], v[88:89], v[212:213], v[210:211] op_sel:[1,1,0] op_sel_hi:[1,0,1] neg_lo:[1,0,0]
    ds_write_b64 v45, v[210:211] offset:7680
    v_pk_mul_f32 v[212:213], v[88:89], v[210:211] op_sel:[0,0] op_sel_hi:[0,1]
    v_pk_fma_f32 v[212:213], v[88:89], v[210:211], v[212:213] op_sel:[1,1,0] op_sel_hi:[1,0,1] neg_lo:[1,0,0]
    ds_write_b64 v45, v[212:213] offset:8320
    v_pk_mul_f32 v[210:211], v[88:89], v[212:213] op_sel:[0,0] op_sel_hi:[0,1]
    v_pk_fma_f32 v[210:211], v[88:89], v[212:213], v[210:211] op_sel:[1,1,0] op_sel_hi:[1,0,1] neg_lo:[1,0,0]
    ds_write_b64 v45, v[210:211] offset:8960
    v_pk_mul_f32 v[212:213], v[88:89], v[210:211] op_sel:[0,0] op_sel_hi:[0,1]
    v_pk_fma_f32 v[212:213], v[88:89], v[210:211], v[212:213] op_sel:[1,1,0] op_sel_hi:[1,0,1] neg_lo:[1,0,0]
    ds_write_b64 v45, v[212:213] offset:9600
    v_pk_mul_f32 v[204:205], v[88:89], v[88:89] op_sel:[0,0] op_sel_hi:[0,1]
    v_pk_fma_f32 v[204:205], v[88:89], v[88:89], v[204:205] op_sel:[1,1,0] op_sel_hi:[1,0,1] neg_lo:[1,0,0]
    v_pk_mul_f32 v[206:207], v[204:205], v[204:205] op_sel:[0,0] op_sel_hi:[0,1]
    v_pk_fma_f32 v[206:207], v[204:205], v[204:205], v[206:207] op_sel:[1,1,0] op_sel_hi:[1,0,1] neg_lo:[1,0,0]
    v_pk_mul_f32 v[204:205], v[206:207], v[206:207] op_sel:[0,0] op_sel_hi:[0,1]
    v_pk_fma_f32 v[204:205], v[206:207], v[206:207], v[204:205] op_sel:[1,1,0] op_sel_hi:[1,0,1] neg_lo:[1,0,0]
    v_pk_mul_f32 v[90:91], v[204:205], v[204:205] op_sel:[0,0] op_sel_hi:[0,1]
    v_pk_fma_f32 v[90:91], v[204:205], v[204:205], v[90:91] op_sel:[1,1,0] op_sel_hi:[1,0,1] neg_lo:[1,0,0]
    ds_write_b64 v45, v[90:91] offset:12160
    s_mov_b64 exec, -1
    s_waitcnt lgkmcnt(0)
L_noconst_4:
    s_waitcnt vmcnt(5)
    s_barrier
    s_cmp_lg_u32 s5, 0
    s_cbranch_scc1 L_nosend_5
    v_add_u32 v5, 32, v3
    s_lshl_b32 s11, s47, 2
    s_add_u32 s11, s11, 256
    s_mov_b64 exec, 0xffff
    buffer_store_dword v5, v4, s[52:55], s11 offen sc1
    s_mov_b64 exec, -1
L_nosend_5:
    s_add_u32 m0, s86, 40960
    s_nop 0
    buffer_load_dwordx4 v16, s[56:59], s80 offen offset:0 lds
    buffer_load_dwordx4 v17, s[56:59], s80 offen offset:1024 lds
    buffer_load_dwordx4 v18, s[56:59], s80 offen offset:2048 lds
    s_add_u32 m0, s87, 40960
    s_nop 0
    buffer_load_dwordx4 v19, s[60:63], s80 offen offset:0 lds
    buffer_load_dwordx4 v20, s[60:63], s80 offen offset:1024 lds
    s_add_u32 s80, s80, 128
    s_cmp_eq_u32 s80, 1280
    s_cselect_b32 s80, 0, s80
    s_add_u32 m0, s86, 61440
    s_nop 0
    buffer_load_dwordx4 v16, s[56:59], s80 offen offset:0 lds
    buffer_load_dwordx4 v17, s[56:59], s80 offen offset:1024 lds
    buffer_load_dwordx4 v18, s[56:59], s80 offen offset:2048 lds
    s_add_u32 m0, s87, 61440
    s_nop 0
    buffer_load_dwordx4 v19, s[60:63], s80 offen offset:0 lds
    buffer_load_dwordx4 v20, s[60:63], s80 offen offset:1024 lds
    s_add_u32 s80, s80, 128
    s_cmp_eq_u32 s80, 1280
    s_cselect_b32 s80, 0, s80
    ds_read_b64 v[48:49], v46 offset:10240
    ds_read_b64 v[58:59], v46 offset:10880
    ds_read_b64 v[68:69], v46 offset:11520
    ds_read_b64 v[78:79], v47 offset:0
    ds_read_b64 v[50:51], v46 offset:10368
    ds_read_b64 v[60:61], v46 offset:11008
    ds_read_b64 v[70:71], v46 offset:11648
    ds_read_b64 v[80:81], v47 offset:128
    ds_read_b64 v[52:53], v46 offset:10496
    ds_read_b64 v[62:63], v46 offset:11136
    ds_read_b64 v[72:73], v46 offset:11776
    ds_read_b64 v[82:83], v47 offset:256
    ds_read_b64 v[54:55], v46 offset:10624
    ds_read_b64 v[64:65], v46 offset:11264
    ds_read_b64 v[74:75], v46 offset:11904
    ds_read_b64 v[84:85], v47 offset:384
    ds_read_b64 v[56:57], v46 offset:10752
    ds_read_b64 v[66:67], v46 offset:11392
    ds_read_b64 v[76:77], v46 offset:12032
    ds_read_b64 v[86:87], v47 offset:512
    ds_read_b64 v[90:91], v45 offset:12160
    v_and_b32 v13, 2, v1
    v_and_b32 v15, 1, v1
    v_lshl_add_u32 v13, v13, 2, v15
    v_lshl_add_u32 v13, s5, 1, v13
    v_lshlrev_b32 v13, 2, v13
    s_add_u32 s11, s9, 256
    s_add_u32 s12, s7, 32
L_poll_6:
    buffer_load_dword v12, v13, s[52:55], s11 offen sc1
    s_cmp_eq_u32 s10, 0
    s_waitcnt vmcnt(0)
    s_cbranch_scc1 L_polled_7
    s_sub_u32 s10, s10, 1
    v_cmp_eq_u32 vcc, s12, v12
    s_nop 0
    s_cmp_eq_u64 vcc, exec
    s_cbranch_scc0 L_poll_6
L_polled_7:
    buffer_load_dwordx4 a[0:3], v2, s[52:55], s83 offen offset:0 sc1
    buffer_load_dwordx4 a[4:7], v44, s[52:55], s83 offen offset:0 sc1
    buffer_load_dwordx4 a[8:11], v2, s[52:55], s83 offen offset:1024 sc1
    buffer_load_dwordx4 a[12:15], v44, s[52:55], s83 offen offset:1024 sc1
    s_add_u32 s83, s83, 2048
    s_cmp_eq_u32 s83, s85
    s_cselect_b32 s83, s84, s83
    ds_read_b128 a[64:67], v26 offset:0
    ds_read_b128 a[68:71], v26 offset:10240
    ds_read_b128 a[72:75], v26 offset:2048
    ds_read_b128 a[76:79], v26 offset:12288
    ds_read_b128 a[80:83], v26 offset:4096
    ds_read_b128 a[84:87], v26 offset:14336
    ds_read_b128 a[88:91], v26 offset:6144
    ds_read_b128 a[92:95], v26 offset:16384
    ds_read_b128 a[96:99], v26 offset:8192
    ds_read_b128 a[100:103], v26 offset:18432
    s_waitcnt vmcnt(2) lgkmcnt(5)
    v_mfma_f32_16x16x32_bf16 v[96:99], a[0:3], a[64:67], 0
    ds_read_b128 a[104:107], v27 offset:0
    v_mfma_f32_16x16x32_bf16 v[100:103], a[4:7], a[64:67], 0
    ds_read_b128 a[108:111], v27 offset:10240
    v_mfma_f32_16x16x32_bf16 v[104:107], a[0:3], a[68:71], 0
    buffer_load_dwordx4 a[16:19], v2, s[52:55], s83 offen offset:0 sc1
    v_mfma_f32_16x16x32_bf16 v[108:111], a[4:7], a[68:71], 0
    ds_read_b128 a[112:115], v27 offset:2048
    v_mfma_f32_16x16x32_bf16 v[112:115], a[0:3], a[72:75], 0
    ds_read_b128 a[116:119], v27 offset:12288
    v_mfma_f32_16x16x32_bf16 v[116:119], a[4:7], a[72:75], 0
    v_mfma_f32_16x16x32_bf16 v[120:123], a[0:3], a[76:79], 0
    ds_read_b128 a[120:123], v27 offset:4096
    buffer_load_dwordx4 a[20:23], v44, s[52:55], s83 offen offset:0 sc1
    v_mfma_f32_16x16x32_bf16 v[124:127], a[4:7], a[76:79], 0
    ds_read_b128 a[124:127], v27 offset:14336
    v_mfma_f32_16x16x32_bf16 v[128:131], a[0:3], a[80:83], 0
    v_mfma_f32_16x16x32_bf16 v[132:135], a[4:7], a[80:83], 0
    ds_read_b128 a[128:131], v27 offset:6144
    s_waitcnt lgkmcnt(7)
    v_mfma_f32_16x16x32_bf16 v[136:139], a[0:3], a[84:87], 0
    ds_read_b128 a[132:135], v27 offset:16384
    buffer_load_dwordx4 a[24:27], v2, s[52:55], s83 offen offset:1024 sc1
    v_mfma_f32_16x16x32_bf16 v[140:143], a[4:7], a[84:87], 0
    v_mfma_f32_16x16x32_bf16 v[144:147], a[0:3], a[88:91], 0
    ds_read_b128 a[136:139], v27 offset:8192
    v_mfma_f32_16x16x32_bf16 v[148:151], a[4:7], a[88:91], 0
    ds_read_b128 a[140:143], v27 offset:18432
    v_mfma_f32_16x16x32_bf16 v[152:155], a[0:3], a[92:95], 0
    buffer_load_dwordx4 a[28:31], v44, s[52:55], s83 offen offset:1024 sc1
    s_add_u32 s83, s83, 2048
    s_cmp_eq_u32 s83, s85
    s_cselect_b32 s83, s84, s83
    v_mfma_f32_16x16x32_bf16 v[156:159], a[4:7], a[92:95], 0
    v_mfma_f32_16x16x32_bf16 v[160:163], a[0:3], a[96:99], 0
    v_mfma_f32_16x16x32_bf16 v[164:167], a[4:7], a[96:99], 0
    v_mfma_f32_16x16x32_bf16 v[168:171], a[0:3], a[100:103], 0
    buffer_load_dwordx4 a[32:35], v2, s[52:55], s83 offen offset:0 sc1
    v_mfma_f32_16x16x32_bf16 v[172:175], a[4:7], a[100:103], 0
    s_barrier
    s_waitcnt vmcnt(5) lgkmcnt(5)
    v_mfma_f32_16x16x32_bf16 v[96:99], a[8:11], a[104:107], v[96:99]
    ds_read_b128 a[64:67], v26 offset:20480
    s_lshl_b32 s90, s4, 11
    v_mfma_f32_16x16x32_bf16 v[100:103], a[12:15], a[104:107], v[100:103]
    ds_read_b128 a[68:71], v26 offset:30720
    s_add_u32 s90, s90, s84
    buffer_load_dwordx4 a[36:39], v44, s[52:55], s83 offen offset:0 sc1
    v_mfma_f32_16x16x32_bf16 v[104:107], a[8:11], a[108:111], v[104:107]
    v_mfma_f32_16x16x32_bf16 v[108:111], a[12:15], a[108:111], v[108:111]
    ds_read_b128 a[72:75], v26 offset:22528
    s_lshl_b32 s91, s4, 9
    v_mfma_f32_16x16x32_bf16 v[112:115], a[8:11], a[112:115], v[112:115]
    ds_read_b128 a[76:79], v26 offset:32768
    v_mfma_f32_16x16x32_bf16 v[116:119], a[12:15], a[112:115], v[116:119]
    s_add_u32 s91, s91, s84
    buffer_load_dwordx4 a[40:43], v2, s[52:55], s83 offen offset:1024 sc1
    v_mfma_f32_16x16x32_bf16 v[120:123], a[8:11], a[116:119], v[120:123]
    ds_read_b128 a[80:83], v26 offset:24576
    v_mfma_f32_16x16x32_bf16 v[124:127], a[12:15], a[116:119], v[124:127]
    ds_read_b128 a[84:87], v26 offset:34816
    s_add_u32 s91, s91, 16384
    v_mfma_f32_16x16x32_bf16 v[128:131], a[8:11], a[120:123], v[128:131]
    buffer_load_dwordx4 a[44:47], v44, s[52:55], s83 offen offset:1024 sc1
    s_add_u32 s83, s83, 2048
    s_cmp_eq_u32 s83, s85
    s_cselect_b32 s83, s84, s83
    v_mfma_f32_16x16x32_bf16 v[132:135], a[12:15], a[120:123], v[132:135]
    ds_read_b128 a[88:91], v26 offset:26624
    v_lshrrev_b32 v12, 2, v1
    s_waitcnt lgkmcnt(7)
    v_mfma_f32_16x16x32_bf16 v[136:139], a[8:11], a[124:127], v[136:139]
    ds_read_b128 a[92:95], v26 offset:36864
    v_lshrrev_b32 v94, 2, v12
    v_mfma_f32_16x16x32_bf16 v[140:143], a[12:15], a[124:127], v[140:143]
    s_add_u32 m0, s86, 81920
    s_nop 0
    buffer_load_dwordx4 v16, s[56:59], s80 offen offset:0 lds
    v_mfma_f32_16x16x32_bf16 v[144:147], a[8:11], a[128:131], v[144:147]
    ds_read_b128 a[96:99], v26 offset:28672
    v_lshlrev_b32 v94, 3, v94
    v_mfma_f32_16x16x32_bf16 v[148:151], a[12:15], a[128:131], v[148:151]
    ds_read_b128 a[100:103], v26 offset:38912
    v_mfma_f32_16x16x32_bf16 v[152:155], a[8:11], a[132:135], v[152:155]
    v_and_b32 v15, 1, v12
    v_mfma_f32_16x16x32_bf16 v[156:159], a[12:15], a[132:135], v[156:159]
    buffer_load_dwordx4 v17, s[56:59], s80 offen offset:1024 lds
    v_mfma_f32_16x16x32_bf16 v[160:163], a[8:11], a[136:139], v[160:163]
    v_lshl_add_u32 v94, v15, 2, v94
    v_mfma_f32_16x16x32_bf16 v[164:167], a[12:15], a[136:139], v[164:167]
    v_mfma_f32_16x16x32_bf16 v[168:171], a[8:11], a[140:143], v[168:171]
    v_bfe_u32 v15, v12, 1, 1
    buffer_load_dwordx4 v18, s[56:59], s80 offen offset:2048 lds
    s_add_u32 m0, s87, 81920
    v_mfma_f32_16x16x32_bf16 v[172:175], a[12:15], a[140:143], v[172:175]
    s_waitcnt vmcnt(9) lgkmcnt(5)
    v_mfma_f32_16x16x32_bf16 v[96:99], a[16:19], a[64:67], v[96:99]
    ds_read_b128 a[104:107], v27 offset:20480
    v_add_u32 v94, v94, v15
    v_mfma_f32_16x16x32_bf16 v[100:103], a[20:23], a[64:67], v[100:103]
    ds_read_b128 a[108:111], v27 offset:30720
    v_mul_u32_u24 v94, 0x500, v94
    buffer_load_dwordx4 v19, s[60:63], s80 offen offset:0 lds
    v_mfma_f32_16x16x32_bf16 v[104:107], a[16:19], a[68:71], v[104:107]
    v_mfma_f32_16x16x32_bf16 v[108:111], a[20:23], a[68:71], v[108:111]
    ds_read_b128 a[112:115], v27 offset:22528
    v_and_b32 v15, 3, v1
    v_mfma_f32_16x16x32_bf16 v[112:115], a[16:19], a[72:75], v[112:115]
    ds_read_b128 a[116:119], v27 offset:32768
    v_mfma_f32_16x16x32_bf16 v[116:119], a[20:23], a[72:75], v[116:119]
    v_lshl_add_u32 v94, v15, 4, v94
    buffer_load_dwordx4 v20, s[60:63], s80 offen offset:1024 lds
    s_add_u32 s80, s80, 128
    s_cmp_eq_u32 s80, 1280
    s_cselect_b32 s80, 0, s80
    s_add_u32 m0, s86, 102400
    v_mfma_f32_16x16x32_bf16 v[120:123], a[16:19], a[76:79], v[120:123]
    ds_read_b128 a[120:123], v27 offset:24576
    v_mfma_f32_16x16x32_bf16 v[124:127], a[20:23], a[76:79], v[124:127]
    ds_read_b128 a[124:127], v27 offset:34816
    v_bfe_u32 v12, v1, 1, 4
    v_mfma_f32_16x16x32_bf16 v[128:131], a[16:19], a[80:83], v[128:131]
    buffer_load_dwordx4 a[48:51], v2, s[52:55], s83 offen offset:0 sc1
    v_mfma_f32_16x16x32_bf16 v[132:135], a[20:23], a[80:83], v[132:135]
    ds_read_b128 a[128:131], v27 offset:26624
    v_lshrrev_b32 v95, 2, v12
    s_waitcnt lgkmcnt(7)
    v_mfma_f32_16x16x32_bf16 v[136:139], a[16:19], a[84:87], v[136:139]
    ds_read_b128 a[132:135], v27 offset:36864
    v_lshlrev_b32 v95, 3, v95
    v_mfma_f32_16x16x32_bf16 v[140:143], a[20:23], a[84:87], v[140:143]
    buffer_load_dwordx4 a[52:55], v44, s[52:55], s83 offen offset:0 sc1
    v_mfma_f32_16x16x32_bf16 v[144:147], a[16:19], a[88:91], v[144:147]
    ds_read_b128 a[136:139], v27 offset:28672
    v_and_b32 v15, 1, v12
    v_mfma_f32_16x16x32_bf16 v[148:151], a[20:23], a[88:91], v[148:151]
    ds_read_b128 a[140:143], v27 offset:38912
    v_mfma_f32_16x16x32_bf16 v[152:155], a[16:19], a[92:95], v[152:155]
    v_lshl_add_u32 v95, v15, 2, v95
    v_mfma_f32_16x16x32_bf16 v[156:159], a[20:23], a[92:95], v[156:159]
    buffer_load_dwordx4 a[56:59], v2, s[52:55], s83 offen offset:1024 sc1
    v_mfma_f32_16x16x32_bf16 v[160:163], a[16:19], a[96:99], v[160:163]
    v_bfe_u32 v15, v12, 1, 1
    v_mfma_f32_16x16x32_bf16 v[164:167], a[20:23], a[96:99], v[164:167]
    v_mfma_f32_16x16x32_bf16 v[168:171], a[16:19], a[100:103], v[168:171]
    v_add_u32 v95, v95, v15
    buffer_load_dwordx4 a[60:63], v44, s[52:55], s83 offen offset:1024 sc1
    s_add_u32 s83, s83, 2048
    s_cmp_eq_u32 s83, s85
    s_cselect_b32 s83, s84, s83
    v_mfma_f32_16x16x32_bf16 v[172:175], a[20:23], a[100:103], v[172:175]
    s_barrier
    s_waitcnt vmcnt(13) lgkmcnt(5)
    v_mfma_f32_16x16x32_bf16 v[96:99], a[24:27], a[104:107], v[96:99]
    ds_read_b128 a[64:67], v26 offset:40960
    v_mul_u32_u24 v95, 0x500, v95
    v_mfma_f32_16x16x32_bf16 v[100:103], a[28:31], a[104:107], v[100:103]
    ds_read_b128 a[68:71], v26 offset:51200
    buffer_load_dwordx4 v16, s[56:59], s80 offen offset:0 lds
    v_mfma_f32_16x16x32_bf16 v[104:107], a[24:27], a[108:111], v[104:107]
    v_and_b32 v15, 1, v1
    v_mfma_f32_16x16x32_bf16 v[108:111], a[28:31], a[108:111], v[108:111]
    ds_read_b128 a[72:75], v26 offset:43008
    v_mfma_f32_16x16x32_bf16 v[112:115], a[24:27], a[112:115], v[112:115]
    ds_read_b128 a[76:79], v26 offset:53248
    v_lshl_add_u32 v95, v15, 4, v95
    v_mfma_f32_16x16x32_bf16 v[116:119], a[28:31], a[112:115], v[116:119]
    buffer_load_dwordx4 v17, s[56:59], s80 offen offset:1024 lds
    v_mfma_f32_16x16x32_bf16 v[120:123], a[24:27], a[116:119], v[120:123]
    ds_read_b128 a[80:83], v26 offset:45056
    s_lshl_b32 s11, s3, 2
    v_mfma_f32_16x16x32_bf16 v[124:127], a[28:31], a[116:119], v[124:127]
    ds_read_b128 a[84:87], v26 offset:55296
    v_mfma_f32_16x16x32_bf16 v[128:131], a[24:27], a[120:123], v[128:131]
    s_add_u32 s11, s11, s5
    buffer_load_dwordx4 v18, s[56:59], s80 offen offset:2048 lds
    s_add_u32 m0, s87, 102400
    v_mfma_f32_16x16x32_bf16 v[132:135], a[28:31], a[120:123], v[132:135]
    ds_read_b128 a[88:91], v26 offset:47104
    s_waitcnt lgkmcnt(7)
    v_mfma_f32_16x16x32_bf16 v[136:139], a[24:27], a[124:127], v[136:139]
    ds_read_b128 a[92:95], v26 offset:57344
    s_mul_i32 s11, s11, 40960
    v_mfma_f32_16x16x32_bf16 v[140:143], a[28:31], a[124:127], v[140:143]
    buffer_load_dwordx4 v19, s[60:63], s80 offen offset:0 lds
    v_mfma_f32_16x16x32_bf16 v[144:147], a[24:27], a[128:131], v[144:147]
    ds_read_b128 a[96:99], v26 offset:49152
    s_lshl_b32 s96, s4, 7
    v_mfma_f32_16x16x32_bf16 v[148:151], a[28:31], a[128:131], v[148:151]
    ds_read_b128 a[100:103], v26 offset:59392
    v_mfma_f32_16x16x32_bf16 v[152:155], a[24:27], a[132:135], v[152:155]
    s_add_u32 s96, s96, s11
    v_mfma_f32_16x16x32_bf16 v[156:159], a[28:31], a[132:135], v[156:159]
    buffer_load_dwordx4 v20, s[60:63], s80 offen offset:1024 lds
    s_add_u32 s80, s80, 128
    s_cmp_eq_u32 s80, 1280
    s_cselect_b32 s80, 0, s80
    s_add_u32 m0, s86, 122880
    v_mfma_f32_16x16x32_bf16 v[160:163], a[24:27], a[136:139], v[160:163]
    s_lshl_b32 s97, s4, 5
    v_mfma_f32_16x16x32_bf16 v[164:167], a[28:31], a[136:139], v[164:167]
    v_mfma_f32_16x16x32_bf16 v[168:171], a[24:27], a[140:143], v[168:171]
    s_add_u32 s97, s97, s11
    buffer_load_dwordx4 a[0:3], v2, s[52:55], s83 offen offset:0 sc1
    v_mfma_f32_16x16x32_bf16 v[172:175], a[28:31], a[140:143], v[172:175]
    s_waitcnt vmcnt(17) lgkmcnt(5)
    v_mfma_f32_16x16x32_bf16 v[96:99], a[32:35], a[64:67], v[96:99]
    ds_read_b128 a[104:107], v27 offset:40960
    s_add_u32 s97, s97, 1024
    v_mfma_f32_16x16x32_bf16 v[100:103], a[36:39], a[64:67], v[100:103]
    ds_read_b128 a[108:111], v27 offset:51200
    s_mov_b32 s76, s32
    v_mfma_f32_16x16x32_bf16 v[104:107], a[32:35], a[68:71], v[104:107]
    buffer_load_dwordx4 a[4:7], v44, s[52:55], s83 offen offset:0 sc1
    v_mfma_f32_16x16x32_bf16 v[108:111], a[36:39], a[68:71], v[108:111]
    ds_read_b128 a[112:115], v27 offset:43008
    s_mov_b32 s77, s33
    v_mfma_f32_16x16x32_bf16 v[112:115], a[32:35], a[72:75], v[112:115]
    ds_read_b128 a[116:119], v27 offset:53248
    v_mfma_f32_16x16x32_bf16 v[116:119], a[36:39], a[72:75], v[116:119]
    s_mov_b32 s78, 1280
    v_mfma_f32_16x16x32_bf16 v[120:123], a[32:35], a[76:79], v[120:123]
    ds_read_b128 a[120:123], v27 offset:45056
    v_mfma_f32_16x16x32_bf16 v[124:127], a[36:39], a[76:79], v[124:127]
    ds_read_b128 a[124:127], v27 offset:55296
    s_mov_b32 s79, 0x20000
    buffer_load_dwordx4 a[8:11], v2, s[52:55], s83 offen offset:1024 sc1
    v_mfma_f32_16x16x32_bf16 v[128:131], a[32:35], a[80:83], v[128:131]
    v_mfma_f32_16x16x32_bf16 v[132:135], a[36:39], a[80:83], v[132:135]
    ds_read_b128 a[128:131], v27 offset:47104
    v_and_b32 v12, 15, v1
    s_waitcnt lgkmcnt(7)
    v_mfma_f32_16x16x32_bf16 v[136:139], a[32:35], a[84:87], v[136:139]
    ds_read_b128 a[132:135], v27 offset:57344
    v_lshlrev_b32 v12, 1, v12
    v_mfma_f32_16x16x32_bf16 v[140:143], a[36:39], a[84:87], v[140:143]
    v_mfma_f32_16x16x32_bf16 v[144:147], a[32:35], a[88:91], v[144:147]
    ds_read_b128 a[136:139], v27 offset:49152
    s_lshl_b32 s12, s4, 7
    buffer_load_dwordx4 a[12:15], v44, s[52:55], s83 offen offset:1024 sc1
    s_add_u32 s83, s83, 2048
    s_cmp_eq_u32 s83, s85
    s_cselect_b32 s83, s84, s83
    v_mfma_f32_16x16x32_bf16 v[148:151], a[36:39], a[88:91], v[148:151]
    ds_read_b128 a[140:143], v27 offset:59392
    v_mfma_f32_16x16x32_bf16 v[152:155], a[32:35], a[92:95], v[152:155]
    s_lshl_b32 s13, s4, 5
    v_mfma_f32_16x16x32_bf16 v[156:159], a[36:39], a[92:95], v[156:159]
    v_mfma_f32_16x16x32_bf16 v[160:163], a[32:35], a[96:99], v[160:163]
    s_add_u32 s13, s13, 1024
    v_mfma_f32_16x16x32_bf16 v[164:167], a[36:39], a[96:99], v[164:167]
    buffer_load_dwordx4 v16, s[56:59], s80 offen offset:0 lds
    v_mfma_f32_16x16x32_bf16 v[168:171], a[32:35], a[100:103], v[168:171]
    buffer_load_ushort v250, v12, s[76:79], s12 offen offset:0
    v_mfma_f32_16x16x32_bf16 v[172:175], a[36:39], a[100:103], v[172:175]
    s_barrier
    s_waitcnt vmcnt(20) lgkmcnt(5)
    v_mfma_f32_16x16x32_bf16 v[96:99], a[40:43], a[104:107], v[96:99]
    ds_read_b128 a[64:67], v28 offset:0
    buffer_load_ushort v251, v12, s[76:79], s12 offen offset:32
    v_mfma_f32_16x16x32_bf16 v[100:103], a[44:47], a[104:107], v[100:103]
    ds_read_b128 a[68:71], v28 offset:10240
    buffer_load_ushort v252, v12, s[76:79], s12 offen offset:64
    v_mfma_f32_16x16x32_bf16 v[104:107], a[40:43], a[108:111], v[104:107]
    v_mfma_f32_16x16x32_bf16 v[108:111], a[44:47], a[108:111], v[108:111]
    ds_read_b128 a[72:75], v28 offset:2048
    buffer_load_ushort v253, v12, s[76:79], s12 offen offset:96
    v_mfma_f32_16x16x32_bf16 v[112:115], a[40:43], a[112:115], v[112:115]
    ds_read_b128 a[76:79], v28 offset:12288
    v_mfma_f32_16x16x32_bf16 v[116:119], a[44:47], a[112:115], v[116:119]
    buffer_load_ushort v254, v12, s[76:79], s13 offen offset:0
    buffer_load_dwordx4 v17, s[56:59], s80 offen offset:1024 lds
    v_mfma_f32_16x16x32_bf16 v[120:123], a[40:43], a[116:119], v[120:123]
    ds_read_b128 a[80:83], v28 offset:4096
    v_mfma_f32_16x16x32_bf16 v[124:127], a[44:47], a[116:119], v[124:127]
    ds_read_b128 a[84:87], v28 offset:14336
    v_and_b32 v12, 15, v1
    v_mfma_f32_16x16x32_bf16 v[128:131], a[40:43], a[120:123], v[128:131]
    v_mfma_f32_16x16x32_bf16 v[132:135], a[44:47], a[120:123], v[132:135]
    ds_read_b128 a[88:91], v28 offset:6144
    v_lshrrev_b32 v13, 4, v1
    s_waitcnt lgkmcnt(7)
    v_mfma_f32_16x16x32_bf16 v[136:139], a[40:43], a[124:127], v[136:139]
    ds_read_b128 a[92:95], v28 offset:16384
    v_lshrrev_b32 v14, 3, v12
    v_mfma_f32_16x16x32_bf16 v[140:143], a[44:47], a[124:127], v[140:143]
    v_mfma_f32_16x16x32_bf16 v[144:147], a[40:43], a[128:131], v[144:147]
    ds_read_b128 a[96:99], v28 offset:8192
    v_lshlrev_b32 v14, 2, v14
    v_mfma_f32_16x16x32_bf16 v[148:151], a[44:47], a[128:131], v[148:151]
    ds_read_b128 a[100:103], v28 offset:18432
    v_mfma_f32_16x16x32_bf16 v[152:155], a[40:43], a[132:135], v[152:155]
    v_xor_b32 v14, v14, v12
    v_mfma_f32_16x16x32_bf16 v[156:159], a[44:47], a[132:135], v[156:159]
    buffer_load_dwordx4 v18, s[56:59], s80 offen offset:2048 lds
    s_add_u32 m0, s87, 122880
    v_mfma_f32_16x16x32_bf16 v[160:163], a[40:43], a[136:139], v[160:163]
    v_lshlrev_b32 v14, 5, v14
    v_mfma_f32_16x16x32_bf16 v[164:167], a[44:47], a[136:139], v[164:167]
    v_mfma_f32_16x16x32_bf16 v[168:171], a[40:43], a[140:143], v[168:171]
    v_lshrrev_b32 v15, 2, v12
    v_mfma_f32_16x16x32_bf16 v[172:175], a[44:47], a[140:143], v[172:175]
    s_waitcnt vmcnt(19) lgkmcnt(5)
    v_mfma_f32_16x16x32_bf16 v[96:99], a[48:51], a[64:67], v[96:99]
    ds_read_b128 a[104:107], v29 offset:0
    v_xor_b32 v15, v15, v13
    v_mfma_f32_16x16x32_bf16 v[100:103], a[52:55], a[64:67], v[100:103]
    ds_read_b128 a[108:111], v29 offset:10240
    buffer_load_dwordx4 v19, s[60:63], s80 offen offset:0 lds
    v_mfma_f32_16x16x32_bf16 v[104:107], a[48:51], a[68:71], v[104:107]
    v_lshl_add_u32 v14, v15, 3, v14
    v_mfma_f32_16x16x32_bf16 v[108:111], a[52:55], a[68:71], v[108:111]
    ds_read_b128 a[112:115], v29 offset:2048
    v_mfma_f32_16x16x32_bf16 v[112:115], a[48:51], a[72:75], v[112:115]
    ds_read_b128 a[116:119], v29 offset:12288
    s_lshl_b32 s11, s5, 11
    v_mfma_f32_16x16x32_bf16 v[116:119], a[52:55], a[72:75], v[116:119]
    buffer_load_dwordx4 v20, s[60:63], s80 offen offset:1024 lds
    s_add_u32 s80, s80, 128
    s_cmp_eq_u32 s80, 1280
    s_cselect_b32 s80, 0, s80
    s_add_u32 m0, s86, 0
    v_mfma_f32_16x16x32_bf16 v[120:123], a[48:51], a[76:79], v[120:123]
    ds_read_b128 a[120:123], v29 offset:4096
    s_add_u32 s11, s11, 155648
    v_mfma_f32_16x16x32_bf16 v[124:127], a[52:55], a[76:79], v[124:127]
    ds_read_b128 a[124:127], v29 offset:14336
    v_mfma_f32_16x16x32_bf16 v[128:131], a[48:51], a[80:83], v[128:131]
    v_add_u32 v7, s11, v14
    buffer_load_dwordx4 a[16:19], v2, s[52:55], s83 offen offset:0 sc1
    v_mfma_f32_16x16x32_bf16 v[132:135], a[52:55], a[80:83], v[132:135]
    ds_read_b128 a[128:131], v29 offset:6144
    s_waitcnt lgkmcnt(7)
    v_mfma_f32_16x16x32_bf16 v[136:139], a[48:51], a[84:87], v[136:139]
    ds_read_b128 a[132:135], v29 offset:16384
    v_and_b32 v14, 1, v13
    v_mfma_f32_16x16x32_bf16 v[140:143], a[52:55], a[84:87], v[140:143]
    buffer_load_dwordx4 a[20:23], v44, s[52:55], s83 offen offset:0 sc1
    v_mfma_f32_16x16x32_bf16 v[144:147], a[48:51], a[88:91], v[144:147]
    ds_read_b128 a[136:139], v29 offset:8192
    v_xor_b32 v14, 0, v14
    v_mfma_f32_16x16x32_bf16 v[148:151], a[52:55], a[88:91], v[148:151]
    ds_read_b128 a[140:143], v29 offset:18432
    v_mfma_f32_16x16x32_bf16 v[152:155], a[48:51], a[92:95], v[152:155]
    v_lshlrev_b32 v14, 2, v14
    v_mfma_f32_16x16x32_bf16 v[156:159], a[52:55], a[92:95], v[156:159]
    buffer_load_dwordx4 a[24:27], v2, s[52:55], s83 offen offset:1024 sc1
    v_mfma_f32_16x16x32_bf16 v[160:163], a[48:51], a[96:99], v[160:163]
    v_lshl_add_u32 v14, v13, 3, v14
    v_mfma_f32_16x16x32_bf16 v[164:167], a[52:55], a[96:99], v[164:167]
    v_mfma_f32_16x16x32_bf16 v[168:171], a[48:51], a[100:103], v[168:171]
    v_bfe_u32 v15, v1, 2, 2
    buffer_load_dwordx4 a[28:31], v44, s[52:55], s83 offen offset:1024 sc1
    s_add_u32 s83, s83, 2048
    s_cmp_eq_u32 s83, s85
    s_cselect_b32 s83, s84, s83
    v_mfma_f32_16x16x32_bf16 v[172:175], a[52:55], a[100:103], v[172:175]
    s_barrier
    s_waitcnt vmcnt(23) lgkmcnt(5)
    v_mfma_f32_16x16x32_bf16 v[96:99], a[56:59], a[104:107], v[96:99]
    ds_read_b128 a[64:67], v28 offset:20480
    v_add_u32 v14, v14, v15
    v_mfma_f32_16x16x32_bf16 v[100:103], a[60:63], a[104:107], v[100:103]
    ds_read_b128 a[68:71], v28 offset:30720
    v_lshlrev_b32 v14, 5, v14
    buffer_load_dwordx4 v16, s[56:59], s80 offen offset:0 lds
    v_mfma_f32_16x16x32_bf16 v[104:107], a[56:59], a[108:111], v[104:107]
    v_mfma_f32_16x16x32_bf16 v[108:111], a[60:63], a[108:111], v[108:111]
    ds_read_b128 a[72:75], v28 offset:22528
    v_lshlrev_b32 v15, 1, v13
    v_mfma_f32_16x16x32_bf16 v[112:115], a[56:59], a[112:115], v[112:115]
    ds_read_b128 a[76:79], v28 offset:32768
    v_mfma_f32_16x16x32_bf16 v[116:119], a[60:63], a[112:115], v[116:119]
    v_add_u32 v15, 0, v15
    buffer_load_dwordx4 v17, s[56:59], s80 offen offset:1024 lds
    v_mfma_f32_16x16x32_bf16 v[120:123], a[56:59], a[116:119], v[120:123]
    ds_read_b128 a[80:83], v28 offset:24576
    v_mfma_f32_16x16x32_bf16 v[124:127], a[60:63], a[116:119], v[124:127]
    ds_read_b128 a[84:87], v28 offset:34816
    v_xor_b32 v15, v15, v1
    v_mfma_f32_16x16x32_bf16 v[128:131], a[56:59], a[120:123], v[128:131]
    buffer_load_dwordx4 v18, s[56:59], s80 offen offset:2048 lds
    s_add_u32 m0, s87, 0
    v_mfma_f32_16x16x32_bf16 v[132:135], a[60:63], a[120:123], v[132:135]
    ds_read_b128 a[88:91], v28 offset:26624
    v_and_b32 v15, 3, v15
    s_waitcnt lgkmcnt(7)
    v_mfma_f32_16x16x32_bf16 v[136:139], a[56:59], a[124:127], v[136:139]
    ds_read_b128 a[92:95], v28 offset:36864
    v_lshl_add_u32 v14, v15, 3, v14
    v_mfma_f32_16x16x32_bf16 v[140:143], a[60:63], a[124:127], v[140:143]
    buffer_load_dwordx4 v19, s[60:63], s80 offen offset:0 lds
    v_mfma_f32_16x16x32_bf16 v[144:147], a[56:59], a[128:131], v[144:147]
    ds_read_b128 a[96:99], v28 offset:28672
    v_add_u32 v8, s11, v14
    v_mfma_f32_16x16x32_bf16 v[148:151], a[60:63], a[128:131], v[148:151]
    ds_read_b128 a[100:103], v28 offset:38912
    v_mfma_f32_16x16x32_bf16 v[152:155], a[56:59], a[132:135], v[152:155]
    v_and_b32 v14, 1, v13
    v_mfma_f32_16x16x32_bf16 v[156:159], a[60:63], a[132:135], v[156:159]
    buffer_load_dwordx4 v20, s[60:63], s80 offen offset:1024 lds
    s_add_u32 s80, s80, 128
    s_cmp_eq_u32 s80, 1280
    s_cselect_b32 s80, 0, s80
    s_add_u32 m0, s86, 20480
    v_mfma_f32_16x16x32_bf16 v[160:163], a[56:59], a[136:139], v[160:163]
    v_xor_b32 v14, 1, v14
    v_mfma_f32_16x16x32_bf16 v[164:167], a[60:63], a[136:139], v[164:167]
    v_mfma_f32_16x16x32_bf16 v[168:171], a[56:59], a[140:143], v[168:171]
    v_lshlrev_b32 v14, 2, v14
    buffer_load_dwordx4 a[32:35], v2, s[52:55], s83 offen offset:0 sc1
    v_mfma_f32_16x16x32_bf16 v[172:175], a[60:63], a[140:143], v[172:175]
    s_waitcnt vmcnt(22) lgkmcnt(5)
    v_mfma_f32_16x16x32_bf16 v[96:99], a[0:3], a[64:67], v[96:99]
    ds_read_b128 a[104:107], v29 offset:20480
    v_lshl_add_u32 v14, v13, 3, v14
    v_mfma_f32_16x16x32_bf16 v[100:103], a[4:7], a[64:67], v[100:103]
    ds_read_b128 a[108:111], v29 offset:30720
    v_mfma_f32_16x16x32_bf16 v[104:107], a[0:3], a[68:71], v[104:107]
    v_bfe_u32 v15, v1, 2, 2
    buffer_load_dwordx4 a[36:39], v44, s[52:55], s83 offen offset:0 sc1
    v_mfma_f32_16x16x32_bf16 v[108:111], a[4:7], a[68:71], v[108:111]
    ds_read_b128 a[112:115], v29 offset:22528
    v_mfma_f32_16x16x32_bf16 v[112:115], a[0:3], a[72:75], v[112:115]
    ds_read_b128 a[116:119], v29 offset:32768
    v_add_u32 v14, v14, v15
    v_mfma_f32_16x16x32_bf16 v[116:119], a[4:7], a[72:75], v[116:119]
    v_mfma_f32_16x16x32_bf16 v[120:123], a[0:3], a[76:79], v[120:123]
    ds_read_b128 a[120:123], v29 offset:24576
    v_lshlrev_b32 v14, 5, v14
    buffer_load_dwordx4 a[40:43], v2, s[52:55], s83 offen offset:1024 sc1
    v_mfma_f32_16x16x32_bf16 v[124:127], a[4:7], a[76:79], v[124:127]
    ds_read_b128 a[124:127], v29 offset:34816
    v_mfma_f32_16x16x32_bf16 v[128:131], a[0:3], a[80:83], v[128:131]
    v_lshlrev_b32 v15, 1, v13
    v_mfma_f32_16x16x32_bf16 v[132:135], a[4:7], a[80:83], v[132:135]
    ds_read_b128 a[128:131], v29 offset:26624
    s_waitcnt lgkmcnt(7)
    v_mfma_f32_16x16x32_bf16 v[136:139], a[0:3], a[84:87], v[136:139]
    ds_read_b128 a[132:135], v29 offset:36864
    v_add_u32 v15, 1, v15
    buffer_load_dwordx4 a[44:47], v44, s[52:55], s83 offen offset:1024 sc1
    s_add_u32 s83, s83, 2048
    s_cmp_eq_u32 s83, s85
    s_cselect_b32 s83, s84, s83
    v_mfma_f32_16x16x32_bf16 v[140:143], a[4:7], a[84:87], v[140:143]
    v_mfma_f32_16x16x32_bf16 v[144:147], a[0:3], a[88:91], v[144:147]
    ds_read_b128 a[136:139], v29 offset:28672
    v_xor_b32 v15, v15, v1
    v_mfma_f32_16x16x32_bf16 v[148:151], a[4:7], a[88:91], v[148:151]
    ds_read_b128 a[140:143], v29 offset:38912
    v_mfma_f32_16x16x32_bf16 v[152:155], a[0:3], a[92:95], v[152:155]
    v_and_b32 v15, 3, v15
    buffer_load_dwordx4 v16, s[56:59], s80 offen offset:0 lds
    v_mfma_f32_16x16x32_bf16 v[156:159], a[4:7], a[92:95], v[156:159]
    v_mfma_f32_16x16x32_bf16 v[160:163], a[0:3], a[96:99], v[160:163]
    v_lshl_add_u32 v14, v15, 3, v14
    v_mfma_f32_16x16x32_bf16 v[164:167], a[4:7], a[96:99], v[164:167]
    v_mfma_f32_16x16x32_bf16 v[168:171], a[0:3], a[100:103], v[168:171]
    v_add_u32 v9, s11, v14
    buffer_load_dwordx4 v17, s[56:59], s80 offen offset:1024 lds
    v_mfma_f32_16x16x32_bf16 v[172:175], a[4:7], a[100:103], v[172:175]
    s_barrier
    s_waitcnt vmcnt(25) lgkmcnt(5)
    v_mfma_f32_16x16x32_bf16 v[96:99], a[8:11], a[104:107], v[96:99]
    ds_read_b128 a[64:67], v28 offset:40960
    v_mfma_f32_16x16x32_bf16 v[100:103], a[12:15], a[104:107], v[100:103]
    ds_read_b128 a[68:71], v28 offset:51200
    buffer_load_dwordx4 v18, s[56:59], s80 offen offset:2048 lds
    s_add_u32 m0, s87, 20480
    v_mfma_f32_16x16x32_bf16 v[104:107], a[8:11], a[108:111], v[104:107]
    v_mfma_f32_16x16x32_bf16 v[108:111], a[12:15], a[108:111], v[108:111]
    ds_read_b128 a[72:75], v28 offset:43008
    v_mfma_f32_16x16x32_bf16 v[112:115], a[8:11], a[112:115], v[112:115]
    ds_read_b128 a[76:79], v28 offset:53248
    v_mfma_f32_16x16x32_bf16 v[116:119], a[12:15], a[112:115], v[116:119]
    buffer_load_dwordx4 v19, s[60:63], s80 offen offset:0 lds
    v_mfma_f32_16x16x32_bf16 v[120:123], a[8:11], a[116:119], v[120:123]
    ds_read_b128 a[80:83], v28 offset:45056
    v_mfma_f32_16x16x32_bf16 v[124:127], a[12:15], a[116:119], v[124:127]
    ds_read_b128 a[84:87], v28 offset:55296
    v_mfma_f32_16x16x32_bf16 v[128:131], a[8:11], a[120:123], v[128:131]
    buffer_load_dwordx4 v20, s[60:63], s80 offen offset:1024 lds
    s_add_u32 s80, s80, 128
    s_cmp_eq_u32 s80, 1280
    s_cselect_b32 s80, 0, s80
    s_add_u32 m0, s86, 40960
    v_mfma_f32_16x16x32_bf16 v[132:135], a[12:15], a[120:123], v[132:135]
    ds_read_b128 a[88:91], v28 offset:47104
    s_waitcnt lgkmcnt(7)
    v_mfma_f32_16x16x32_bf16 v[136:139], a[8:11], a[124:127], v[136:139]
    ds_read_b128 a[92:95], v28 offset:57344
    v_mfma_f32_16x16x32_bf16 v[140:143], a[12:15], a[124:127], v[140:143]
    buffer_load_dwordx4 a[48:51], v2, s[52:55], s83 offen offset:0 sc1
    v_mfma_f32_16x16x32_bf16 v[144:147], a[8:11], a[128:131], v[144:147]
    ds_read_b128 a[96:99], v28 offset:49152
    v_mfma_f32_16x16x32_bf16 v[148:151], a[12:15], a[128:131], v[148:151]
    ds_read_b128 a[100:103], v28 offset:59392
    v_mfma_f32_16x16x32_bf16 v[152:155], a[8:11], a[132:135], v[152:155]
    v_mfma_f32_16x16x32_bf16 v[156:159], a[12:15], a[132:135], v[156:159]
    buffer_load_dwordx4 a[52:55], v44, s[52:55], s83 offen offset:0 sc1
    v_mfma_f32_16x16x32_bf16 v[160:163], a[8:11], a[136:139], v[160:163]
    v_mfma_f32_16x16x32_bf16 v[164:167], a[12:15], a[136:139], v[164:167]
    v_mfma_f32_16x16x32_bf16 v[168:171], a[8:11], a[140:143], v[168:171]
    buffer_load_dwordx4 a[56:59], v2, s[52:55], s83 offen offset:1024 sc1
    v_mfma_f32_16x16x32_bf16 v[172:175], a[12:15], a[140:143], v[172:175]
    s_waitcnt vmcnt(19) lgkmcnt(5)
    v_mfma_f32_16x16x32_bf16 v[96:99], a[16:19], a[64:67], v[96:99]
    ds_read_b128 a[104:107], v29 offset:40960
    v_mfma_f32_16x16x32_bf16 v[100:103], a[20:23], a[64:67], v[100:103]
    ds_read_b128 a[108:111], v29 offset:51200
    buffer_load_dwordx4 a[60:63], v44, s[52:55], s83 offen offset:1024 sc1
    s_add_u32 s83, s83, 2048
    s_cmp_eq_u32 s83, s85
    s_cselect_b32 s83, s84, s83
    v_mfma_f32_16x16x32_bf16 v[104:107], a[16:19], a[68:71], v[104:107]
    v_mfma_f32_16x16x32_bf16 v[108:111], a[20:23], a[68:71], v[108:111]
    ds_read_b128 a[112:115], v29 offset:43008
    v_mfma_f32_16x16x32_bf16 v[112:115], a[16:19], a[72:75], v[112:115]
    ds_read_b128 a[116:119], v29 offset:53248
    v_mfma_f32_16x16x32_bf16 v[116:119], a[20:23], a[72:75], v[116:119]
    buffer_load_dwordx4 v16, s[56:59], s80 offen offset:0 lds
    v_mfma_f32_16x16x32_bf16 v[120:123], a[16:19], a[76:79], v[120:123]
    ds_read_b128 a[120:123], v29 offset:45056
    v_mfma_f32_16x16x32_bf16 v[124:127], a[20:23], a[76:79], v[124:127]
    ds_read_b128 a[124:127], v29 offset:55296
    v_mfma_f32_16x16x32_bf16 v[128:131], a[16:19], a[80:83], v[128:131]
    buffer_load_dwordx4 v17, s[56:59], s80 offen offset:1024 lds
    v_mfma_f32_16x16x32_bf16 v[132:135], a[20:23], a[80:83], v[132:135]
    ds_read_b128 a[128:131], v29 offset:47104
    s_waitcnt lgkmcnt(7)
    v_mfma_f32_16x16x32_bf16 v[136:139], a[16:19], a[84:87], v[136:139]
    ds_read_b128 a[132:135], v29 offset:57344
    v_mfma_f32_16x16x32_bf16 v[140:143], a[20:23], a[84:87], v[140:143]
    buffer_load_dwordx4 v18, s[56:59], s80 offen offset:2048 lds
    s_add_u32 m0, s87, 40960
    v_mfma_f32_16x16x32_bf16 v[144:147], a[16:19], a[88:91], v[144:147]
    ds_read_b128 a[136:139], v29 offset:49152
    v_mfma_f32_16x16x32_bf16 v[148:151], a[20:23], a[88:91], v[148:151]
    ds_read_b128 a[140:143], v29 offset:59392
    v_mfma_f32_16x16x32_bf16 v[152:155], a[16:19], a[92:95], v[152:155]
    v_mfma_f32_16x16x32_bf16 v[156:159], a[20:23], a[92:95], v[156:159]
    buffer_load_dwordx4 v19, s[60:63], s80 offen offset:0 lds
    v_mfma_f32_16x16x32_bf16 v[160:163], a[16:19], a[96:99], v[160:163]
    v_mfma_f32_16x16x32_bf16 v[164:167], a[20:23], a[96:99], v[164:167]
    v_mfma_f32_16x16x32_bf16 v[168:171], a[16:19], a[100:103], v[168:171]
    buffer_load_dwordx4 v20, s[60:63], s80 offen offset:1024 lds
    s_add_u32 s80, s80, 128
    s_cmp_eq_u32 s80, 1280
    s_cselect_b32 s80, 0, s80
    s_add_u32 m0, s86, 61440
    v_mfma_f32_16x16x32_bf16 v[172:175], a[20:23], a[100:103], v[172:175]
    s_barrier
    s_waitcnt vmcnt(23) lgkmcnt(5)
    v_mfma_f32_16x16x32_bf16 v[96:99], a[24:27], a[104:107], v[96:99]
    ds_read_b128 a[64:67], v30 offset:0
    v_mfma_f32_16x16x32_bf16 v[100:103], a[28:31], a[104:107], v[100:103]
    ds_read_b128 a[68:71], v30 offset:10240
    buffer_load_dwordx4 a[0:3], v2, s[52:55], s83 offen offset:0 sc1
    v_mfma_f32_16x16x32_bf16 v[104:107], a[24:27], a[108:111], v[104:107]
    v_mfma_f32_16x16x32_bf16 v[108:111], a[28:31], a[108:111], v[108:111]
    ds_read_b128 a[72:75], v30 offset:2048
    v_mfma_f32_16x16x32_bf16 v[112:115], a[24:27], a[112:115], v[112:115]
    ds_read_b128 a[76:79], v30 offset:12288
    v_mfma_f32_16x16x32_bf16 v[116:119], a[28:31], a[112:115], v[116:119]
    buffer_load_dwordx4 a[4:7], v44, s[52:55], s83 offen offset:0 sc1
    v_mfma_f32_16x16x32_bf16 v[120:123], a[24:27], a[116:119], v[120:123]
    ds_read_b128 a[80:83], v30 offset:4096
    v_mfma_f32_16x16x32_bf16 v[124:127], a[28:31], a[116:119], v[124:127]
    ds_read_b128 a[84:87], v30 offset:14336
    v_mfma_f32_16x16x32_bf16 v[128:131], a[24:27], a[120:123], v[128:131]
    buffer_load_dwordx4 a[8:11], v2, s[52:55], s83 offen offset:1024 sc1
    v_mfma_f32_16x16x32_bf16 v[132:135], a[28:31], a[120:123], v[132:135]
    ds_read_b128 a[88:91], v30 offset:6144
    s_waitcnt lgkmcnt(7)
    v_mfma_f32_16x16x32_bf16 v[136:139], a[24:27], a[124:127], v[136:139]
    ds_read_b128 a[92:95], v30 offset:16384
    v_mfma_f32_16x16x32_bf16 v[140:143], a[28:31], a[124:127], v[140:143]
    buffer_load_dwordx4 a[12:15], v44, s[52:55], s83 offen offset:1024 sc1
    s_add_u32 s83, s83, 2048
    s_cmp_eq_u32 s83, s85
    s_cselect_b32 s83, s84, s83
    v_mfma_f32_16x16x32_bf16 v[144:147], a[24:27], a[128:131], v[144:147]
    ds_read_b128 a[96:99], v30 offset:8192
    v_mfma_f32_16x16x32_bf16 v[148:151], a[28:31], a[128:131], v[148:151]
    ds_read_b128 a[100:103], v30 offset:18432
    v_mfma_f32_16x16x32_bf16 v[152:155], a[24:27], a[132:135], v[152:155]
    v_mfma_f32_16x16x32_bf16 v[156:159], a[28:31], a[132:135], v[156:159]
    buffer_load_dwordx4 a[16:19], v2, s[52:55], s83 offen offset:0 sc1
    v_mfma_f32_16x16x32_bf16 v[160:163], a[24:27], a[136:139], v[160:163]
    v_mfma_f32_16x16x32_bf16 v[164:167], a[28:31], a[136:139], v[164:167]
    v_mfma_f32_16x16x32_bf16 v[168:171], a[24:27], a[140:143], v[168:171]
    buffer_load_dwordx4 a[20:23], v44, s[52:55], s83 offen offset:0 sc1
    v_mfma_f32_16x16x32_bf16 v[172:175], a[28:31], a[140:143], v[172:175]
    s_waitcnt vmcnt(22) lgkmcnt(5)
    v_mfma_f32_16x16x32_bf16 v[96:99], a[32:35], a[64:67], v[96:99]
    ds_read_b128 a[104:107], v31 offset:0
    v_mfma_f32_16x16x32_bf16 v[100:103], a[36:39], a[64:67], v[100:103]
    ds_read_b128 a[108:111], v31 offset:10240
    v_mfma_f32_16x16x32_bf16 v[104:107], a[32:35], a[68:71], v[104:107]
    buffer_load_dwordx4 v21, s[64:67], s81 offen offset:0 lds
    v_mfma_f32_16x16x32_bf16 v[108:111], a[36:39], a[68:71], v[108:111]
    ds_read_b128 a[112:115], v31 offset:2048
    v_mfma_f32_16x16x32_bf16 v[112:115], a[32:35], a[72:75], v[112:115]
    ds_read_b128 a[116:119], v31 offset:12288
    v_mfma_f32_16x16x32_bf16 v[116:119], a[36:39], a[72:75], v[116:119]
    v_mfma_f32_16x16x32_bf16 v[120:123], a[32:35], a[76:79], v[120:123]
    ds_read_b128 a[120:123], v31 offset:4096
    buffer_load_dwordx4 v22, s[64:67], s81 offen offset:1024 lds
    v_mfma_f32_16x16x32_bf16 v[124:127], a[36:39], a[76:79], v[124:127]
    ds_read_b128 a[124:127], v31 offset:14336
    v_mfma_f32_16x16x32_bf16 v[128:131], a[32:35], a[80:83], v[128:131]
    v_mfma_f32_16x16x32_bf16 v[132:135], a[36:39], a[80:83], v[132:135]
    ds_read_b128 a[128:131], v31 offset:6144
    s_waitcnt lgkmcnt(7)
    v_mfma_f32_16x16x32_bf16 v[136:139], a[32:35], a[84:87], v[136:139]
    ds_read_b128 a[132:135], v31 offset:16384
    buffer_load_dwordx4 v23, s[64:67], s81 offen offset:2048 lds
    s_add_u32 m0, s87, 61440
    v_mfma_f32_16x16x32_bf16 v[140:143], a[36:39], a[84:87], v[140:143]
    v_mfma_f32_16x16x32_bf16 v[144:147], a[32:35], a[88:91], v[144:147]
    ds_read_b128 a[136:139], v31 offset:8192
    v_mfma_f32_16x16x32_bf16 v[148:151], a[36:39], a[88:91], v[148:151]
    ds_read_b128 a[140:143], v31 offset:18432
    v_mfma_f32_16x16x32_bf16 v[152:155], a[32:35], a[92:95], v[152:155]
    buffer_load_dwordx4 v24, s[68:71], s81 offen offset:0 lds
    v_mfma_f32_16x16x32_bf16 v[156:159], a[36:39], a[92:95], v[156:159]
    v_mfma_f32_16x16x32_bf16 v[160:163], a[32:35], a[96:99], v[160:163]
    v_mfma_f32_16x16x32_bf16 v[164:167], a[36:39], a[96:99], v[164:167]
    v_mfma_f32_16x16x32_bf16 v[168:171], a[32:35], a[100:103], v[168:171]
    buffer_load_dwordx4 v25, s[68:71], s81 offen offset:1024 lds
    s_add_u32 s81, s81, 128
    s_cmp_eq_u32 s81, 1280
    s_cselect_b32 s81, 0, s81
    s_add_u32 m0, s86, 81920
    v_mfma_f32_16x16x32_bf16 v[172:175], a[36:39], a[100:103], v[172:175]
    s_barrier
    s_waitcnt vmcnt(25) lgkmcnt(5)
    v_mfma_f32_16x16x32_bf16 v[96:99], a[40:43], a[104:107], v[96:99]
    ds_read_b128 a[64:67], v26 offset:0
    v_mfma_f32_16x16x32_bf16 v[100:103], a[44:47], a[104:107], v[100:103]
    ds_read_b128 a[68:71], v26 offset:10240
    v_mfma_f32_16x16x32_bf16 v[104:107], a[40:43], a[108:111], v[104:107]
    v_mfma_f32_16x16x32_bf16 v[108:111], a[44:47], a[108:111], v[108:111]
    ds_read_b128 a[72:75], v26 offset:2048
    v_mfma_f32_16x16x32_bf16 v[112:115], a[40:43], a[112:115], v[112:115]
    ds_read_b128 a[76:79], v26 offset:12288
    v_mfma_f32_16x16x32_bf16 v[116:119], a[44:47], a[112:115], v[116:119]
    buffer_load_dwordx4 a[24:27], v2, s[52:55], s83 offen offset:1024 sc1
    v_mfma_f32_16x16x32_bf16 v[120:123], a[40:43], a[116:119], v[120:123]
    ds_read_b128 a[80:83], v26 offset:4096
    v_mfma_f32_16x16x32_bf16 v[124:127], a[44:47], a[116:119], v[124:127]
    ds_read_b128 a[84:87], v26 offset:14336
    v_mfma_f32_16x16x32_bf16 v[128:131], a[40:43], a[120:123], v[128:131]
    v_mfma_f32_16x16x32_bf16 v[132:135], a[44:47], a[120:123], v[132:135]
    ds_read_b128 a[88:91], v26 offset:6144
    s_waitcnt lgkmcnt(7)
    v_mfma_f32_16x16x32_bf16 v[136:139], a[40:43], a[124:127], v[136:139]
    ds_read_b128 a[92:95], v26 offset:16384
    v_mfma_f32_16x16x32_bf16 v[140:143], a[44:47], a[124:127], v[140:143]
    v_mfma_f32_16x16x32_bf16 v[144:147], a[40:43], a[128:131], v[144:147]
    ds_read_b128 a[96:99], v26 offset:8192
    v_mfma_f32_16x16x32_bf16 v[148:151], a[44:47], a[128:131], v[148:151]
    ds_read_b128 a[100:103], v26 offset:18432
    v_mfma_f32_16x16x32_bf16 v[152:155], a[40:43], a[132:135], v[152:155]
    v_mfma_f32_16x16x32_bf16 v[156:159], a[44:47], a[132:135], v[156:159]
    buffer_load_dwordx4 a[28:31], v44, s[52:55], s83 offen offset:1024 sc1
    s_add_u32 s83, s83, 2048
    s_cmp_eq_u32 s83, s85
    s_cselect_b32 s83, s84, s83
    v_mfma_f32_16x16x32_bf16 v[160:163], a[40:43], a[136:139], v[160:163]
    v_mfma_f32_16x16x32_bf16 v[164:167], a[44:47], a[136:139], v[164:167]
    v_mfma_f32_16x16x32_bf16 v[168:171], a[40:43], a[140:143], v[168:171]
    v_mfma_f32_16x16x32_bf16 v[172:175], a[44:47], a[140:143], v[172:175]
    s_waitcnt vmcnt(20) lgkmcnt(5)
    v_mfma_f32_16x16x32_bf16 v[96:99], a[48:51], a[64:67], v[96:99]
    ds_read_b128 a[104:107], v27 offset:0
    v_mfma_f32_16x16x32_bf16 v[100:103], a[52:55], a[64:67], v[100:103]
    ds_read_b128 a[108:111], v27 offset:10240
    v_mfma_f32_16x16x32_bf16 v[104:107], a[48:51], a[68:71], v[104:107]
    v_mfma_f32_16x16x32_bf16 v[108:111], a[52:55], a[68:71], v[108:111]
    ds_read_b128 a[112:115], v27 offset:2048
    v_mfma_f32_16x16x32_bf16 v[112:115], a[48:51], a[72:75], v[112:115]
    ds_read_b128 a[116:119], v27 offset:12288
    v_mfma_f32_16x16x32_bf16 v[116:119], a[52:55], a[72:75], v[116:119]
    buffer_load_dwordx4 a[144:147], v2, s[52:55], s90 offen offset:0 sc1
    v_mfma_f32_16x16x32_bf16 v[120:123], a[48:51], a[76:79], v[120:123]
    ds_read_b128 a[120:123], v27 offset:4096
    v_mfma_f32_16x16x32_bf16 v[124:127], a[52:55], a[76:79], v[124:127]
    ds_read_b128 a[124:127], v27 offset:14336
    v_mfma_f32_16x16x32_bf16 v[128:131], a[48:51], a[80:83], v[128:131]
    v_mfma_f32_16x16x32_bf16 v[132:135], a[52:55], a[80:83], v[132:135]
    ds_read_b128 a[128:131], v27 offset:6144
    s_waitcnt lgkmcnt(7)
    v_mfma_f32_16x16x32_bf16 v[136:139], a[48:51], a[84:87], v[136:139]
    ds_read_b128 a[132:135], v27 offset:16384
    v_mfma_f32_16x16x32_bf16 v[140:143], a[52:55], a[84:87], v[140:143]
    v_mfma_f32_16x16x32_bf16 v[144:147], a[48:51], a[88:91], v[144:147]
    ds_read_b128 a[136:139], v27 offset:8192
    v_mfma_f32_16x16x32_bf16 v[148:151], a[52:55], a[88:91], v[148:151]
    ds_read_b128 a[140:143], v27 offset:18432
    v_mfma_f32_16x16x32_bf16 v[152:155], a[48:51], a[92:95], v[152:155]
    v_mfma_f32_16x16x32_bf16 v[156:159], a[52:55], a[92:95], v[156:159]
    buffer_load_dwordx4 a[148:151], v44, s[52:55], s90 offen offset:0 sc1
    v_mfma_f32_16x16x32_bf16 v[160:163], a[48:51], a[96:99], v[160:163]
    v_mfma_f32_16x16x32_bf16 v[164:167], a[52:55], a[96:99], v[164:167]
    v_mfma_f32_16x16x32_bf16 v[168:171], a[48:51], a[100:103], v[168:171]
    v_mfma_f32_16x16x32_bf16 v[172:175], a[52:55], a[100:103], v[172:175]
    s_barrier
    s_waitcnt vmcnt(20) lgkmcnt(5)
    v_mfma_f32_16x16x32_bf16 v[96:99], a[56:59], a[104:107], v[96:99]
    ds_read_b128 a[64:67], v26 offset:20480
    v_mfma_f32_16x16x32_bf16 v[100:103], a[60:63], a[104:107], v[100:103]
    ds_read_b128 a[68:71], v26 offset:30720
    v_mfma_f32_16x16x32_bf16 v[104:107], a[56:59], a[108:111], v[104:107]
    v_mfma_f32_16x16x32_bf16 v[108:111], a[60:63], a[108:111], v[108:111]
    ds_read_b128 a[72:75], v26 offset:22528
    v_mfma_f32_16x16x32_bf16 v[112:115], a[56:59], a[112:115], v[112:115]
    ds_read_b128 a[76:79], v26 offset:32768
    v_mfma_f32_16x16x32_bf16 v[116:119], a[60:63], a[112:115], v[116:119]
    buffer_load_dwordx4 a[152:155], v2, s[52:55], s90 offen offset:1024 sc1
    v_mfma_f32_16x16x32_bf16 v[120:123], a[56:59], a[116:119], v[120:123]
    ds_read_b128 a[80:83], v26 offset:24576
    v_mfma_f32_16x16x32_bf16 v[124:127], a[60:63], a[116:119], v[124:127]
    ds_read_b128 a[84:87], v26 offset:34816
    v_mfma_f32_16x16x32_bf16 v[128:131], a[56:59], a[120:123], v[128:131]
    v_mfma_f32_16x16x32_bf16 v[132:135], a[60:63], a[120:123], v[132:135]
    ds_read_b128 a[88:91], v26 offset:26624
    s_waitcnt lgkmcnt(7)
    v_mfma_f32_16x16x32_bf16 v[136:139], a[56:59], a[124:127], v[136:139]
    ds_read_b128 a[92:95], v26 offset:36864
    v_mfma_f32_16x16x32_bf16 v[140:143], a[60:63], a[124:127], v[140:143]
    v_mfma_f32_16x16x32_bf16 v[144:147], a[56:59], a[128:131], v[144:147]
    ds_read_b128 a[96:99], v26 offset:28672
    v_mfma_f32_16x16x32_bf16 v[148:151], a[60:63], a[128:131], v[148:151]
    ds_read_b128 a[100:103], v26 offset:38912
    v_mfma_f32_16x16x32_bf16 v[152:155], a[56:59], a[132:135], v[152:155]
    v_mfma_f32_16x16x32_bf16 v[156:159], a[60:63], a[132:135], v[156:159]
    buffer_load_dwordx4 a[156:159], v44, s[52:55], s90 offen offset:1024 sc1
    v_mfma_f32_16x16x32_bf16 v[160:163], a[56:59], a[136:139], v[160:163]
    v_mfma_f32_16x16x32_bf16 v[164:167], a[60:63], a[136:139], v[164:167]
    v_mfma_f32_16x16x32_bf16 v[168:171], a[56:59], a[140:143], v[168:171]
    v_mfma_f32_16x16x32_bf16 v[172:175], a[60:63], a[140:143], v[172:175]
    s_waitcnt vmcnt(15) lgkmcnt(5)
    v_mfma_f32_16x16x32_bf16 v[96:99], a[0:3], a[64:67], v[96:99]
    ds_read_b128 a[104:107], v27 offset:20480
    v_mfma_f32_16x16x32_bf16 v[100:103], a[4:7], a[64:67], v[100:103]
    ds_read_b128 a[108:111], v27 offset:30720
    s_mov_b32 exec_hi, 0
    buffer_load_dwordx4 a[192:195], v2, s[52:55], s91 offen sc1
    s_mov_b64 exec, -1
    v_mfma_f32_16x16x32_bf16 v[104:107], a[0:3], a[68:71], v[104:107]
    v_mfma_f32_16x16x32_bf16 v[108:111], a[4:7], a[68:71], v[108:111]
    ds_read_b128 a[112:115], v27 offset:22528
    v_mfma_f32_16x16x32_bf16 v[112:115], a[0:3], a[72:75], v[112:115]
    ds_read_b128 a[116:119], v27 offset:32768
    v_mfma_f32_16x16x32_bf16 v[116:119], a[4:7], a[72:75], v[116:119]
    s_mov_b32 exec_hi, 0
    buffer_load_dwordx4 a[196:199], v44, s[52:55], s91 offen sc1
    s_mov_b64 exec, -1
    v_mfma_f32_16x16x32_bf16 v[120:123], a[0:3], a[76:79], v[120:123]
    ds_read_b128 a[120:123], v27 offset:24576
    v_mfma_f32_16x16x32_bf16 v[124:127], a[4:7], a[76:79], v[124:127]
    ds_read_b128 a[124:127], v27 offset:34816
    v_mfma_f32_16x16x32_bf16 v[128:131], a[0:3], a[80:83], v[128:131]
    buffer_load_dwordx4 v21, s[64:67], s81 offen offset:0 lds
    v_mfma_f32_16x16x32_bf16 v[132:135], a[4:7], a[80:83], v[132:135]
    ds_read_b128 a[128:131], v27 offset:26624
    s_waitcnt lgkmcnt(7)
    v_mfma_f32_16x16x32_bf16 v[136:139], a[0:3], a[84:87], v[136:139]
    ds_read_b128 a[132:135], v27 offset:36864
    v_mfma_f32_16x16x32_bf16 v[140:143], a[4:7], a[84:87], v[140:143]
    buffer_load_dwordx4 v22, s[64:67], s81 offen offset:1024 lds
    v_mfma_f32_16x16x32_bf16 v[144:147], a[0:3], a[88:91], v[144:147]
    ds_read_b128 a[136:139], v27 offset:28672
    v_mfma_f32_16x16x32_bf16 v[148:151], a[4:7], a[88:91], v[148:151]
    ds_read_b128 a[140:143], v27 offset:38912
    v_mfma_f32_16x16x32_bf16 v[152:155], a[0:3], a[92:95], v[152:155]
    v_mfma_f32_16x16x32_bf16 v[156:159], a[4:7], a[92:95], v[156:159]
    buffer_load_dwordx4 v23, s[64:67], s81 offen offset:2048 lds
    s_add_u32 m0, s87, 81920
    v_mfma_f32_16x16x32_bf16 v[160:163], a[0:3], a[96:99], v[160:163]
    v_mfma_f32_16x16x32_bf16 v[164:167], a[4:7], a[96:99], v[164:167]
    v_mfma_f32_16x16x32_bf16 v[168:171], a[0:3], a[100:103], v[168:171]
    buffer_load_dwordx4 v24, s[68:71], s81 offen offset:0 lds
    v_mfma_f32_16x16x32_bf16 v[172:175], a[4:7], a[100:103], v[172:175]
    s_barrier
    s_waitcnt vmcnt(19) lgkmcnt(5)
    v_mfma_f32_16x16x32_bf16 v[96:99], a[8:11], a[104:107], v[96:99]
    ds_read_b128 a[64:67], v26 offset:40960
    v_mfma_f32_16x16x32_bf16 v[100:103], a[12:15], a[104:107], v[100:103]
    ds_read_b128 a[68:71], v26 offset:51200
    v_mfma_f32_16x16x32_bf16 v[104:107], a[8:11], a[108:111], v[104:107]
    v_mfma_f32_16x16x32_bf16 v[108:111], a[12:15], a[108:111], v[108:111]
    ds_read_b128 a[72:75], v26 offset:43008
    buffer_load_dwordx4 a[160:163], v94, s[48:51], s96 offen offset:0
    v_mfma_f32_16x16x32_bf16 v[112:115], a[8:11], a[112:115], v[112:115]
    ds_read_b128 a[76:79], v26 offset:53248
    v_mfma_f32_16x16x32_bf16 v[116:119], a[12:15], a[112:115], v[116:119]
    v_mfma_f32_16x16x32_bf16 v[120:123], a[8:11], a[116:119], v[120:123]
    ds_read_b128 a[80:83], v26 offset:45056
    v_mfma_f32_16x16x32_bf16 v[124:127], a[12:15], a[116:119], v[124:127]
    ds_read_b128 a[84:87], v26 offset:55296
    v_mfma_f32_16x16x32_bf16 v[128:131], a[8:11], a[120:123], v[128:131]
    v_mfma_f32_16x16x32_bf16 v[132:135], a[12:15], a[120:123], v[132:135]
    ds_read_b128 a[88:91], v26 offset:47104
    s_waitcnt lgkmcnt(7)
    v_mfma_f32_16x16x32_bf16 v[136:139], a[8:11], a[124:127], v[136:139]
    ds_read_b128 a[92:95], v26 offset:57344
    buffer_load_dwordx4 a[168:171], v94, s[48:51], s96 offen offset:64
    v_mfma_f32_16x16x32_bf16 v[140:143], a[12:15], a[124:127], v[140:143]
    v_mfma_f32_16x16x32_bf16 v[144:147], a[8:11], a[128:131], v[144:147]
    ds_read_b128 a[96:99], v26 offset:49152
    v_mfma_f32_16x16x32_bf16 v[148:151], a[12:15], a[128:131], v[148:151]
    ds_read_b128 a[100:103], v26 offset:59392
    v_mfma_f32_16x16x32_bf16 v[152:155], a[8:11], a[132:135], v[152:155]
    v_mfma_f32_16x16x32_bf16 v[156:159], a[12:15], a[132:135], v[156:159]
    v_mfma_f32_16x16x32_bf16 v[160:163], a[8:11], a[136:139], v[160:163]
    buffer_load_dwordx4 v25, s[68:71], s81 offen offset:1024 lds
    s_add_u32 s81, s81, 128
    s_cmp_eq_u32 s81, 1280
    s_cselect_b32 s81, 0, s81
    s_add_u32 m0, s86, 102400
    v_mfma_f32_16x16x32_bf16 v[164:167], a[12:15], a[136:139], v[164:167]
    v_mfma_f32_16x16x32_bf16 v[168:171], a[8:11], a[140:143], v[168:171]
    v_mfma_f32_16x16x32_bf16 v[172:175], a[12:15], a[140:143], v[172:175]
    s_waitcnt vmcnt(20) lgkmcnt(5)
    v_mfma_f32_16x16x32_bf16 v[96:99], a[16:19], a[64:67], v[96:99]
    ds_read_b128 a[104:107], v27 offset:40960
    v_mfma_f32_16x16x32_bf16 v[100:103], a[20:23], a[64:67], v[100:103]
    ds_read_b128 a[108:111], v27 offset:51200
    v_mfma_f32_16x16x32_bf16 v[104:107], a[16:19], a[68:71], v[104:107]
    v_mfma_f32_16x16x32_bf16 v[108:111], a[20:23], a[68:71], v[108:111]
    ds_read_b128 a[112:115], v27 offset:43008
    v_mfma_f32_16x16x32_bf16 v[112:115], a[16:19], a[72:75], v[112:115]
    ds_read_b128 a[116:119], v27 offset:53248
    v_mfma_f32_16x16x32_bf16 v[116:119], a[20:23], a[72:75], v[116:119]
    buffer_load_dwordx4 a[164:167], v94, s[48:51], s96 offen offset:2560
    v_mfma_f32_16x16x32_bf16 v[120:123], a[16:19], a[76:79], v[120:123]
    ds_read_b128 a[120:123], v27 offset:45056
    v_mfma_f32_16x16x32_bf16 v[124:127], a[20:23], a[76:79], v[124:127]
    ds_read_b128 a[124:127], v27 offset:55296
    v_mfma_f32_16x16x32_bf16 v[128:131], a[16:19], a[80:83], v[128:131]
    v_mfma_f32_16x16x32_bf16 v[132:135], a[20:23], a[80:83], v[132:135]
    ds_read_b128 a[128:131], v27 offset:47104
    s_waitcnt lgkmcnt(7)
    v_mfma_f32_16x16x32_bf16 v[136:139], a[16:19], a[84:87], v[136:139]
    ds_read_b128 a[132:135], v27 offset:57344
    v_mfma_f32_16x16x32_bf16 v[140:143], a[20:23], a[84:87], v[140:143]
    v_mfma_f32_16x16x32_bf16 v[144:147], a[16:19], a[88:91], v[144:147]
    ds_read_b128 a[136:139], v27 offset:49152
    v_mfma_f32_16x16x32_bf16 v[148:151], a[20:23], a[88:91], v[148:151]
    ds_read_b128 a[140:143], v27 offset:59392
    v_mfma_f32_16x16x32_bf16 v[152:155], a[16:19], a[92:95], v[152:155]
    v_mfma_f32_16x16x32_bf16 v[156:159], a[20:23], a[92:95], v[156:159]
    buffer_load_dwordx4 a[172:175], v94, s[48:51], s96 offen offset:2624
    v_mfma_f32_16x16x32_bf16 v[160:163], a[16:19], a[96:99], v[160:163]
    v_mfma_f32_16x16x32_bf16 v[164:167], a[20:23], a[96:99], v[164:167]
    v_mfma_f32_16x16x32_bf16 v[168:171], a[16:19], a[100:103], v[168:171]
    v_mfma_f32_16x16x32_bf16 v[172:175], a[20:23], a[100:103], v[172:175]
    s_barrier
    s_waitcnt vmcnt(15) lgkmcnt(5)
    v_mfma_f32_16x16x32_bf16 v[96:99], a[24:27], a[104:107], v[96:99]
    v_mfma_f32_16x16x32_bf16 v[100:103], a[28:31], a[104:107], v[100:103]
    v_mfma_f32_16x16x32_bf16 v[104:107], a[24:27], a[108:111], v[104:107]
    v_mfma_f32_16x16x32_bf16 v[108:111], a[28:31], a[108:111], v[108:111]
    v_mfma_f32_16x16x32_bf16 v[112:115], a[24:27], a[112:115], v[112:115]
    v_mfma_f32_16x16x32_bf16 v[116:119], a[28:31], a[112:115], v[116:119]
    s_mov_b32 exec_lo, 0
    buffer_load_dwordx4 a[200:203], v95, s[48:51], s97 offen offset:0
    s_mov_b64 exec, -1
    v_mfma_f32_16x16x32_bf16 v[120:123], a[24:27], a[116:119], v[120:123]
    v_mfma_f32_16x16x32_bf16 v[124:127], a[28:31], a[116:119], v[124:127]
    v_mfma_f32_16x16x32_bf16 v[128:131], a[24:27], a[120:123], v[128:131]
    v_mfma_f32_16x16x32_bf16 v[132:135], a[28:31], a[120:123], v[132:135]
    s_waitcnt lgkmcnt(0)
    v_mfma_f32_16x16x32_bf16 v[136:139], a[24:27], a[124:127], v[136:139]
    v_mfma_f32_16x16x32_bf16 v[140:143], a[28:31], a[124:127], v[140:143]
    v_mfma_f32_16x16x32_bf16 v[144:147], a[24:27], a[128:131], v[144:147]
    v_mfma_f32_16x16x32_bf16 v[148:151], a[28:31], a[128:131], v[148:151]
    v_mfma_f32_16x16x32_bf16 v[152:155], a[24:27], a[132:135], v[152:155]
    v_mfma_f32_16x16x32_bf16 v[156:159], a[28:31], a[132:135], v[156:159]
    s_mov_b32 exec_lo, 0
    buffer_load_dwordx4 a[204:207], v95, s[48:51], s97 offen offset:2560
    s_mov_b64 exec, -1
    v_mfma_f32_16x16x32_bf16 v[160:163], a[24:27], a[136:139], v[160:163]
    v_mfma_f32_16x16x32_bf16 v[164:167], a[28:31], a[136:139], v[164:167]
    v_mfma_f32_16x16x32_bf16 v[168:171], a[24:27], a[140:143], v[168:171]
    v_mfma_f32_16x16x32_bf16 v[172:175], a[28:31], a[140:143], v[172:175]
    v_pk_fma_f32 v[176:177], v[48:49], v[96:97], v[98:99] op_sel:[0,0,0] op_sel_hi:[0,1,1]
    v_pk_fma_f32 v[178:179], v[48:49], v[104:105], v[106:107] op_sel:[0,0,0] op_sel_hi:[0,1,1]
    v_pk_fma_f32 v[176:177], v[48:49], v[104:105], v[176:177] op_sel:[1,0,0] op_sel_hi:[1,1,1] neg_lo:[1,0,0] neg_hi:[1,0,0]
    v_pk_fma_f32 v[178:179], v[48:49], v[96:97], v[178:179] op_sel:[1,0,0] op_sel_hi:[1,1,1]
    v_pk_fma_f32 v[196:197], v[48:49], v[176:177], v[100:101] op_sel:[0,0,0] op_sel_hi:[0,1,1]
    v_pk_fma_f32 v[198:199], v[48:49], v[178:179], v[108:109] op_sel:[0,0,0] op_sel_hi:[0,1,1]
    v_pk_fma_f32 v[196:197], v[48:49], v[178:179], v[196:197] op_sel:[1,0,0] op_sel_hi:[1,1,1] neg_lo:[1,0,0] neg_hi:[1,0,0]
    v_pk_fma_f32 v[198:199], v[48:49], v[176:177], v[198:199] op_sel:[1,0,0] op_sel_hi:[1,1,1]
    v_pk_fma_f32 v[176:177], v[48:49], v[196:197], v[102:103] op_sel:[0,0,0] op_sel_hi:[0,1,1]
    v_pk_fma_f32 v[178:179], v[48:49], v[198:199], v[110:111] op_sel:[0,0,0] op_sel_hi:[0,1,1]
    v_pk_fma_f32 v[176:177], v[48:49], v[198:199], v[176:177] op_sel:[1,0,0] op_sel_hi:[1,1,1] neg_lo:[1,0,0] neg_hi:[1,0,0]
    v_pk_fma_f32 v[178:179], v[48:49], v[196:197], v[178:179] op_sel:[1,0,0] op_sel_hi:[1,1,1]
    v_fma_f32 v200, v58, v176, v177
    v_fma_f32 v201, v58, v178, v179
    v_fma_f32 v200, -v59, v178, v200
    v_fma_f32 v201, v59, v176, v201
    ds_write_b64 v47, v[200:201] offset:0
    v_pk_fma_f32 v[180:181], v[50:51], v[112:113], v[114:115] op_sel:[0,0,0] op_sel_hi:[0,1,1]
    v_pk_fma_f32 v[182:183], v[50:51], v[120:121], v[122:123] op_sel:[0,0,0] op_sel_hi:[0,1,1]
    v_pk_fma_f32 v[180:181], v[50:51], v[120:121], v[180:181] op_sel:[1,0,0] op_sel_hi:[1,1,1] neg_lo:[1,0,0] neg_hi:[1,0,0]
    v_pk_fma_f32 v[182:183], v[50:51], v[112:113], v[182:183] op_sel:[1,0,0] op_sel_hi:[1,1,1]
    v_pk_fma_f32 v[196:197], v[50:51], v[180:181], v[116:117] op_sel:[0,0,0] op_sel_hi:[0,1,1]
    v_pk_fma_f32 v[198:199], v[50:51], v[182:183], v[124:125] op_sel:[0,0,0] op_sel_hi:[0,1,1]
    v_pk_fma_f32 v[196:197], v[50:51], v[182:183], v[196:197] op_sel:[1,0,0] op_sel_hi:[1,1,1] neg_lo:[1,0,0] neg_hi:[1,0,0]
    v_pk_fma_f32 v[198:199], v[50:51], v[180:181], v[198:199] op_sel:[1,0,0] op_sel_hi:[1,1,1]
    v_pk_fma_f32 v[180:181], v[50:51], v[196:197], v[118:119] op_sel:[0,0,0] op_sel_hi:[0,1,1]
    v_pk_fma_f32 v[182:183], v[50:51], v[198:199], v[126:127] op_sel:[0,0,0] op_sel_hi:[0,1,1]
    v_pk_fma_f32 v[180:181], v[50:51], v[198:199], v[180:181] op_sel:[1,0,0] op_sel_hi:[1,1,1] neg_lo:[1,0,0] neg_hi:[1,0,0]
    v_pk_fma_f32 v[182:183], v[50:51], v[196:197], v[182:183] op_sel:[1,0,0] op_sel_hi:[1,1,1]
    v_fma_f32 v202, v60, v180, v181
    v_fma_f32 v203, v60, v182, v183
    v_fma_f32 v202, -v61, v182, v202
    v_fma_f32 v203, v61, v180, v203
    ds_write_b64 v47, v[202:203] offset:128
    v_pk_fma_f32 v[184:185], v[52:53], v[128:129], v[130:131] op_sel:[0,0,0] op_sel_hi:[0,1,1]
    v_pk_fma_f32 v[186:187], v[52:53], v[136:137], v[138:139] op_sel:[0,0,0] op_sel_hi:[0,1,1]
    v_pk_fma_f32 v[184:185], v[52:53], v[136:137], v[184:185] op_sel:[1,0,0] op_sel_hi:[1,1,1] neg_lo:[1,0,0] neg_hi:[1,0,0]
    v_pk_fma_f32 v[186:187], v[52:53], v[128:129], v[186:187] op_sel:[1,0,0] op_sel_hi:[1,1,1]
    v_pk_fma_f32 v[196:197], v[52:53], v[184:185], v[132:133] op_sel:[0,0,0] op_sel_hi:[0,1,1]
    v_pk_fma_f32 v[198:199], v[52:53], v[186:187], v[140:141] op_sel:[0,0,0] op_sel_hi:[0,1,1]
    v_pk_fma_f32 v[196:197], v[52:53], v[186:187], v[196:197] op_sel:[1,0,0] op_sel_hi:[1,1,1] neg_lo:[1,0,0] neg_hi:[1,0,0]
    v_pk_fma_f32 v[198:199], v[52:53], v[184:185], v[198:199] op_sel:[1,0,0] op_sel_hi:[1,1,1]
    v_pk_fma_f32 v[184:185], v[52:53], v[196:197], v[134:135] op_sel:[0,0,0] op_sel_hi:[0,1,1]
    v_pk_fma_f32 v[186:187], v[52:53], v[198:199], v[142:143] op_sel:[0,0,0] op_sel_hi:[0,1,1]
    v_pk_fma_f32 v[184:185], v[52:53], v[198:199], v[184:185] op_sel:[1,0,0] op_sel_hi:[1,1,1] neg_lo:[1,0,0] neg_hi:[1,0,0]
    v_pk_fma_f32 v[186:187], v[52:53], v[196:197], v[186:187] op_sel:[1,0,0] op_sel_hi:[1,1,1]
    v_fma_f32 v200, v62, v184, v185
    v_fma_f32 v201, v62, v186, v187
    v_fma_f32 v200, -v63, v186, v200
    v_fma_f32 v201, v63, v184, v201
    ds_write_b64 v47, v[200:201] offset:256
    v_pk_fma_f32 v[188:189], v[54:55], v[144:145], v[146:147] op_sel:[0,0,0] op_sel_hi:[0,1,1]
    v_pk_fma_f32 v[190:191], v[54:55], v[152:153], v[154:155] op_sel:[0,0,0] op_sel_hi:[0,1,1]
    v_pk_fma_f32 v[188:189], v[54:55], v[152:153], v[188:189] op_sel:[1,0,0] op_sel_hi:[1,1,1] neg_lo:[1,0,0] neg_hi:[1,0,0]
    v_pk_fma_f32 v[190:191], v[54:55], v[144:145], v[190:191] op_sel:[1,0,0] op_sel_hi:[1,1,1]
    v_pk_fma_f32 v[196:197], v[54:55], v[188:189], v[148:149] op_sel:[0,0,0] op_sel_hi:[0,1,1]
    v_pk_fma_f32 v[198:199], v[54:55], v[190:191], v[156:157] op_sel:[0,0,0] op_sel_hi:[0,1,1]
    v_pk_fma_f32 v[196:197], v[54:55], v[190:191], v[196:197] op_sel:[1,0,0] op_sel_hi:[1,1,1] neg_lo:[1,0,0] neg_hi:[1,0,0]
    v_pk_fma_f32 v[198:199], v[54:55], v[188:189], v[198:199] op_sel:[1,0,0] op_sel_hi:[1,1,1]
    v_pk_fma_f32 v[188:189], v[54:55], v[196:197], v[150:151] op_sel:[0,0,0] op_sel_hi:[0,1,1]
    v_pk_fma_f32 v[190:191], v[54:55], v[198:199], v[158:159] op_sel:[0,0,0] op_sel_hi:[0,1,1]
    v_pk_fma_f32 v[188:189], v[54:55], v[198:199], v[188:189] op_sel:[1,0,0] op_sel_hi:[1,1,1] neg_lo:[1,0,0] neg_hi:[1,0,0]
    v_pk_fma_f32 v[190:191], v[54:55], v[196:197], v[190:191] op_sel:[1,0,0] op_sel_hi:[1,1,1]
    v_fma_f32 v202, v64, v188, v189
    v_fma_f32 v203, v64, v190, v191
    v_fma_f32 v202, -v65, v190, v202
    v_fma_f32 v203, v65, v188, v203
    ds_write_b64 v47, v[202:203] offset:384
    v_pk_fma_f32 v[192:193], v[56:57], v[160:161], v[162:163] op_sel:[0,0,0] op_sel_hi:[0,1,1]
    v_pk_fma_f32 v[194:195], v[56:57], v[168:169], v[170:171] op_sel:[0,0,0] op_sel_hi:[0,1,1]
    v_pk_fma_f32 v[192:193], v[56:57], v[168:169], v[192:193] op_sel:[1,0,0] op_sel_hi:[1,1,1] neg_lo:[1,0,0] neg_hi:[1,0,0]
    v_pk_fma_f32 v[194:195], v[56:57], v[160:161], v[194:195] op_sel:[1,0,0] op_sel_hi:[1,1,1]
    v_pk_fma_f32 v[196:197], v[56:57], v[192:193], v[164:165] op_sel:[0,0,0] op_sel_hi:[0,1,1]
    v_pk_fma_f32 v[198:199], v[56:57], v[194:195], v[172:173] op_sel:[0,0,0] op_sel_hi:[0,1,1]
    v_pk_fma_f32 v[196:197], v[56:57], v[194:195], v[196:197] op_sel:[1,0,0] op_sel_hi:[1,1,1] neg_lo:[1,0,0] neg_hi:[1,0,0]
    v_pk_fma_f32 v[198:199], v[56:57], v[192:193], v[198:199] op_sel:[1,0,0] op_sel_hi:[1,1,1]
    v_pk_fma_f32 v[192:193], v[56:57], v[196:197], v[166:167] op_sel:[0,0,0] op_sel_hi:[0,1,1]
    v_pk_fma_f32 v[194:195], v[56:57], v[198:199], v[174:175] op_sel:[0,0,0] op_sel_hi:[0,1,1]
    v_pk_fma_f32 v[192:193], v[56:57], v[198:199], v[192:193] op_sel:[1,0,0] op_sel_hi:[1,1,1] neg_lo:[1,0,0] neg_hi:[1,0,0]
    v_pk_fma_f32 v[194:195], v[56:57], v[196:197], v[194:195] op_sel:[1,0,0] op_sel_hi:[1,1,1]
    v_fma_f32 v200, v66, v192, v193
    v_fma_f32 v201, v66, v194, v195
    v_fma_f32 v200, -v67, v194, v200
    v_fma_f32 v201, v67, v192, v201
    ds_write_b64 v47, v[200:201] offset:512
    s_waitcnt lgkmcnt(0)
    s_barrier
    s_cmp_gt_u32 s5, 1
    s_cbranch_scc1 L_nocomb_8
    s_mov_b64 exec, s[88:89]
    ds_read_b64 v[196:197], v45 offset:0
    ds_read_b64 v[198:199], v45 offset:640
    ds_read_b64 v[200:201], v45 offset:1280
    ds_read_b64 v[202:203], v45 offset:1920
    ds_read_b64 v[204:205], v45 offset:2560
    ds_read_b64 v[206:207], v45 offset:3200
    ds_read_b64 v[208:209], v45 offset:3840
    ds_read_b64 v[210:211], v45 offset:4480
    ds_read_b64 v[212:213], v45 offset:5120
    ds_read_b64 v[214:215], v45 offset:5760
    ds_read_b64 v[216:217], v45 offset:6400
    ds_read_b64 v[218:219], v45 offset:7040
    ds_read_b64 v[220:221], v45 offset:7680
    ds_read_b64 v[222:223], v45 offset:8320
    ds_read_b64 v[224:225], v45 offset:8960
    ds_read_b64 v[226:227], v45 offset:9600
    s_waitcnt lgkmcnt(14)
    v_pk_fma_f32 v[198:199], v[88:89], v[196:197], v[198:199] op_sel:[0,0,0] op_sel_hi:[0,1,1]
    v_pk_fma_f32 v[198:199], v[88:89], v[196:197], v[198:199] op_sel:[1,1,0] op_sel_hi:[1,0,1] neg_lo:[1,0,0]
    s_waitcnt lgkmcnt(13)
    v_pk_fma_f32 v[200:201], v[88:89], v[198:199], v[200:201] op_sel:[0,0,0] op_sel_hi:[0,1,1]
    v_pk_fma_f32 v[200:201], v[88:89], v[198:199], v[200:201] op_sel:[1,1,0] op_sel_hi:[1,0,1] neg_lo:[1,0,0]
    s_waitcnt lgkmcnt(12)
    v_pk_fma_f32 v[202:203], v[88:89], v[200:201], v[202:203] op_sel:[0,0,0] op_sel_hi:[0,1,1]
    v_pk_fma_f32 v[202:203], v[88:89], v[200:201], v[202:203] op_sel:[1,1,0] op_sel_hi:[1,0,1] neg_lo:[1,0,0]
    s_waitcnt lgkmcnt(11)
    v_pk_fma_f32 v[204:205], v[88:89], v[202:203], v[204:205] op_sel:[0,0,0] op_sel_hi:[0,1,1]
    v_pk_fma_f32 v[204:205], v[88:89], v[202:203], v[204:205] op_sel:[1,1,0] op_sel_hi:[1,0,1] neg_lo:[1,0,0]
    s_waitcnt lgkmcnt(10)
    v_pk_fma_f32 v[206:207], v[88:89], v[204:205], v[206:207] op_sel:[0,0,0] op_sel_hi:[0,1,1]
    v_pk_fma_f32 v[206:207], v[88:89], v[204:205], v[206:207] op_sel:[1,1,0] op_sel_hi:[1,0,1] neg_lo:[1,0,0]
    s_waitcnt lgkmcnt(9)
    v_pk_fma_f32 v[208:209], v[88:89], v[206:207], v[208:209] op_sel:[0,0,0] op_sel_hi:[0,1,1]
    v_pk_fma_f32 v[208:209], v[88:89], v[206:207], v[208:209] op_sel:[1,1,0] op_sel_hi:[1,0,1] neg_lo:[1,0,0]
    s_waitcnt lgkmcnt(8)
    v_pk_fma_f32 v[210:211], v[88:89], v[208:209], v[210:211] op_sel:[0,0,0] op_sel_hi:[0,1,1]
    v_pk_fma_f32 v[210:211], v[88:89], v[208:209], v[210:211] op_sel:[1,1,0] op_sel_hi:[1,0,1] neg_lo:[1,0,0]
    s_waitcnt lgkmcnt(7)
    v_pk_fma_f32 v[212:213], v[88:89], v[210:211], v[212:213] op_sel:[0,0,0] op_sel_hi:[0,1,1]
    v_pk_fma_f32 v[212:213], v[88:89], v[210:211], v[212:213] op_sel:[1,1,0] op_sel_hi:[1,0,1] neg_lo:[1,0,0]
    s_waitcnt lgkmcnt(6)
    v_pk_fma_f32 v[214:215], v[88:89], v[212:213], v[214:215] op_sel:[0,0,0] op_sel_hi:[0,1,1]
    v_pk_fma_f32 v[214:215], v[88:89], v[212:213], v[214:215] op_sel:[1,1,0] op_sel_hi:[1,0,1] neg_lo:[1,0,0]
    s_waitcnt lgkmcnt(5)
    v_pk_fma_f32 v[216:217], v[88:89], v[214:215], v[216:217] op_sel:[0,0,0] op_sel_hi:[0,1,1]
    v_pk_fma_f32 v[216:217], v[88:89], v[214:215], v[216:217] op_sel:[1,1,0] op_sel_hi:[1,0,1] neg_lo:[1,0,0]
    s_waitcnt lgkmcnt(4)
    v_pk_fma_f32 v[218:219], v[88:89], v[216:217], v[218:219] op_sel:[0,0,0] op_sel_hi:[0,1,1]
    v_pk_fma_f32 v[218:219], v[88:89], v[216:217], v[218:219] op_sel:[1,1,0] op_sel_hi:[1,0,1] neg_lo:[1,0,0]
    s_waitcnt lgkmcnt(3)
    v_pk_fma_f32 v[220:221], v[88:89], v[218:219], v[220:221] op_sel:[0,0,0] op_sel_hi:[0,1,1]
    v_pk_fma_f32 v[220:221], v[88:89], v[218:219], v[220:221] op_sel:[1,1,0] op_sel_hi:[1,0,1] neg_lo:[1,0,0]
    s_waitcnt lgkmcnt(2)
    v_pk_fma_f32 v[222:223], v[88:89], v[220:221], v[222:223] op_sel:[0,0,0] op_sel_hi:[0,1,1]
    v_pk_fma_f32 v[222:223], v[88:89], v[220:221], v[222:223] op_sel:[1,1,0] op_sel_hi:[1,0,1] neg_lo:[1,0,0]
    s_waitcnt lgkmcnt(1)
    v_pk_fma_f32 v[224:225], v[88:89], v[222:223], v[224:225] op_sel:[0,0,0] op_sel_hi:[0,1,1]
    v_pk_fma_f32 v[224:225], v[88:89], v[222:223], v[224:225] op_sel:[1,1,0] op_sel_hi:[1,0,1] neg_lo:[1,0,0]
    s_waitcnt lgkmcnt(0)
    v_pk_fma_f32 v[226:227], v[88:89], v[224:225], v[226:227] op_sel:[0,0,0] op_sel_hi:[0,1,1]
    v_pk_fma_f32 v[226:227], v[88:89], v[224:225], v[226:227] op_sel:[1,1,0] op_sel_hi:[1,0,1] neg_lo:[1,0,0]
    v_subrev_u32 v12, 143360, v45
    v_lshlrev_b32 v12, 1, v12
    s_add_u32 s11, s6, 80
    v_mov_b32 v228, s11
    v_mov_b32 v229, s11
    s_lshl_b32 s12, s4, 4
    s_sub_u32 s12, s12, s3
    s_mul_i32 s12, s12, 1280
    s_add_u32 s12, s12, 281344
    buffer_store_dwordx4 v[226:229], v12, s[52:55], s12 offen sc1
    v_mov_b32 v14, 0
    v_mov_b32 v15, 0
    ds_write_b64 v45, v[14:15]
    v_pk_mul_f32 v[234:235], v[92:93], v[196:197] op_sel:[0,0] op_sel_hi:[0,1]
    v_pk_fma_f32 v[234:235], v[92:93], v[196:197], v[234:235] op_sel:[1,1,0] op_sel_hi:[1,0,1] neg_lo:[1,0,0]
    ds_write_b64 v45, v[234:235] offset:640
    v_pk_mul_f32 v[232:233], v[92:93], v[198:199] op_sel:[0,0] op_sel_hi:[0,1]
    v_pk_fma_f32 v[232:233], v[92:93], v[198:199], v[232:233] op_sel:[1,1,0] op_sel_hi:[1,0,1] neg_lo:[1,0,0]
    ds_write_b64 v45, v[232:233] offset:1280
    v_pk_mul_f32 v[234:235], v[92:93], v[200:201] op_sel:[0,0] op_sel_hi:[0,1]
    v_pk_fma_f32 v[234:235], v[92:93], v[200:201], v[234:235] op_sel:[1,1,0] op_sel_hi:[1,0,1] neg_lo:[1,0,0]
    ds_write_b64 v45, v[234:235] offset:1920
    v_pk_mul_f32 v[232:233], v[92:93], v[202:203] op_sel:[0,0] op_sel_hi:[0,1]
    v_pk_fma_f32 v[232:233], v[92:93], v[202:203], v[232:233] op_sel:[1,1,0] op_sel_hi:[1,0,1] neg_lo:[1,0,0]
    ds_write_b64 v45, v[232:233] offset:2560
    v_pk_mul_f32 v[234:235], v[92:93], v[204:205] op_sel:[0,0] op_sel_hi:[0,1]
    v_pk_fma_f32 v[234:235], v[92:93], v[204:205], v[234:235] op_sel:[1,1,0] op_sel_hi:[1,0,1] neg_lo:[1,0,0]
    ds_write_b64 v45, v[234:235] offset:3200
    v_pk_mul_f32 v[232:233], v[92:93], v[206:207] op_sel:[0,0] op_sel_hi:[0,1]
    v_pk_fma_f32 v[232:233], v[92:93], v[206:207], v[232:233] op_sel:[1,1,0] op_sel_hi:[1,0,1] neg_lo:[1,0,0]
    ds_write_b64 v45, v[232:233] offset:3840
    v_pk_mul_f32 v[234:235], v[92:93], v[208:209] op_sel:[0,0] op_sel_hi:[0,1]
    v_pk_fma_f32 v[234:235], v[92:93], v[208:209], v[234:235] op_sel:[1,1,0] op_sel_hi:[1,0,1] neg_lo:[1,0,0]
    ds_write_b64 v45, v[234:235] offset:4480
    v_pk_mul_f32 v[232:233], v[92:93], v[210:211] op_sel:[0,0] op_sel_hi:[0,1]
    v_pk_fma_f32 v[232:233], v[92:93], v[210:211], v[232:233] op_sel:[1,1,0] op_sel_hi:[1,0,1] neg_lo:[1,0,0]
    ds_write_b64 v45, v[232:233] offset:5120
    v_pk_mul_f32 v[234:235], v[92:93], v[212:213] op_sel:[0,0] op_sel_hi:[0,1]
    v_pk_fma_f32 v[234:235], v[92:93], v[212:213], v[234:235] op_sel:[1,1,0] op_sel_hi:[1,0,1] neg_lo:[1,0,0]
    ds_write_b64 v45, v[234:235] offset:5760
    v_pk_mul_f32 v[232:233], v[92:93], v[214:215] op_sel:[0,0] op_sel_hi:[0,1]
    v_pk_fma_f32 v[232:233], v[92:93], v[214:215], v[232:233] op_sel:[1,1,0] op_sel_hi:[1,0,1] neg_lo:[1,0,0]
    ds_write_b64 v45, v[232:233] offset:6400
    v_pk_mul_f32 v[234:235], v[92:93], v[216:217] op_sel:[0,0] op_sel_hi:[0,1]
    v_pk_fma_f32 v[234:235], v[92:93], v[216:217], v[234:235] op_sel:[1,1,0] op_sel_hi:[1,0,1] neg_lo:[1,0,0]
    ds_write_b64 v45, v[234:235] offset:7040
    v_pk_mul_f32 v[232:233], v[92:93], v[218:219] op_sel:[0,0] op_sel_hi:[0,1]
    v_pk_fma_f32 v[232:233], v[92:93], v[218:219], v[232:233] op_sel:[1,1,0] op_sel_hi:[1,0,1] neg_lo:[1,0,0]
    ds_write_b64 v45, v[232:233] offset:7680
    v_pk_mul_f32 v[234:235], v[92:93], v[220:221] op_sel:[0,0] op_sel_hi:[0,1]
    v_pk_fma_f32 v[234:235], v[92:93], v[220:221], v[234:235] op_sel:[1,1,0] op_sel_hi:[1,0,1] neg_lo:[1,0,0]
    ds_write_b64 v45, v[234:235] offset:8320
    v_pk_mul_f32 v[232:233], v[92:93], v[222:223] op_sel:[0,0] op_sel_hi:[0,1]
    v_pk_fma_f32 v[232:233], v[92:93], v[222:223], v[232:233] op_sel:[1,1,0] op_sel_hi:[1,0,1] neg_lo:[1,0,0]
    ds_write_b64 v45, v[232:233] offset:8960
    v_pk_mul_f32 v[234:235], v[92:93], v[224:225] op_sel:[0,0] op_sel_hi:[0,1]
    v_pk_fma_f32 v[234:235], v[92:93], v[224:225], v[234:235] op_sel:[1,1,0] op_sel_hi:[1,0,1] neg_lo:[1,0,0]
    ds_write_b64 v45, v[234:235] offset:9600
    s_mov_b64 exec, -1
L_nocomb_8:
    buffer_load_dwordx4 v21, s[64:67], s81 offen offset:0 lds
    buffer_load_dwordx4 v22, s[64:67], s81 offen offset:1024 lds
    buffer_load_dwordx4 v23, s[64:67], s81 offen offset:2048 lds
    s_add_u32 m0, s87, 102400
    s_nop 0
    buffer_load_dwordx4 v24, s[68:71], s81 offen offset:0 lds
    buffer_load_dwordx4 v25, s[68:71], s81 offen offset:1024 lds
    s_add_u32 s81, s81, 128
    s_cmp_eq_u32 s81, 1280
    s_cselect_b32 s81, 0, s81
    s_add_u32 m0, s86, 122880
    s_nop 0
    buffer_load_dwordx4 v21, s[64:67], s81 offen offset:0 lds
    buffer_load_dwordx4 v22, s[64:67], s81 offen offset:1024 lds
    buffer_load_dwordx4 v23, s[64:67], s81 offen offset:2048 lds
    s_add_u32 m0, s87, 122880
    s_nop 0
    buffer_load_dwordx4 v24, s[68:71], s81 offen offset:0 lds
    buffer_load_dwordx4 v25, s[68:71], s81 offen offset:1024 lds
    s_add_u32 s81, s81, 128
    s_cmp_eq_u32 s81, 1280
    s_cselect_b32 s81, 0, s81
    s_add_u32 m0, s86, 0
    s_nop 0
    buffer_load_dwordx4 v21, s[64:67], s81 offen offset:0 lds
    buffer_load_dwordx4 v22, s[64:67], s81 offen offset:1024 lds
    buffer_load_dwordx4 v23, s[64:67], s81 offen offset:2048 lds
    s_add_u32 m0, s87, 0
    s_nop 0
    buffer_load_dwordx4 v24, s[68:71], s81 offen offset:0 lds
    buffer_load_dwordx4 v25, s[68:71], s81 offen offset:1024 lds
    s_add_u32 s81, s81, 128
    s_cmp_eq_u32 s81, 1280
    s_cselect_b32 s81, 0, s81
    s_add_u32 m0, s86, 20480
    s_nop 0
    buffer_load_dwordx4 v21, s[64:67], s81 offen offset:0 lds
    buffer_load_dwordx4 v22, s[64:67], s81 offen offset:1024 lds
    buffer_load_dwordx4 v23, s[64:67], s81 offen offset:2048 lds
    s_add_u32 m0, s87, 20480
    s_nop 0
    buffer_load_dwordx4 v24, s[68:71], s81 offen offset:0 lds
    buffer_load_dwordx4 v25, s[68:71], s81 offen offset:1024 lds
    s_add_u32 s81, s81, 128
    s_cmp_eq_u32 s81, 1280
    s_cselect_b32 s81, 0, s81
    v_pk_mul_f32 v[14:15], v[68:69], v[178:179] op_sel:[1,0] op_sel_hi:[1,1] neg_lo:[1,0] neg_hi:[1,0]
    v_pk_mul_f32 v[178:179], v[68:69], v[178:179] op_sel:[0,0] op_sel_hi:[0,1]
    v_pk_fma_f32 v[178:179], v[68:69], v[176:177], v[178:179] op_sel:[1,0,0] op_sel_hi:[1,1,1]
    v_pk_fma_f32 v[176:177], v[68:69], v[176:177], v[14:15] op_sel:[0,0,0] op_sel_hi:[0,1,1]
    v_pk_mul_f32 v[14:15], v[68:69], v[104:105] op_sel:[1,0] op_sel_hi:[1,1] neg_lo:[1,0] neg_hi:[1,0]
    v_pk_mul_f32 v[104:105], v[68:69], v[104:105] op_sel:[0,0] op_sel_hi:[0,1]
    v_pk_fma_f32 v[104:105], v[68:69], v[96:97], v[104:105] op_sel:[1,0,0] op_sel_hi:[1,1,1]
    v_pk_fma_f32 v[96:97], v[68:69], v[96:97], v[14:15] op_sel:[0,0,0] op_sel_hi:[0,1,1]
    v_pk_mul_f32 v[14:15], v[68:69], v[106:107] op_sel:[1,0] op_sel_hi:[1,1] neg_lo:[1,0] neg_hi:[1,0]
    v_pk_mul_f32 v[106:107], v[68:69], v[106:107] op_sel:[0,0] op_sel_hi:[0,1]
    v_pk_fma_f32 v[106:107], v[68:69], v[98:99], v[106:107] op_sel:[1,0,0] op_sel_hi:[1,1,1]
    v_pk_fma_f32 v[98:99], v[68:69], v[98:99], v[14:15] op_sel:[0,0,0] op_sel_hi:[0,1,1]
    v_pk_mul_f32 v[14:15], v[68:69], v[108:109] op_sel:[1,0] op_sel_hi:[1,1] neg_lo:[1,0] neg_hi:[1,0]
    v_pk_mul_f32 v[108:109], v[68:69], v[108:109] op_sel:[0,0] op_sel_hi:[0,1]
    v_pk_fma_f32 v[108:109], v[68:69], v[100:101], v[108:109] op_sel:[1,0,0] op_sel_hi:[1,1,1]
    v_pk_fma_f32 v[100:101], v[68:69], v[100:101], v[14:15] op_sel:[0,0,0] op_sel_hi:[0,1,1]
    v_pk_mul_f32 v[14:15], v[68:69], v[110:111] op_sel:[1,0] op_sel_hi:[1,1] neg_lo:[1,0] neg_hi:[1,0]
    v_pk_mul_f32 v[110:111], v[68:69], v[110:111] op_sel:[0,0] op_sel_hi:[0,1]
    v_pk_fma_f32 v[110:111], v[68:69], v[102:103], v[110:111] op_sel:[1,0,0] op_sel_hi:[1,1,1]
    v_pk_fma_f32 v[102:103], v[68:69], v[102:103], v[14:15] op_sel:[0,0,0] op_sel_hi:[0,1,1]
    v_pk_mul_f32 v[14:15], v[70:71], v[182:183] op_sel:[1,0] op_sel_hi:[1,1] neg_lo:[1,0] neg_hi:[1,0]
    v_pk_mul_f32 v[182:183], v[70:71], v[182:183] op_sel:[0,0] op_sel_hi:[0,1]
    v_pk_fma_f32 v[182:183], v[70:71], v[180:181], v[182:183] op_sel:[1,0,0] op_sel_hi:[1,1,1]
    v_pk_fma_f32 v[180:181], v[70:71], v[180:181], v[14:15] op_sel:[0,0,0] op_sel_hi:[0,1,1]
    v_pk_mul_f32 v[14:15], v[70:71], v[120:121] op_sel:[1,0] op_sel_hi:[1,1] neg_lo:[1,0] neg_hi:[1,0]
    v_pk_mul_f32 v[120:121], v[70:71], v[120:121] op_sel:[0,0] op_sel_hi:[0,1]
    v_pk_fma_f32 v[120:121], v[70:71], v[112:113], v[120:121] op_sel:[1,0,0] op_sel_hi:[1,1,1]
    v_pk_fma_f32 v[112:113], v[70:71], v[112:113], v[14:15] op_sel:[0,0,0] op_sel_hi:[0,1,1]
    v_pk_mul_f32 v[14:15], v[70:71], v[122:123] op_sel:[1,0] op_sel_hi:[1,1] neg_lo:[1,0] neg_hi:[1,0]
    v_pk_mul_f32 v[122:123], v[70:71], v[122:123] op_sel:[0,0] op_sel_hi:[0,1]
    v_pk_fma_f32 v[122:123], v[70:71], v[114:115], v[122:123] op_sel:[1,0,0] op_sel_hi:[1,1,1]
    v_pk_fma_f32 v[114:115], v[70:71], v[114:115], v[14:15] op_sel:[0,0,0] op_sel_hi:[0,1,1]
    v_pk_mul_f32 v[14:15], v[70:71], v[124:125] op_sel:[1,0] op_sel_hi:[1,1] neg_lo:[1,0] neg_hi:[1,0]
    v_pk_mul_f32 v[124:125], v[70:71], v[124:125] op_sel:[0,0] op_sel_hi:[0,1]
    v_pk_fma_f32 v[124:125], v[70:71], v[116:117], v[124:125] op_sel:[1,0,0] op_sel_hi:[1,1,1]
    v_pk_fma_f32 v[116:117], v[70:71], v[116:117], v[14:15] op_sel:[0,0,0] op_sel_hi:[0,1,1]
    v_pk_mul_f32 v[14:15], v[70:71], v[126:127] op_sel:[1,0] op_sel_hi:[1,1] neg_lo:[1,0] neg_hi:[1,0]
    v_pk_mul_f32 v[126:127], v[70:71], v[126:127] op_sel:[0,0] op_sel_hi:[0,1]
    v_pk_fma_f32 v[126:127], v[70:71], v[118:119], v[126:127] op_sel:[1,0,0] op_sel_hi:[1,1,1]
    v_pk_fma_f32 v[118:119], v[70:71], v[118:119], v[14:15] op_sel:[0,0,0] op_sel_hi:[0,1,1]
    v_pk_mul_f32 v[14:15], v[72:73], v[186:187] op_sel:[1,0] op_sel_hi:[1,1] neg_lo:[1,0] neg_hi:[1,0]
    v_pk_mul_f32 v[186:187], v[72:73], v[186:187] op_sel:[0,0] op_sel_hi:[0,1]
    v_pk_fma_f32 v[186:187], v[72:73], v[184:185], v[186:187] op_sel:[1,0,0] op_sel_hi:[1,1,1]
    v_pk_fma_f32 v[184:185], v[72:73], v[184:185], v[14:15] op_sel:[0,0,0] op_sel_hi:[0,1,1]
    v_pk_mul_f32 v[14:15], v[72:73], v[136:137] op_sel:[1,0] op_sel_hi:[1,1] neg_lo:[1,0] neg_hi:[1,0]
    v_pk_mul_f32 v[136:137], v[72:73], v[136:137] op_sel:[0,0] op_sel_hi:[0,1]
    v_pk_fma_f32 v[136:137], v[72:73], v[128:129], v[136:137] op_sel:[1,0,0] op_sel_hi:[1,1,1]
    v_pk_fma_f32 v[128:129], v[72:73], v[128:129], v[14:15] op_sel:[0,0,0] op_sel_hi:[0,1,1]
    v_pk_mul_f32 v[14:15], v[72:73], v[138:139] op_sel:[1,0] op_sel_hi:[1,1] neg_lo:[1,0] neg_hi:[1,0]
    v_pk_mul_f32 v[138:139], v[72:73], v[138:139] op_sel:[0,0] op_sel_hi:[0,1]
    v_pk_fma_f32 v[138:139], v[72:73], v[130:131], v[138:139] op_sel:[1,0,0] op_sel_hi:[1,1,1]
    v_pk_fma_f32 v[130:131], v[72:73], v[130:131], v[14:15] op_sel:[0,0,0] op_sel_hi:[0,1,1]
    v_pk_mul_f32 v[14:15], v[72:73], v[140:141] op_sel:[1,0] op_sel_hi:[1,1] neg_lo:[1,0] neg_hi:[1,0]
    v_pk_mul_f32 v[140:141], v[72:73], v[140:141] op_sel:[0,0] op_sel_hi:[0,1]
    v_pk_fma_f32 v[140:141], v[72:73], v[132:133], v[140:141] op_sel:[1,0,0] op_sel_hi:[1,1,1]
    v_pk_fma_f32 v[132:133], v[72:73], v[132:133], v[14:15] op_sel:[0,0,0] op_sel_hi:[0,1,1]
    v_pk_mul_f32 v[14:15], v[72:73], v[142:143] op_sel:[1,0] op_sel_hi:[1,1] neg_lo:[1,0] neg_hi:[1,0]
    v_pk_mul_f32 v[142:143], v[72:73], v[142:143] op_sel:[0,0] op_sel_hi:[0,1]
    v_pk_fma_f32 v[142:143], v[72:73], v[134:135], v[142:143] op_sel:[1,0,0] op_sel_hi:[1,1,1]
    v_pk_fma_f32 v[134:135], v[72:73], v[134:135], v[14:15] op_sel:[0,0,0] op_sel_hi:[0,1,1]
    v_pk_mul_f32 v[14:15], v[74:75], v[190:191] op_sel:[1,0] op_sel_hi:[1,1] neg_lo:[1,0] neg_hi:[1,0]
    v_pk_mul_f32 v[190:191], v[74:75], v[190:191] op_sel:[0,0] op_sel_hi:[0,1]
    v_pk_fma_f32 v[190:191], v[74:75], v[188:189], v[190:191] op_sel:[1,0,0] op_sel_hi:[1,1,1]
    v_pk_fma_f32 v[188:189], v[74:75], v[188:189], v[14:15] op_sel:[0,0,0] op_sel_hi:[0,1,1]
    v_pk_mul_f32 v[14:15], v[74:75], v[152:153] op_sel:[1,0] op_sel_hi:[1,1] neg_lo:[1,0] neg_hi:[1,0]
    v_pk_mul_f32 v[152:153], v[74:75], v[152:153] op_sel:[0,0] op_sel_hi:[0,1]
    v_pk_fma_f32 v[152:153], v[74:75], v[144:145], v[152:153] op_sel:[1,0,0] op_sel_hi:[1,1,1]
    v_pk_fma_f32 v[144:145], v[74:75], v[144:145], v[14:15] op_sel:[0,0,0] op_sel_hi:[0,1,1]
    v_pk_mul_f32 v[14:15], v[74:75], v[154:155] op_sel:[1,0] op_sel_hi:[1,1] neg_lo:[1,0] neg_hi:[1,0]
    v_pk_mul_f32 v[154:155], v[74:75], v[154:155] op_sel:[0,0] op_sel_hi:[0,1]
    v_pk_fma_f32 v[154:155], v[74:75], v[146:147], v[154:155] op_sel:[1,0,0] op_sel_hi:[1,1,1]
    v_pk_fma_f32 v[146:147], v[74:75], v[146:147], v[14:15] op_sel:[0,0,0] op_sel_hi:[0,1,1]
    v_pk_mul_f32 v[14:15], v[74:75], v[156:157] op_sel:[1,0] op_sel_hi:[1,1] neg_lo:[1,0] neg_hi:[1,0]
    v_pk_mul_f32 v[156:157], v[74:75], v[156:157] op_sel:[0,0] op_sel_hi:[0,1]
    v_pk_fma_f32 v[156:157], v[74:75], v[148:149], v[156:157] op_sel:[1,0,0] op_sel_hi:[1,1,1]
    v_pk_fma_f32 v[148:149], v[74:75], v[148:149], v[14:15] op_sel:[0,0,0] op_sel_hi:[0,1,1]
    v_pk_mul_f32 v[14:15], v[74:75], v[158:159] op_sel:[1,0] op_sel_hi:[1,1] neg_lo:[1,0] neg_hi:[1,0]
    v_pk_mul_f32 v[158:159], v[74:75], v[158:159] op_sel:[0,0] op_sel_hi:[0,1]
    v_pk_fma_f32 v[158:159], v[74:75], v[150:151], v[158:159] op_sel:[1,0,0] op_sel_hi:[1,1,1]
    v_pk_fma_f32 v[150:151], v[74:75], v[150:151], v[14:15] op_sel:[0,0,0] op_sel_hi:[0,1,1]
    v_pk_mul_f32 v[14:15], v[76:77], v[194:195] op_sel:[1,0] op_sel_hi:[1,1] neg_lo:[1,0] neg_hi:[1,0]
    v_pk_mul_f32 v[194:195], v[76:77], v[194:195] op_sel:[0,0] op_sel_hi:[0,1]
    v_pk_fma_f32 v[194:195], v[76:77], v[192:193], v[194:195] op_sel:[1,0,0] op_sel_hi:[1,1,1]
    v_pk_fma_f32 v[192:193], v[76:77], v[192:193], v[14:15] op_sel:[0,0,0] op_sel_hi:[0,1,1]
    v_pk_mul_f32 v[14:15], v[76:77], v[168:169] op_sel:[1,0] op_sel_hi:[1,1] neg_lo:[1,0] neg_hi:[1,0]
    v_pk_mul_f32 v[168:169], v[76:77], v[168:169] op_sel:[0,0] op_sel_hi:[0,1]
    v_pk_fma_f32 v[168:169], v[76:77], v[160:161], v[168:169] op_sel:[1,0,0] op_sel_hi:[1,1,1]
    v_pk_fma_f32 v[160:161], v[76:77], v[160:161], v[14:15] op_sel:[0,0,0] op_sel_hi:[0,1,1]
    v_pk_mul_f32 v[14:15], v[76:77], v[170:171] op_sel:[1,0] op_sel_hi:[1,1] neg_lo:[1,0] neg_hi:[1,0]
    v_pk_mul_f32 v[170:171], v[76:77], v[170:171] op_sel:[0,0] op_sel_hi:[0,1]
    v_pk_fma_f32 v[170:171], v[76:77], v[162:163], v[170:171] op_sel:[1,0,0] op_sel_hi:[1,1,1]
    v_pk_fma_f32 v[162:163], v[76:77], v[162:163], v[14:15] op_sel:[0,0,0] op_sel_hi:[0,1,1]
    v_pk_mul_f32 v[14:15], v[76:77], v[172:173] op_sel:[1,0] op_sel_hi:[1,1] neg_lo:[1,0] neg_hi:[1,0]
    v_pk_mul_f32 v[172:173], v[76:77], v[172:173] op_sel:[0,0] op_sel_hi:[0,1]
    v_pk_fma_f32 v[172:173], v[76:77], v[164:165], v[172:173] op_sel:[1,0,0] op_sel_hi:[1,1,1]
    v_pk_fma_f32 v[164:165], v[76:77], v[164:165], v[14:15] op_sel:[0,0,0] op_sel_hi:[0,1,1]
    v_pk_mul_f32 v[14:15], v[76:77], v[174:175] op_sel:[1,0] op_sel_hi:[1,1] neg_lo:[1,0] neg_hi:[1,0]
    v_pk_mul_f32 v[174:175], v[76:77], v[174:175] op_sel:[0,0] op_sel_hi:[0,1]
    v_pk_fma_f32 v[174:175], v[76:77], v[166:167], v[174:175] op_sel:[1,0,0] op_sel_hi:[1,1,1]
    v_pk_fma_f32 v[166:167], v[76:77], v[166:167], v[14:15] op_sel:[0,0,0] op_sel_hi:[0,1,1]
    s_cmp_lt_u32 s5, 2
    s_cbranch_scc1 L_nocarry_9
    s_lshl_b32 s11, s4, 4
    s_sub_u32 s11, s11, s3
    s_mul_i32 s11, s11, 1280
    s_add_u32 s11, s11, 282624
    s_add_u32 s76, s44, s11
    s_addc_u32 s77, s45, 0
    s_mul_i32 s78, s3, 1280
    s_mov_b32 s79, 0x20000
    s_add_u32 s12, s6, 80
    s_mul_i32 s12, s12, s3
    s_mov_b64 exec, s[88:89]
    v_subrev_u32 v10, 143360, v45
    v_lshlrev_b32 v10, 1, v10
    v_add_u32 v11, 3840, v10
    v_add_u32 v12, 7680, v10
    v_add_u32 v13, 11520, v10
    v_add_u32 v14, 15360, v10
L_cpoll_10:
    buffer_load_dwordx3 v[196:198], v10, s[76:79], 0 offen offset:0 sc1
    buffer_load_dwordx3 v[200:202], v10, s[76:79], 0 offen offset:1280 sc1
    buffer_load_dwordx3 v[204:206], v10, s[76:79], 0 offen offset:2560 sc1
    buffer_load_dwordx3 v[208:210], v11, s[76:79], 0 offen offset:0 sc1
    buffer_load_dwordx3 v[212:214], v11, s[76:79], 0 offen offset:1280 sc1
    buffer_load_dwordx3 v[216:218], v11, s[76:79], 0 offen offset:2560 sc1
    buffer_load_dwordx3 v[220:222], v12, s[76:79], 0 offen offset:0 sc1
    buffer_load_dwordx3 v[224:226], v12, s[76:79], 0 offen offset:1280 sc1
    buffer_load_dwordx3 v[228:230], v12, s[76:79], 0 offen offset:2560 sc1
    buffer_load_dwordx3 v[232:234], v13, s[76:79], 0 offen offset:0 sc1
    buffer_load_dwordx3 v[236:238], v13, s[76:79], 0 offen offset:1280 sc1
    buffer_load_dwordx3 v[240:242], v13, s[76:79], 0 offen offset:2560 sc1
    buffer_load_dwordx3 v[244:246], v14, s[76:79], 0 offen offset:0 sc1
    buffer_load_dwordx3 v[16:18], v14, s[76:79], 0 offen offset:1280 sc1
    buffer_load_dwordx3 v[26:28], v14, s[76:79], 0 offen offset:2560 sc1
    s_cmp_eq_u32 s10, 0
    s_waitcnt vmcnt(0)
    s_cbranch_scc1 L_cpolled_11
    s_sub_u32 s10, s10, 1
    v_add3_u32 v15, v198, v202, v206
    v_add3_u32 v15, v15, v210, v214
    v_add3_u32 v15, v15, v218, v222
    v_add3_u32 v15, v15, v226, v230
    v_add3_u32 v15, v15, v234, v238
    v_add3_u32 v15, v15, v242, v246
    v_add3_u32 v15, v15, v18, v28
    v_cmp_eq_u32 vcc, s12, v15
    s_nop 0
    s_cmp_eq_u64 vcc, exec
    s_cbranch_scc0 L_cpoll_10
L_cpolled_11:
    v_pk_fma_f32 v[16:17], v[90:91], v[26:27], v[16:17] op_sel:[0,0,0] op_sel_hi:[0,1,1]
    v_pk_fma_f32 v[16:17], v[90:91], v[26:27], v[16:17] op_sel:[1,1,0] op_sel_hi:[1,0,1] neg_lo:[1,0,0]
    v_pk_fma_f32 v[244:245], v[90:91], v[16:17], v[244:245] op_sel:[0,0,0] op_sel_hi:[0,1,1]
    v_pk_fma_f32 v[244:245], v[90:91], v[16:17], v[244:245] op_sel:[1,1,0] op_sel_hi:[1,0,1] neg_lo:[1,0,0]
    v_pk_fma_f32 v[240:241], v[90:91], v[244:245], v[240:241] op_sel:[0,0,0] op_sel_hi:[0,1,1]
    v_pk_fma_f32 v[240:241], v[90:91], v[244:245], v[240:241] op_sel:[1,1,0] op_sel_hi:[1,0,1] neg_lo:[1,0,0]
    v_pk_fma_f32 v[236:237], v[90:91], v[240:241], v[236:237] op_sel:[0,0,0] op_sel_hi:[0,1,1]
    v_pk_fma_f32 v[236:237], v[90:91], v[240:241], v[236:237] op_sel:[1,1,0] op_sel_hi:[1,0,1] neg_lo:[1,0,0]
    v_pk_fma_f32 v[232:233], v[90:91], v[236:237], v[232:233] op_sel:[0,0,0] op_sel_hi:[0,1,1]
    v_pk_fma_f32 v[232:233], v[90:91], v[236:237], v[232:233] op_sel:[1,1,0] op_sel_hi:[1,0,1] neg_lo:[1,0,0]
    v_pk_fma_f32 v[228:229], v[90:91], v[232:233], v[228:229] op_sel:[0,0,0] op_sel_hi:[0,1,1]
    v_pk_fma_f32 v[228:229], v[90:91], v[232:233], v[228:229] op_sel:[1,1,0] op_sel_hi:[1,0,1] neg_lo:[1,0,0]
    v_pk_fma_f32 v[224:225], v[90:91], v[228:229], v[224:225] op_sel:[0,0,0] op_sel_hi:[0,1,1]
    v_pk_fma_f32 v[224:225], v[90:91], v[228:229], v[224:225] op_sel:[1,1,0] op_sel_hi:[1,0,1] neg_lo:[1,0,0]
    v_pk_fma_f32 v[220:221], v[90:91], v[224:225], v[220:221] op_sel:[0,0,0] op_sel_hi:[0,1,1]
    v_pk_fma_f32 v[220:221], v[90:91], v[224:225], v[220:221] op_sel:[1,1,0] op_sel_hi:[1,0,1] neg_lo:[1,0,0]
    v_pk_fma_f32 v[216:217], v[90:91], v[220:221], v[216:217] op_sel:[0,0,0] op_sel_hi:[0,1,1]
    v_pk_fma_f32 v[216:217], v[90:91], v[220:221], v[216:217] op_sel:[1,1,0] op_sel_hi:[1,0,1] neg_lo:[1,0,0]
    v_pk_fma_f32 v[212:213], v[90:91], v[216:217], v[212:213] op_sel:[0,0,0] op_sel_hi:[0,1,1]
    v_pk_fma_f32 v[212:213], v[90:91], v[216:217], v[212:213] op_sel:[1,1,0] op_sel_hi:[1,0,1] neg_lo:[1,0,0]
    v_pk_fma_f32 v[208:209], v[90:91], v[212:213], v[208:209] op_sel:[0,0,0] op_sel_hi:[0,1,1]
    v_pk_fma_f32 v[208:209], v[90:91], v[212:213], v[208:209] op_sel:[1,1,0] op_sel_hi:[1,0,1] neg_lo:[1,0,0]
    v_pk_fma_f32 v[204:205], v[90:91], v[208:209], v[204:205] op_sel:[0,0,0] op_sel_hi:[0,1,1]
    v_pk_fma_f32 v[204:205], v[90:91], v[208:209], v[204:205] op_sel:[1,1,0] op_sel_hi:[1,0,1] neg_lo:[1,0,0]
    v_pk_fma_f32 v[200:201], v[90:91], v[204:205], v[200:201] op_sel:[0,0,0] op_sel_hi:[0,1,1]
    v_pk_fma_f32 v[200:201], v[90:91], v[204:205], v[200:201] op_sel:[1,1,0] op_sel_hi:[1,0,1] neg_lo:[1,0,0]
    v_pk_fma_f32 v[196:197], v[90:91], v[200:201], v[196:197] op_sel:[0,0,0] op_sel_hi:[0,1,1]
    v_pk_fma_f32 v[196:197], v[90:91], v[200:201], v[196:197] op_sel:[1,1,0] op_sel_hi:[1,0,1] neg_lo:[1,0,0]
    ds_write_b64 v45, v[196:197] offset:10240
    s_mov_b64 exec, -1
L_nocarry_9:
    s_waitcnt lgkmcnt(0)
    s_barrier
    ds_read_b64 v[196:197], v47 offset:0
    ds_read_b64 v[198:199], v46 offset:10240
    ds_read_b64 v[200:201], v47 offset:128
    ds_read_b64 v[202:203], v46 offset:10368
    ds_read_b64 v[204:205], v47 offset:256
    ds_read_b64 v[206:207], v46 offset:10496
    ds_read_b64 v[208:209], v47 offset:384
    ds_read_b64 v[210:211], v46 offset:10624
    ds_read_b64 v[212:213], v47 offset:512
    ds_read_b64 v[214:215], v46 offset:10752
    s_mul_i32 s84, s3, 327680
    s_mul_i32 s11, s5, 81920
    s_add_u32 s84, s84, s11
    s_add_u32 s84, s84, 8388608
    s_add_u32 s85, s84, 40960
    s_mul_i32 s13, s4, 5120
    s_add_u32 s13, s13, s84
    v_add_u32 v44, 40960, v2
    s_waitcnt lgkmcnt(0)
    v_fma_f32 v196, v78, v198, v196
    v_fma_f32 v197, v78, v199, v197
    v_fma_f32 v196, -v79, v199, v196
    v_fma_f32 v197, v79, v198, v197
    v_fma_f32 v177, v58, v196, v176
    v_fma_f32 v179, v58, v197, v178
    v_fma_f32 v177, -v59, v197, v177
    v_fma_f32 v179, v59, v196, v179
    v_mov_b32 v176, v196
    v_mov_b32 v178, v197
    v_pk_fma_f32 v[96:97], v[48:49], v[176:177], v[96:97] op_sel:[0,0,0] op_sel_hi:[0,1,1]
    v_pk_fma_f32 v[104:105], v[48:49], v[178:179], v[104:105] op_sel:[0,0,0] op_sel_hi:[0,1,1]
    v_pk_fma_f32 v[96:97], v[48:49], v[178:179], v[96:97] op_sel:[1,0,0] op_sel_hi:[1,1,1] neg_lo:[1,0,0] neg_hi:[1,0,0]
    v_pk_fma_f32 v[104:105], v[48:49], v[176:177], v[104:105] op_sel:[1,0,0] op_sel_hi:[1,1,1]
    v_pk_fma_f32 v[98:99], v[48:49], v[96:97], v[98:99] op_sel:[0,0,0] op_sel_hi:[0,1,1]
    v_pk_fma_f32 v[106:107], v[48:49], v[104:105], v[106:107] op_sel:[0,0,0] op_sel_hi:[0,1,1]
    v_pk_fma_f32 v[98:99], v[48:49], v[104:105], v[98:99] op_sel:[1,0,0] op_sel_hi:[1,1,1] neg_lo:[1,0,0] neg_hi:[1,0,0]
    v_pk_fma_f32 v[106:107], v[48:49], v[96:97], v[106:107] op_sel:[1,0,0] op_sel_hi:[1,1,1]
    v_pk_fma_f32 v[100:101], v[48:49], v[98:99], v[100:101] op_sel:[0,0,0] op_sel_hi:[0,1,1]
    v_pk_fma_f32 v[108:109], v[48:49], v[106:107], v[108:109] op_sel:[0,0,0] op_sel_hi:[0,1,1]
    v_pk_fma_f32 v[100:101], v[48:49], v[106:107], v[100:101] op_sel:[1,0,0] op_sel_hi:[1,1,1] neg_lo:[1,0,0] neg_hi:[1,0,0]
    v_pk_fma_f32 v[108:109], v[48:49], v[98:99], v[108:109] op_sel:[1,0,0] op_sel_hi:[1,1,1]
    v_pk_fma_f32 v[102:103], v[48:49], v[100:101], v[102:103] op_sel:[0,0,0] op_sel_hi:[0,1,1]
    v_pk_fma_f32 v[110:111], v[48:49], v[108:109], v[110:111] op_sel:[0,0,0] op_sel_hi:[0,1,1]
    v_pk_fma_f32 v[102:103], v[48:49], v[108:109], v[102:103] op_sel:[1,0,0] op_sel_hi:[1,1,1] neg_lo:[1,0,0] neg_hi:[1,0,0]
    v_pk_fma_f32 v[110:111], v[48:49], v[100:101], v[110:111] op_sel:[1,0,0] op_sel_hi:[1,1,1]
    v_cvt_pk_bf16_f32 v12, v96, v97
    v_cvt_pk_bf16_f32 v13, v98, v99
    ds_write_b64 v7, v[12:13] offset:0
    v_cvt_pk_bf16_f32 v14, -v104, -v105
    v_cvt_pk_bf16_f32 v15, -v106, -v107
    ds_write_b64 v7, v[14:15] offset:512
    v_cvt_pk_bf16_f32 v12, v100, v101
    v_cvt_pk_bf16_f32 v13, v102, v103
    ds_write_b64 v7, v[12:13] offset:1024
    v_cvt_pk_bf16_f32 v14, -v108, -v109
    v_cvt_pk_bf16_f32 v15, -v110, -v111
    ds_write_b64 v7, v[14:15] offset:1536
    ds_read_b64_tr_b16 v[216:217], v8 offset:0
    ds_read_b64_tr_b16 v[218:219], v9 offset:0
    ds_read_b64_tr_b16 v[220:221], v8 offset:1024
    ds_read_b64_tr_b16 v[222:223], v9 offset:1024
    v_fma_f32 v200, v80, v202, v200
    v_fma_f32 v201, v80, v203, v201
    v_fma_f32 v200, -v81, v203, v200
    v_fma_f32 v201, v81, v202, v201
    v_fma_f32 v181, v60, v200, v180
    v_fma_f32 v183, v60, v201, v182
    v_fma_f32 v181, -v61, v201, v181
    v_fma_f32 v183, v61, v200, v183
    v_mov_b32 v180, v200
    v_mov_b32 v182, v201
    v_pk_fma_f32 v[112:113], v[50:51], v[180:181], v[112:113] op_sel:[0,0,0] op_sel_hi:[0,1,1]
    v_pk_fma_f32 v[120:121], v[50:51], v[182:183], v[120:121] op_sel:[0,0,0] op_sel_hi:[0,1,1]
    v_pk_fma_f32 v[112:113], v[50:51], v[182:183], v[112:113] op_sel:[1,0,0] op_sel_hi:[1,1,1] neg_lo:[1,0,0] neg_hi:[1,0,0]
    v_pk_fma_f32 v[120:121], v[50:51], v[180:181], v[120:121] op_sel:[1,0,0] op_sel_hi:[1,1,1]
    v_pk_fma_f32 v[114:115], v[50:51], v[112:113], v[114:115] op_sel:[0,0,0] op_sel_hi:[0,1,1]
    v_pk_fma_f32 v[122:123], v[50:51], v[120:121], v[122:123] op_sel:[0,0,0] op_sel_hi:[0,1,1]
    v_pk_fma_f32 v[114:115], v[50:51], v[120:121], v[114:115] op_sel:[1,0,0] op_sel_hi:[1,1,1] neg_lo:[1,0,0] neg_hi:[1,0,0]
    v_pk_fma_f32 v[122:123], v[50:51], v[112:113], v[122:123] op_sel:[1,0,0] op_sel_hi:[1,1,1]
    v_pk_fma_f32 v[116:117], v[50:51], v[114:115], v[116:117] op_sel:[0,0,0] op_sel_hi:[0,1,1]
    v_pk_fma_f32 v[124:125], v[50:51], v[122:123], v[124:125] op_sel:[0,0,0] op_sel_hi:[0,1,1]
    v_pk_fma_f32 v[116:117], v[50:51], v[122:123], v[116:117] op_sel:[1,0,0] op_sel_hi:[1,1,1] neg_lo:[1,0,0] neg_hi:[1,0,0]
    v_pk_fma_f32 v[124:125], v[50:51], v[114:115], v[124:125] op_sel:[1,0,0] op_sel_hi:[1,1,1]
    v_pk_fma_f32 v[118:119], v[50:51], v[116:117], v[118:119] op_sel:[0,0,0] op_sel_hi:[0,1,1]
    v_pk_fma_f32 v[126:127], v[50:51], v[124:125], v[126:127] op_sel:[0,0,0] op_sel_hi:[0,1,1]
    v_pk_fma_f32 v[118:119], v[50:51], v[124:125], v[118:119] op_sel:[1,0,0] op_sel_hi:[1,1,1] neg_lo:[1,0,0] neg_hi:[1,0,0]
    v_pk_fma_f32 v[126:127], v[50:51], v[116:117], v[126:127] op_sel:[1,0,0] op_sel_hi:[1,1,1]
    v_cvt_pk_bf16_f32 v12, v112, v113
    v_cvt_pk_bf16_f32 v13, v114, v115
    ds_write_b64 v7, v[12:13] offset:0
    v_cvt_pk_bf16_f32 v14, -v120, -v121
    v_cvt_pk_bf16_f32 v15, -v122, -v123
    ds_write_b64 v7, v[14:15] offset:512
    v_cvt_pk_bf16_f32 v12, v116, v117
    v_cvt_pk_bf16_f32 v13, v118, v119
    ds_write_b64 v7, v[12:13] offset:1024
    v_cvt_pk_bf16_f32 v14, -v124, -v125
    v_cvt_pk_bf16_f32 v15, -v126, -v127
    ds_write_b64 v7, v[14:15] offset:1536
    ds_read_b64_tr_b16 v[224:225], v8 offset:0
    ds_read_b64_tr_b16 v[226:227], v9 offset:0
    ds_read_b64_tr_b16 v[228:229], v8 offset:1024
    ds_read_b64_tr_b16 v[230:231], v9 offset:1024
    s_waitcnt lgkmcnt(10)
    buffer_store_dwordx4 v[216:219], v2, s[52:55], s13 offen offset:0 sc1
    s_waitcnt lgkmcnt(8)
    buffer_store_dwordx4 v[220:223], v44, s[52:55], s13 offen offset:0 sc1
    v_fma_f32 v204, v82, v206, v204
    v_fma_f32 v205, v82, v207, v205
    v_fma_f32 v204, -v83, v207, v204
    v_fma_f32 v205, v83, v206, v205
    v_fma_f32 v185, v62, v204, v184
    v_fma_f32 v187, v62, v205, v186
    v_fma_f32 v185, -v63, v205, v185
    v_fma_f32 v187, v63, v204, v187
    v_mov_b32 v184, v204
    v_mov_b32 v186, v205
    v_pk_fma_f32 v[128:129], v[52:53], v[184:185], v[128:129] op_sel:[0,0,0] op_sel_hi:[0,1,1]
    v_pk_fma_f32 v[136:137], v[52:53], v[186:187], v[136:137] op_sel:[0,0,0] op_sel_hi:[0,1,1]
    v_pk_fma_f32 v[128:129], v[52:53], v[186:187], v[128:129] op_sel:[1,0,0] op_sel_hi:[1,1,1] neg_lo:[1,0,0] neg_hi:[1,0,0]
    v_pk_fma_f32 v[136:137], v[52:53], v[184:185], v[136:137] op_sel:[1,0,0] op_sel_hi:[1,1,1]
    v_pk_fma_f32 v[130:131], v[52:53], v[128:129], v[130:131] op_sel:[0,0,0] op_sel_hi:[0,1,1]
    v_pk_fma_f32 v[138:139], v[52:53], v[136:137], v[138:139] op_sel:[0,0,0] op_sel_hi:[0,1,1]
    v_pk_fma_f32 v[130:131], v[52:53], v[136:137], v[130:131] op_sel:[1,0,0] op_sel_hi:[1,1,1] neg_lo:[1,0,0] neg_hi:[1,0,0]
    v_pk_fma_f32 v[138:139], v[52:53], v[128:129], v[138:139] op_sel:[1,0,0] op_sel_hi:[1,1,1]
    v_pk_fma_f32 v[132:133], v[52:53], v[130:131], v[132:133] op_sel:[0,0,0] op_sel_hi:[0,1,1]
    v_pk_fma_f32 v[140:141], v[52:53], v[138:139], v[140:141] op_sel:[0,0,0] op_sel_hi:[0,1,1]
    v_pk_fma_f32 v[132:133], v[52:53], v[138:139], v[132:133] op_sel:[1,0,0] op_sel_hi:[1,1,1] neg_lo:[1,0,0] neg_hi:[1,0,0]
    v_pk_fma_f32 v[140:141], v[52:53], v[130:131], v[140:141] op_sel:[1,0,0] op_sel_hi:[1,1,1]
    v_pk_fma_f32 v[134:135], v[52:53], v[132:133], v[134:135] op_sel:[0,0,0] op_sel_hi:[0,1,1]
    v_pk_fma_f32 v[142:143], v[52:53], v[140:141], v[142:143] op_sel:[0,0,0] op_sel_hi:[0,1,1]
    v_pk_fma_f32 v[134:135], v[52:53], v[140:141], v[134:135] op_sel:[1,0,0] op_sel_hi:[1,1,1] neg_lo:[1,0,0] neg_hi:[1,0,0]
    v_pk_fma_f32 v[142:143], v[52:53], v[132:133], v[142:143] op_sel:[1,0,0] op_sel_hi:[1,1,1]
    v_cvt_pk_bf16_f32 v12, v128, v129
    v_cvt_pk_bf16_f32 v13, v130, v131
    ds_write_b64 v7, v[12:13] offset:0
    v_cvt_pk_bf16_f32 v14, -v136, -v137
    v_cvt_pk_bf16_f32 v15, -v138, -v139
    ds_write_b64 v7, v[14:15] offset:512
    v_cvt_pk_bf16_f32 v12, v132, v133
    v_cvt_pk_bf16_f32 v13, v134, v135
    ds_write_b64 v7, v[12:13] offset:1024
    v_cvt_pk_bf16_f32 v14, -v140, -v141
    v_cvt_pk_bf16_f32 v15, -v142, -v143
    ds_write_b64 v7, v[14:15] offset:1536
    ds_read_b64_tr_b16 v[216:217], v8 offset:0
    ds_read_b64_tr_b16 v[218:219], v9 offset:0
    ds_read_b64_tr_b16 v[220:221], v8 offset:1024
    ds_read_b64_tr_b16 v[222:223], v9 offset:1024
    s_waitcnt lgkmcnt(10)
    buffer_store_dwordx4 v[224:227], v2, s[52:55], s13 offen offset:1024 sc1
    s_waitcnt lgkmcnt(8)
    buffer_store_dwordx4 v[228:231], v44, s[52:55], s13 offen offset:1024 sc1
    v_fma_f32 v208, v84, v210, v208
    v_fma_f32 v209, v84, v211, v209
    v_fma_f32 v208, -v85, v211, v208
    v_fma_f32 v209, v85, v210, v209
    v_fma_f32 v189, v64, v208, v188
    v_fma_f32 v191, v64, v209, v190
    v_fma_f32 v189, -v65, v209, v189
    v_fma_f32 v191, v65, v208, v191
    v_mov_b32 v188, v208
    v_mov_b32 v190, v209
    v_pk_fma_f32 v[144:145], v[54:55], v[188:189], v[144:145] op_sel:[0,0,0] op_sel_hi:[0,1,1]
    v_pk_fma_f32 v[152:153], v[54:55], v[190:191], v[152:153] op_sel:[0,0,0] op_sel_hi:[0,1,1]
    v_pk_fma_f32 v[144:145], v[54:55], v[190:191], v[144:145] op_sel:[1,0,0] op_sel_hi:[1,1,1] neg_lo:[1,0,0] neg_hi:[1,0,0]
    v_pk_fma_f32 v[152:153], v[54:55], v[188:189], v[152:153] op_sel:[1,0,0] op_sel_hi:[1,1,1]
    v_pk_fma_f32 v[146:147], v[54:55], v[144:145], v[146:147] op_sel:[0,0,0] op_sel_hi:[0,1,1]
    v_pk_fma_f32 v[154:155], v[54:55], v[152:153], v[154:155] op_sel:[0,0,0] op_sel_hi:[0,1,1]
    v_pk_fma_f32 v[146:147], v[54:55], v[152:153], v[146:147] op_sel:[1,0,0] op_sel_hi:[1,1,1] neg_lo:[1,0,0] neg_hi:[1,0,0]
    v_pk_fma_f32 v[154:155], v[54:55], v[144:145], v[154:155] op_sel:[1,0,0] op_sel_hi:[1,1,1]
    v_pk_fma_f32 v[148:149], v[54:55], v[146:147], v[148:149] op_sel:[0,0,0] op_sel_hi:[0,1,1]
    v_pk_fma_f32 v[156:157], v[54:55], v[154:155], v[156:157] op_sel:[0,0,0] op_sel_hi:[0,1,1]
    v_pk_fma_f32 v[148:149], v[54:55], v[154:155], v[148:149] op_sel:[1,0,0] op_sel_hi:[1,1,1] neg_lo:[1,0,0] neg_hi:[1,0,0]
    v_pk_fma_f32 v[156:157], v[54:55], v[146:147], v[156:157] op_sel:[1,0,0] op_sel_hi:[1,1,1]
    v_pk_fma_f32 v[150:151], v[54:55], v[148:149], v[150:151] op_sel:[0,0,0] op_sel_hi:[0,1,1]
    v_pk_fma_f32 v[158:159], v[54:55], v[156:157], v[158:159] op_sel:[0,0,0] op_sel_hi:[0,1,1]
    v_pk_fma_f32 v[150:151], v[54:55], v[156:157], v[150:151] op_sel:[1,0,0] op_sel_hi:[1,1,1] neg_lo:[1,0,0] neg_hi:[1,0,0]
    v_pk_fma_f32 v[158:159], v[54:55], v[148:149], v[158:159] op_sel:[1,0,0] op_sel_hi:[1,1,1]
    v_cvt_pk_bf16_f32 v12, v144, v145
    v_cvt_pk_bf16_f32 v13, v146, v147
    ds_write_b64 v7, v[12:13] offset:0
    v_cvt_pk_bf16_f32 v14, -v152, -v153
    v_cvt_pk_bf16_f32 v15, -v154, -v155
    ds_write_b64 v7, v[14:15] offset:512
    v_cvt_pk_bf16_f32 v12, v148, v149
    v_cvt_pk_bf16_f32 v13, v150, v151
    ds_write_b64 v7, v[12:13] offset:1024
    v_cvt_pk_bf16_f32 v14, -v156, -v157
    v_cvt_pk_bf16_f32 v15, -v158, -v159
    ds_write_b64 v7, v[14:15] offset:1536
    ds_read_b64_tr_b16 v[224:225], v8 offset:0
    ds_read_b64_tr_b16 v[226:227], v9 offset:0
    ds_read_b64_tr_b16 v[228:229], v8 offset:1024
    ds_read_b64_tr_b16 v[230:231], v9 offset:1024
    s_waitcnt lgkmcnt(10)
    buffer_store_dwordx4 v[216:219], v2, s[52:55], s13 offen offset:2048 sc1
    s_waitcnt lgkmcnt(8)
    buffer_store_dwordx4 v[220:223], v44, s[52:55], s13 offen offset:2048 sc1
    v_fma_f32 v212, v86, v214, v212
    v_fma_f32 v213, v86, v215, v213
    v_fma_f32 v212, -v87, v215, v212
    v_fma_f32 v213, v87, v214, v213
    v_fma_f32 v193, v66, v212, v192
    v_fma_f32 v195, v66, v213, v194
    v_fma_f32 v193, -v67, v213, v193
    v_fma_f32 v195, v67, v212, v195
    v_mov_b32 v192, v212
    v_mov_b32 v194, v213
    v_pk_fma_f32 v[160:161], v[56:57], v[192:193], v[160:161] op_sel:[0,0,0] op_sel_hi:[0,1,1]
    v_pk_fma_f32 v[168:169], v[56:57], v[194:195], v[168:169] op_sel:[0,0,0] op_sel_hi:[0,1,1]
    v_pk_fma_f32 v[160:161], v[56:57], v[194:195], v[160:161] op_sel:[1,0,0] op_sel_hi:[1,1,1] neg_lo:[1,0,0] neg_hi:[1,0,0]
    v_pk_fma_f32 v[168:169], v[56:57], v[192:193], v[168:169] op_sel:[1,0,0] op_sel_hi:[1,1,1]
    v_pk_fma_f32 v[162:163], v[56:57], v[160:161], v[162:163] op_sel:[0,0,0] op_sel_hi:[0,1,1]
    v_pk_fma_f32 v[170:171], v[56:57], v[168:169], v[170:171] op_sel:[0,0,0] op_sel_hi:[0,1,1]
    v_pk_fma_f32 v[162:163], v[56:57], v[168:169], v[162:163] op_sel:[1,0,0] op_sel_hi:[1,1,1] neg_lo:[1,0,0] neg_hi:[1,0,0]
    v_pk_fma_f32 v[170:171], v[56:57], v[160:161], v[170:171] op_sel:[1,0,0] op_sel_hi:[1,1,1]
    v_pk_fma_f32 v[164:165], v[56:57], v[162:163], v[164:165] op_sel:[0,0,0] op_sel_hi:[0,1,1]
    v_pk_fma_f32 v[172:173], v[56:57], v[170:171], v[172:173] op_sel:[0,0,0] op_sel_hi:[0,1,1]
    v_pk_fma_f32 v[164:165], v[56:57], v[170:171], v[164:165] op_sel:[1,0,0] op_sel_hi:[1,1,1] neg_lo:[1,0,0] neg_hi:[1,0,0]
    v_pk_fma_f32 v[172:173], v[56:57], v[162:163], v[172:173] op_sel:[1,0,0] op_sel_hi:[1,1,1]
    v_pk_fma_f32 v[166:167], v[56:57], v[164:165], v[166:167] op_sel:[0,0,0] op_sel_hi:[0,1,1]
    v_pk_fma_f32 v[174:175], v[56:57], v[172:173], v[174:175] op_sel:[0,0,0] op_sel_hi:[0,1,1]
    v_pk_fma_f32 v[166:167], v[56:57], v[172:173], v[166:167] op_sel:[1,0,0] op_sel_hi:[1,1,1] neg_lo:[1,0,0] neg_hi:[1,0,0]
    v_pk_fma_f32 v[174:175], v[56:57], v[164:165], v[174:175] op_sel:[1,0,0] op_sel_hi:[1,1,1]
    v_cvt_pk_bf16_f32 v12, v160, v161
    v_cvt_pk_bf16_f32 v13, v162, v163
    ds_write_b64 v7, v[12:13] offset:0
    v_cvt_pk_bf16_f32 v14, -v168, -v169
    v_cvt_pk_bf16_f32 v15, -v170, -v171
    ds_write_b64 v7, v[14:15] offset:512
    v_cvt_pk_bf16_f32 v12, v164, v165
    v_cvt_pk_bf16_f32 v13, v166, v167
    ds_write_b64 v7, v[12:13] offset:1024
    v_cvt_pk_bf16_f32 v14, -v172, -v173
    v_cvt_pk_bf16_f32 v15, -v174, -v175
    ds_write_b64 v7, v[14:15] offset:1536
    ds_read_b64_tr_b16 v[216:217], v8 offset:0
    ds_read_b64_tr_b16 v[218:219], v9 offset:0
    ds_read_b64_tr_b16 v[220:221], v8 offset:1024
    ds_read_b64_tr_b16 v[222:223], v9 offset:1024
    s_waitcnt lgkmcnt(10)
    buffer_store_dwordx4 v[224:227], v2, s[52:55], s13 offen offset:3072 sc1
    s_waitcnt lgkmcnt(8)
    buffer_store_dwordx4 v[228:231], v44, s[52:55], s13 offen offset:3072 sc1
    s_add_u32 s13, s13, 4096
    s_waitcnt lgkmcnt(2)
    buffer_store_dwordx4 v[216:219], v2, s[52:55], s13 offen offset:0 sc1
    s_waitcnt lgkmcnt(0)
    buffer_store_dwordx4 v[220:223], v44, s[52:55], s13 offen offset:0 sc1
    v_and_b32 v12, 15, v1
    v_lshrrev_b32 v13, 4, v1
    v_lshl_add_u32 v14, v12, 2, v13
    v_lshlrev_b32 v14, 2, v14
    v_and_b32 v13, 1, v13
    v_lshl_add_u32 v13, v12, 1, v13
    v_lshlrev_b32 v13, 2, v13
    v_add_u32 v13, 0x80, v13
    s_waitcnt vmcnt(36)
    ds_bpermute_b32 a176, v14, a160
    ds_bpermute_b32 a177, v14, a161
    ds_bpermute_b32 a178, v14, a162
    ds_bpermute_b32 a179, v14, a163
    s_waitcnt vmcnt(33)
    ds_bpermute_b32 a180, v14, a164
    ds_bpermute_b32 a181, v14, a165
    ds_bpermute_b32 a182, v14, a166
    ds_bpermute_b32 a183, v14, a167
    ds_bpermute_b32 a184, v14, a168
    ds_bpermute_b32 a185, v14, a169
    ds_bpermute_b32 a186, v14, a170
    ds_bpermute_b32 a187, v14, a171
    s_waitcnt vmcnt(32)
    ds_bpermute_b32 a188, v14, a172
    ds_bpermute_b32 a189, v14, a173
    ds_bpermute_b32 a190, v14, a174
    ds_bpermute_b32 a191, v14, a175
    s_mov_b32 exec_lo, 0
    s_waitcnt vmcnt(31)
    ds_bpermute_b32 a192, v13, a200
    ds_bpermute_b32 a193, v13, a201
    ds_bpermute_b32 a194, v13, a202
    ds_bpermute_b32 a195, v13, a203
    s_waitcnt vmcnt(30)
    ds_bpermute_b32 a196, v13, a204
    ds_bpermute_b32 a197, v13, a205
    ds_bpermute_b32 a198, v13, a206
    ds_bpermute_b32 a199, v13, a207
    s_mov_b64 exec, -1
    s_waitcnt vmcnt(0)
    s_waitcnt lgkmcnt(0)
    s_barrier
    s_cmp_lg_u32 s5, 0
    s_cbranch_scc1 L_nosend_12
    v_add_u32 v5, 48, v3
    s_lshl_b32 s11, s4, 2
    s_add_u32 s11, s11, 384
    s_mov_b64 exec, 0xff
    buffer_store_dword v5, v4, s[52:55], s11 offen sc1
    s_mov_b64 exec, -1
L_nosend_12:
    v_and_b32 v12, 15, v1
    v_lshrrev_b32 v13, 1, v12
    v_bfe_u32 v14, v1, 4, 1
    v_lshlrev_b32 v14, 2, v14
    v_sub_u32 v13, v13, v14
    v_and_b32 v12, 1, v12
    v_lshlrev_b32 v12, 4, v12
    v_cmp_eq_u32 s[90:91], 0, v13
    v_cmp_eq_u32 s[92:93], 1, v13
    v_cmp_eq_u32 s[94:95], 2, v13
    v_cmp_eq_u32 s[96:97], 3, v13
    v_cmp_gt_u32 vcc, 32, v1
    v_mov_b32 v15, 0x3f80
    s_nop 0
    v_cndmask_b32 v14, 0, v250, vcc
    v_lshlrev_b32 v14, v12, v14
    v_cndmask_b32 v196, 0, v14, s[90:91]
    v_cndmask_b32 v197, 0, v14, s[92:93]
    v_cndmask_b32 v198, 0, v14, s[94:95]
    v_cndmask_b32 v199, 0, v14, s[96:97]
    v_cndmask_b32 v14, v251, 0, vcc
    v_lshlrev_b32 v14, v12, v14
    v_cndmask_b32 v200, 0, v14, s[90:91]
    v_cndmask_b32 v201, 0, v14, s[92:93]
    v_cndmask_b32 v202, 0, v14, s[94:95]
    v_cndmask_b32 v203, 0, v14, s[96:97]
    v_cndmask_b32 v14, 0, v252, vcc
    v_lshlrev_b32 v14, v12, v14
    v_cndmask_b32 v204, 0, v14, s[90:91]
    v_cndmask_b32 v205, 0, v14, s[92:93]
    v_cndmask_b32 v206, 0, v14, s[94:95]
    v_cndmask_b32 v207, 0, v14, s[96:97]
    v_cndmask_b32 v14, v253, 0, vcc
    v_lshlrev_b32 v14, v12, v14
    v_cndmask_b32 v208, 0, v14, s[90:91]
    v_cndmask_b32 v209, 0, v14, s[92:93]
    v_cndmask_b32 v210, 0, v14, s[94:95]
    v_cndmask_b32 v211, 0, v14, s[96:97]
    v_cndmask_b32 v14, v15, v254, vcc
    v_lshlrev_b32 v14, v12, v14
    v_cndmask_b32 v212, 0, v14, s[90:91]
    v_cndmask_b32 v213, 0, v14, s[92:93]
    v_cndmask_b32 v214, 0, v14, s[94:95]
    v_cndmask_b32 v215, 0, v14, s[96:97]
    v_cndmask_b32 v14, 0, v15, vcc
    v_lshlrev_b32 v14, v12, v14
    v_cndmask_b32 v216, 0, v14, s[90:91]
    v_cndmask_b32 v217, 0, v14, s[92:93]
    v_cndmask_b32 v218, 0, v14, s[94:95]
    v_cndmask_b32 v219, 0, v14, s[96:97]
    v_cndmask_b32 v14, v15, 0, vcc
    v_lshlrev_b32 v14, v12, v14
    v_cndmask_b32 v220, 0, v14, s[90:91]
    v_cndmask_b32 v221, 0, v14, s[92:93]
    v_cndmask_b32 v222, 0, v14, s[94:95]
    v_cndmask_b32 v223, 0, v14, s[96:97]
    v_mfma_f32_16x16x32_bf16 v[96:99], a[144:147], v[196:199], 0
    v_mfma_f32_16x16x32_bf16 v[100:103], a[148:151], v[196:199], 0
    v_mfma_f32_16x16x32_bf16 v[104:107], a[144:147], v[200:203], 0
    v_mfma_f32_16x16x32_bf16 v[108:111], a[148:151], v[200:203], 0
    v_mfma_f32_16x16x32_bf16 v[112:115], a[152:155], v[204:207], 0
    v_mfma_f32_16x16x32_bf16 v[116:119], a[156:159], v[204:207], 0
    v_mfma_f32_16x16x32_bf16 v[120:123], a[152:155], v[208:211], 0
    v_mfma_f32_16x16x32_bf16 v[124:127], a[156:159], v[208:211], 0
    v_mfma_f32_16x16x32_bf16 v[128:131], a[192:195], v[212:215], 0
    v_mfma_f32_16x16x32_bf16 v[132:135], a[196:199], v[212:215], 0
    v_mfma_f32_16x16x32_bf16 v[96:99], a[176:179], v[216:219], v[96:99]
    v_mfma_f32_16x16x32_bf16 v[100:103], a[180:183], v[216:219], v[100:103]
    v_mfma_f32_16x16x32_bf16 v[104:107], a[176:179], v[220:223], v[104:107]
    v_mfma_f32_16x16x32_bf16 v[108:111], a[180:183], v[220:223], v[108:111]
    v_mfma_f32_16x16x32_bf16 v[112:115], a[184:187], v[216:219], v[112:115]
    v_mfma_f32_16x16x32_bf16 v[116:119], a[188:191], v[216:219], v[116:119]
    v_mfma_f32_16x16x32_bf16 v[120:123], a[184:187], v[220:223], v[120:123]
    v_mfma_f32_16x16x32_bf16 v[124:127], a[188:191], v[220:223], v[124:127]
    s_and_b32 s11, s3, 3
    s_mul_i32 s11, s11, 10
    s_lshr_b32 s11, s11, 2
    s_lshr_b32 s12, s3, 2
    s_add_u32 s11, s11, s12
    s_mul_hi_u32 s12, s11, 429496730
    s_mul_i32 s12, s12, 10
    s_sub_u32 s11, s11, s12
    s_mul_i32 s83, s11, 4096
    s_add_u32 s83, s83, s84
    v_and_b32 v13, 7, v1
    v_lshlrev_b32 v13, 2, v13
    s_add_u32 s11, s9, 384
    s_add_u32 s12, s7, 48
L_poll_13:
    buffer_load_dword v12, v13, s[52:55], s11 offen sc1
    s_cmp_eq_u32 s10, 0
    s_waitcnt vmcnt(0)
    s_cbranch_scc1 L_polled_14
    s_sub_u32 s10, s10, 1
    v_cmp_eq_u32 vcc, s12, v12
    s_nop 0
    s_cmp_eq_u64 vcc, exec
    s_cbranch_scc0 L_poll_13
L_polled_14:
    buffer_load_dwordx4 a[0:3], v2, s[52:55], s83 offen offset:0 sc1
    buffer_load_dwordx4 a[4:7], v44, s[52:55], s83 offen offset:0 sc1
    buffer_load_dwordx4 a[8:11], v2, s[52:55], s83 offen offset:1024 sc1
    buffer_load_dwordx4 a[12:15], v44, s[52:55], s83 offen offset:1024 sc1
    buffer_load_dwordx4 a[16:19], v2, s[52:55], s83 offen offset:2048 sc1
    buffer_load_dwordx4 a[20:23], v44, s[52:55], s83 offen offset:2048 sc1
    buffer_load_dwordx4 a[24:27], v2, s[52:55], s83 offen offset:3072 sc1
    buffer_load_dwordx4 a[28:31], v44, s[52:55], s83 offen offset:3072 sc1
    s_add_u32 s83, s83, 4096
    s_cmp_eq_u32 s83, s85
    s_cselect_b32 s83, s84, s83
    ds_read_b128 a[64:67], v36 offset:0
    ds_read_b128 a[68:71], v36 offset:2048
    ds_read_b128 a[72:75], v36 offset:4096
    ds_read_b128 a[76:79], v36 offset:6144
    ds_read_b128 a[80:83], v36 offset:8192
    s_waitcnt vmcnt(6) lgkmcnt(2)
    v_mfma_f32_16x16x32_bf16 v[96:99], a[0:3], a[64:67], v[96:99]
    ds_read_b128 a[84:87], v37 offset:0
    v_mfma_f32_16x16x32_bf16 v[100:103], a[4:7], a[64:67], v[100:103]
    ds_read_b128 a[88:91], v37 offset:2048
    v_mfma_f32_16x16x32_bf16 v[104:107], a[0:3], a[68:71], v[104:107]
    buffer_load_dwordx4 a[32:35], v2, s[52:55], s83 offen offset:0 sc1
    v_mfma_f32_16x16x32_bf16 v[108:111], a[4:7], a[68:71], v[108:111]
    ds_read_b128 a[92:95], v37 offset:4096
    v_mfma_f32_16x16x32_bf16 v[112:115], a[0:3], a[72:75], v[112:115]
    ds_read_b128 a[96:99], v37 offset:6144
    s_waitcnt lgkmcnt(4)
    v_mfma_f32_16x16x32_bf16 v[116:119], a[4:7], a[72:75], v[116:119]
    v_mfma_f32_16x16x32_bf16 v[120:123], a[0:3], a[76:79], v[120:123]
    ds_read_b128 a[100:103], v37 offset:8192
    v_mfma_f32_16x16x32_bf16 v[124:127], a[4:7], a[76:79], v[124:127]
    buffer_load_dwordx4 a[36:39], v44, s[52:55], s83 offen offset:0 sc1
    v_mfma_f32_16x16x32_bf16 v[128:131], a[0:3], a[80:83], v[128:131]
    v_mfma_f32_16x16x32_bf16 v[132:135], a[4:7], a[80:83], v[132:135]
    s_waitcnt vmcnt(6) lgkmcnt(2)
    v_mfma_f32_16x16x32_bf16 v[96:99], a[8:11], a[84:87], v[96:99]
    ds_read_b128 a[64:67], v38 offset:0
    v_mfma_f32_16x16x32_bf16 v[100:103], a[12:15], a[84:87], v[100:103]
    ds_read_b128 a[68:71], v38 offset:2048
    buffer_load_dwordx4 a[40:43], v2, s[52:55], s83 offen offset:1024 sc1
    v_mfma_f32_16x16x32_bf16 v[104:107], a[8:11], a[88:91], v[104:107]
    v_mfma_f32_16x16x32_bf16 v[108:111], a[12:15], a[88:91], v[108:111]
    ds_read_b128 a[72:75], v38 offset:4096
    v_mfma_f32_16x16x32_bf16 v[112:115], a[8:11], a[92:95], v[112:115]
    ds_read_b128 a[76:79], v38 offset:6144
    s_waitcnt lgkmcnt(4)
    v_mfma_f32_16x16x32_bf16 v[116:119], a[12:15], a[92:95], v[116:119]
    buffer_load_dwordx4 a[44:47], v44, s[52:55], s83 offen offset:1024 sc1
    v_mfma_f32_16x16x32_bf16 v[120:123], a[8:11], a[96:99], v[120:123]
    ds_read_b128 a[80:83], v38 offset:8192
    v_mfma_f32_16x16x32_bf16 v[124:127], a[12:15], a[96:99], v[124:127]
    v_mfma_f32_16x16x32_bf16 v[128:131], a[8:11], a[100:103], v[128:131]
    buffer_load_dwordx4 a[48:51], v2, s[52:55], s83 offen offset:2048 sc1
    v_mfma_f32_16x16x32_bf16 v[132:135], a[12:15], a[100:103], v[132:135]
    s_waitcnt vmcnt(7) lgkmcnt(2)
    v_mfma_f32_16x16x32_bf16 v[96:99], a[16:19], a[64:67], v[96:99]
    ds_read_b128 a[84:87], v39 offset:0
    v_mfma_f32_16x16x32_bf16 v[100:103], a[20:23], a[64:67], v[100:103]
    ds_read_b128 a[88:91], v39 offset:2048
    buffer_load_dwordx4 a[52:55], v44, s[52:55], s83 offen offset:2048 sc1
    v_mfma_f32_16x16x32_bf16 v[104:107], a[16:19], a[68:71], v[104:107]
    v_mfma_f32_16x16x32_bf16 v[108:111], a[20:23], a[68:71], v[108:111]
    ds_read_b128 a[92:95], v39 offset:4096
    v_mfma_f32_16x16x32_bf16 v[112:115], a[16:19], a[72:75], v[112:115]
    ds_read_b128 a[96:99], v39 offset:6144
    s_waitcnt lgkmcnt(4)
    v_mfma_f32_16x16x32_bf16 v[116:119], a[20:23], a[72:75], v[116:119]
    buffer_load_dwordx4 a[56:59], v2, s[52:55], s83 offen offset:3072 sc1
    v_mfma_f32_16x16x32_bf16 v[120:123], a[16:19], a[76:79], v[120:123]
    ds_read_b128 a[100:103], v39 offset:8192
    v_mfma_f32_16x16x32_bf16 v[124:127], a[20:23], a[76:79], v[124:127]
    v_mfma_f32_16x16x32_bf16 v[128:131], a[16:19], a[80:83], v[128:131]
    buffer_load_dwordx4 a[60:63], v44, s[52:55], s83 offen offset:3072 sc1
    s_add_u32 s83, s83, 4096
    s_cmp_eq_u32 s83, s85
    s_cselect_b32 s83, s84, s83
    v_mfma_f32_16x16x32_bf16 v[132:135], a[20:23], a[80:83], v[132:135]
    s_barrier
    s_waitcnt vmcnt(8) lgkmcnt(2)
    v_mfma_f32_16x16x32_bf16 v[96:99], a[24:27], a[84:87], v[96:99]
    ds_read_b128 a[64:67], v36 offset:20480
    v_mfma_f32_16x16x32_bf16 v[100:103], a[28:31], a[84:87], v[100:103]
    ds_read_b128 a[68:71], v36 offset:22528
    buffer_load_dwordx4 a[144:147], v2, s[52:55], s83 offen offset:0 sc1
    v_mfma_f32_16x16x32_bf16 v[104:107], a[24:27], a[88:91], v[104:107]
    v_mfma_f32_16x16x32_bf16 v[108:111], a[28:31], a[88:91], v[108:111]
    ds_read_b128 a[72:75], v36 offset:24576
    v_mfma_f32_16x16x32_bf16 v[112:115], a[24:27], a[92:95], v[112:115]
    ds_read_b128 a[76:79], v36 offset:26624
    s_waitcnt lgkmcnt(4)
    v_mfma_f32_16x16x32_bf16 v[116:119], a[28:31], a[92:95], v[116:119]
    buffer_load_dwordx4 a[148:151], v44, s[52:55], s83 offen offset:0 sc1
    v_mfma_f32_16x16x32_bf16 v[120:123], a[24:27], a[96:99], v[120:123]
    ds_read_b128 a[80:83], v36 offset:28672
    v_mfma_f32_16x16x32_bf16 v[124:127], a[28:31], a[96:99], v[124:127]
    v_mfma_f32_16x16x32_bf16 v[128:131], a[24:27], a[100:103], v[128:131]
    buffer_load_dwordx4 a[152:155], v2, s[52:55], s83 offen offset:1024 sc1
    v_mfma_f32_16x16x32_bf16 v[132:135], a[28:31], a[100:103], v[132:135]
    s_waitcnt vmcnt(9) lgkmcnt(2)
    v_mfma_f32_16x16x32_bf16 v[96:99], a[32:35], a[64:67], v[96:99]
    ds_read_b128 a[84:87], v37 offset:20480
    v_mfma_f32_16x16x32_bf16 v[100:103], a[36:39], a[64:67], v[100:103]
    ds_read_b128 a[88:91], v37 offset:22528
    buffer_load_dwordx4 a[156:159], v44, s[52:55], s83 offen offset:1024 sc1
    v_mfma_f32_16x16x32_bf16 v[104:107], a[32:35], a[68:71], v[104:107]
    v_mfma_f32_16x16x32_bf16 v[108:111], a[36:39], a[68:71], v[108:111]
    ds_read_b128 a[92:95], v37 offset:24576
    v_mfma_f32_16x16x32_bf16 v[112:115], a[32:35], a[72:75], v[112:115]
    ds_read_b128 a[96:99], v37 offset:26624
    s_waitcnt lgkmcnt(4)
    v_mfma_f32_16x16x32_bf16 v[116:119], a[36:39], a[72:75], v[116:119]
    buffer_load_dwordx4 a[160:163], v2, s[52:55], s83 offen offset:2048 sc1
    v_mfma_f32_16x16x32_bf16 v[120:123], a[32:35], a[76:79], v[120:123]
    ds_read_b128 a[100:103], v37 offset:28672
    v_mfma_f32_16x16x32_bf16 v[124:127], a[36:39], a[76:79], v[124:127]
    v_mfma_f32_16x16x32_bf16 v[128:131], a[32:35], a[80:83], v[128:131]
    buffer_load_dwordx4 a[164:167], v44, s[52:55], s83 offen offset:2048 sc1
    v_mfma_f32_16x16x32_bf16 v[132:135], a[36:39], a[80:83], v[132:135]
    s_waitcnt vmcnt(10) lgkmcnt(2)
    v_mfma_f32_16x16x32_bf16 v[96:99], a[40:43], a[84:87], v[96:99]
    ds_read_b128 a[64:67], v38 offset:20480
    v_mfma_f32_16x16x32_bf16 v[100:103], a[44:47], a[84:87], v[100:103]
    ds_read_b128 a[68:71], v38 offset:22528
    buffer_load_dwordx4 a[168:171], v2, s[52:55], s83 offen offset:3072 sc1
    v_mfma_f32_16x16x32_bf16 v[104:107], a[40:43], a[88:91], v[104:107]
    v_mfma_f32_16x16x32_bf16 v[108:111], a[44:47], a[88:91], v[108:111]
    ds_read_b128 a[72:75], v38 offset:24576
    v_mfma_f32_16x16x32_bf16 v[112:115], a[40:43], a[92:95], v[112:115]
    ds_read_b128 a[76:79], v38 offset:26624
    s_waitcnt lgkmcnt(4)
    v_mfma_f32_16x16x32_bf16 v[116:119], a[44:47], a[92:95], v[116:119]
    buffer_load_dwordx4 a[172:175], v44, s[52:55], s83 offen offset:3072 sc1
    s_add_u32 s83, s83, 4096
    s_cmp_eq_u32 s83, s85
    s_cselect_b32 s83, s84, s83
    v_mfma_f32_16x16x32_bf16 v[120:123], a[40:43], a[96:99], v[120:123]
    ds_read_b128 a[80:83], v38 offset:28672
    v_mfma_f32_16x16x32_bf16 v[124:127], a[44:47], a[96:99], v[124:127]
    v_mfma_f32_16x16x32_bf16 v[128:131], a[40:43], a[100:103], v[128:131]
    buffer_load_dwordx4 a[176:179], v2, s[52:55], s83 offen offset:0 sc1
    v_mfma_f32_16x16x32_bf16 v[132:135], a[44:47], a[100:103], v[132:135]
    s_waitcnt vmcnt(11) lgkmcnt(2)
    v_mfma_f32_16x16x32_bf16 v[96:99], a[48:51], a[64:67], v[96:99]
    ds_read_b128 a[84:87], v39 offset:20480
    v_mfma_f32_16x16x32_bf16 v[100:103], a[52:55], a[64:67], v[100:103]
    ds_read_b128 a[88:91], v39 offset:22528
    buffer_load_dwordx4 a[180:183], v44, s[52:55], s83 offen offset:0 sc1
    v_mfma_f32_16x16x32_bf16 v[104:107], a[48:51], a[68:71], v[104:107]
    v_mfma_f32_16x16x32_bf16 v[108:111], a[52:55], a[68:71], v[108:111]
    ds_read_b128 a[92:95], v39 offset:24576
    v_mfma_f32_16x16x32_bf16 v[112:115], a[48:51], a[72:75], v[112:115]
    ds_read_b128 a[96:99], v39 offset:26624
    s_waitcnt lgkmcnt(4)
    v_mfma_f32_16x16x32_bf16 v[116:119], a[52:55], a[72:75], v[116:119]
    buffer_load_dwordx4 a[184:187], v2, s[52:55], s83 offen offset:1024 sc1
    v_mfma_f32_16x16x32_bf16 v[120:123], a[48:51], a[76:79], v[120:123]
    ds_read_b128 a[100:103], v39 offset:28672
    v_mfma_f32_16x16x32_bf16 v[124:127], a[52:55], a[76:79], v[124:127]
    v_mfma_f32_16x16x32_bf16 v[128:131], a[48:51], a[80:83], v[128:131]
    buffer_load_dwordx4 a[188:191], v44, s[52:55], s83 offen offset:1024 sc1
    v_mfma_f32_16x16x32_bf16 v[132:135], a[52:55], a[80:83], v[132:135]
    s_barrier
    s_waitcnt vmcnt(12) lgkmcnt(2)
    v_mfma_f32_16x16x32_bf16 v[96:99], a[56:59], a[84:87], v[96:99]
    ds_read_b128 a[64:67], v36 offset:40960
    v_mfma_f32_16x16x32_bf16 v[100:103], a[60:63], a[84:87], v[100:103]
    ds_read_b128 a[68:71], v36 offset:43008
    buffer_load_dwordx4 a[192:195], v2, s[52:55], s83 offen offset:2048 sc1
    v_mfma_f32_16x16x32_bf16 v[104:107], a[56:59], a[88:91], v[104:107]
    v_mfma_f32_16x16x32_bf16 v[108:111], a[60:63], a[88:91], v[108:111]
    ds_read_b128 a[72:75], v36 offset:45056
    v_mfma_f32_16x16x32_bf16 v[112:115], a[56:59], a[92:95], v[112:115]
    ds_read_b128 a[76:79], v36 offset:47104
    s_waitcnt lgkmcnt(4)
    v_mfma_f32_16x16x32_bf16 v[116:119], a[60:63], a[92:95], v[116:119]
    buffer_load_dwordx4 a[196:199], v44, s[52:55], s83 offen offset:2048 sc1
    v_mfma_f32_16x16x32_bf16 v[120:123], a[56:59], a[96:99], v[120:123]
    ds_read_b128 a[80:83], v36 offset:49152
    v_mfma_f32_16x16x32_bf16 v[124:127], a[60:63], a[96:99], v[124:127]
    v_mfma_f32_16x16x32_bf16 v[128:131], a[56:59], a[100:103], v[128:131]
    buffer_load_dwordx4 a[200:203], v2, s[52:55], s83 offen offset:3072 sc1
    v_mfma_f32_16x16x32_bf16 v[132:135], a[60:63], a[100:103], v[132:135]
    s_waitcnt vmcnt(13) lgkmcnt(2)
    v_mfma_f32_16x16x32_bf16 v[96:99], a[144:147], a[64:67], v[96:99]
    ds_read_b128 a[84:87], v37 offset:40960
    v_mfma_f32_16x16x32_bf16 v[100:103], a[148:151], a[64:67], v[100:103]
    ds_read_b128 a[88:91], v37 offset:43008
    v_mfma_f32_16x16x32_bf16 v[104:107], a[144:147], a[68:71], v[104:107]
    buffer_load_dwordx4 a[204:207], v44, s[52:55], s83 offen offset:3072 sc1
    s_add_u32 s83, s83, 4096
    s_cmp_eq_u32 s83, s85
    s_cselect_b32 s83, s84, s83
    v_mfma_f32_16x16x32_bf16 v[108:111], a[148:151], a[68:71], v[108:111]
    ds_read_b128 a[92:95], v37 offset:45056
    v_mfma_f32_16x16x32_bf16 v[112:115], a[144:147], a[72:75], v[112:115]
    ds_read_b128 a[96:99], v37 offset:47104
    s_waitcnt lgkmcnt(4)
    v_mfma_f32_16x16x32_bf16 v[116:119], a[148:151], a[72:75], v[116:119]
    v_mfma_f32_16x16x32_bf16 v[120:123], a[144:147], a[76:79], v[120:123]
    ds_read_b128 a[100:103], v37 offset:49152
    v_mfma_f32_16x16x32_bf16 v[124:127], a[148:151], a[76:79], v[124:127]
    buffer_load_dwordx4 a[0:3], v2, s[52:55], s83 offen offset:0 sc1
    v_mfma_f32_16x16x32_bf16 v[128:131], a[144:147], a[80:83], v[128:131]
    v_mfma_f32_16x16x32_bf16 v[132:135], a[148:151], a[80:83], v[132:135]
    s_waitcnt vmcnt(13) lgkmcnt(2)
    v_mfma_f32_16x16x32_bf16 v[96:99], a[152:155], a[84:87], v[96:99]
    ds_read_b128 a[64:67], v38 offset:40960
    v_mfma_f32_16x16x32_bf16 v[100:103], a[156:159], a[84:87], v[100:103]
    ds_read_b128 a[68:71], v38 offset:43008
    buffer_load_dwordx4 a[4:7], v44, s[52:55], s83 offen offset:0 sc1
    v_mfma_f32_16x16x32_bf16 v[104:107], a[152:155], a[88:91], v[104:107]
    v_mfma_f32_16x16x32_bf16 v[108:111], a[156:159], a[88:91], v[108:111]
    ds_read_b128 a[72:75], v38 offset:45056
    v_mfma_f32_16x16x32_bf16 v[112:115], a[152:155], a[92:95], v[112:115]
    ds_read_b128 a[76:79], v38 offset:47104
    s_waitcnt lgkmcnt(4)
    v_mfma_f32_16x16x32_bf16 v[116:119], a[156:159], a[92:95], v[116:119]
    buffer_load_dwordx4 a[8:11], v2, s[52:55], s83 offen offset:1024 sc1
    v_mfma_f32_16x16x32_bf16 v[120:123], a[152:155], a[96:99], v[120:123]
    ds_read_b128 a[80:83], v38 offset:49152
    v_mfma_f32_16x16x32_bf16 v[124:127], a[156:159], a[96:99], v[124:127]
    v_mfma_f32_16x16x32_bf16 v[128:131], a[152:155], a[100:103], v[128:131]
    buffer_load_dwordx4 a[12:15], v44, s[52:55], s83 offen offset:1024 sc1
    v_mfma_f32_16x16x32_bf16 v[132:135], a[156:159], a[100:103], v[132:135]
    s_waitcnt vmcnt(14) lgkmcnt(2)
    v_mfma_f32_16x16x32_bf16 v[96:99], a[160:163], a[64:67], v[96:99]
    ds_read_b128 a[84:87], v39 offset:40960
    v_mfma_f32_16x16x32_bf16 v[100:103], a[164:167], a[64:67], v[100:103]
    ds_read_b128 a[88:91], v39 offset:43008
    buffer_load_dwordx4 a[16:19], v2, s[52:55], s83 offen offset:2048 sc1
    v_mfma_f32_16x16x32_bf16 v[104:107], a[160:163], a[68:71], v[104:107]
    v_mfma_f32_16x16x32_bf16 v[108:111], a[164:167], a[68:71], v[108:111]
    ds_read_b128 a[92:95], v39 offset:45056
    v_mfma_f32_16x16x32_bf16 v[112:115], a[160:163], a[72:75], v[112:115]
    ds_read_b128 a[96:99], v39 offset:47104
    s_waitcnt lgkmcnt(4)
    v_mfma_f32_16x16x32_bf16 v[116:119], a[164:167], a[72:75], v[116:119]
    buffer_load_dwordx4 a[20:23], v44, s[52:55], s83 offen offset:2048 sc1
    v_mfma_f32_16x16x32_bf16 v[120:123], a[160:163], a[76:79], v[120:123]
    ds_read_b128 a[100:103], v39 offset:49152
    v_mfma_f32_16x16x32_bf16 v[124:127], a[164:167], a[76:79], v[124:127]
    v_mfma_f32_16x16x32_bf16 v[128:131], a[160:163], a[80:83], v[128:131]
    buffer_load_dwordx4 a[24:27], v2, s[52:55], s83 offen offset:3072 sc1
    v_mfma_f32_16x16x32_bf16 v[132:135], a[164:167], a[80:83], v[132:135]
    s_barrier
    s_waitcnt vmcnt(15) lgkmcnt(2)
    v_mfma_f32_16x16x32_bf16 v[96:99], a[168:171], a[84:87], v[96:99]
    ds_read_b128 a[64:67], v40 offset:0
    v_mfma_f32_16x16x32_bf16 v[100:103], a[172:175], a[84:87], v[100:103]
    ds_read_b128 a[68:71], v40 offset:2048
    buffer_load_dwordx4 a[28:31], v44, s[52:55], s83 offen offset:3072 sc1
    s_add_u32 s83, s83, 4096
    s_cmp_eq_u32 s83, s85
    s_cselect_b32 s83, s84, s83
    v_mfma_f32_16x16x32_bf16 v[104:107], a[168:171], a[88:91], v[104:107]
    v_mfma_f32_16x16x32_bf16 v[108:111], a[172:175], a[88:91], v[108:111]
    ds_read_b128 a[72:75], v40 offset:4096
    v_mfma_f32_16x16x32_bf16 v[112:115], a[168:171], a[92:95], v[112:115]
    ds_read_b128 a[76:79], v40 offset:6144
    s_waitcnt lgkmcnt(4)
    v_mfma_f32_16x16x32_bf16 v[116:119], a[172:175], a[92:95], v[116:119]
    buffer_load_dwordx4 a[32:35], v2, s[52:55], s83 offen offset:0 sc1
    v_mfma_f32_16x16x32_bf16 v[120:123], a[168:171], a[96:99], v[120:123]
    ds_read_b128 a[80:83], v40 offset:8192
    v_mfma_f32_16x16x32_bf16 v[124:127], a[172:175], a[96:99], v[124:127]
    v_mfma_f32_16x16x32_bf16 v[128:131], a[168:171], a[100:103], v[128:131]
    buffer_load_dwordx4 a[36:39], v44, s[52:55], s83 offen offset:0 sc1
    v_mfma_f32_16x16x32_bf16 v[132:135], a[172:175], a[100:103], v[132:135]
    s_waitcnt vmcnt(16) lgkmcnt(2)
    v_mfma_f32_16x16x32_bf16 v[96:99], a[176:179], a[64:67], v[96:99]
    ds_read_b128 a[84:87], v41 offset:0
    v_mfma_f32_16x16x32_bf16 v[100:103], a[180:183], a[64:67], v[100:103]
    ds_read_b128 a[88:91], v41 offset:2048
    buffer_load_dwordx4 a[40:43], v2, s[52:55], s83 offen offset:1024 sc1
    v_mfma_f32_16x16x32_bf16 v[104:107], a[176:179], a[68:71], v[104:107]
    v_mfma_f32_16x16x32_bf16 v[108:111], a[180:183], a[68:71], v[108:111]
    ds_read_b128 a[92:95], v41 offset:4096
    v_mfma_f32_16x16x32_bf16 v[112:115], a[176:179], a[72:75], v[112:115]
    ds_read_b128 a[96:99], v41 offset:6144
    s_waitcnt lgkmcnt(4)
    v_mfma_f32_16x16x32_bf16 v[116:119], a[180:183], a[72:75], v[116:119]
    buffer_load_dwordx4 a[44:47], v44, s[52:55], s83 offen offset:1024 sc1
    v_mfma_f32_16x16x32_bf16 v[120:123], a[176:179], a[76:79], v[120:123]
    ds_read_b128 a[100:103], v41 offset:8192
    v_mfma_f32_16x16x32_bf16 v[124:127], a[180:183], a[76:79], v[124:127]
    v_mfma_f32_16x16x32_bf16 v[128:131], a[176:179], a[80:83], v[128:131]
    s_add_u32 m0, s86, 40960
    s_nop 0
    buffer_load_dwordx4 v21, s[64:67], s81 offen offset:0 lds
    v_mfma_f32_16x16x32_bf16 v[132:135], a[180:183], a[80:83], v[132:135]
    s_waitcnt vmcnt(17) lgkmcnt(2)
    v_mfma_f32_16x16x32_bf16 v[96:99], a[184:187], a[84:87], v[96:99]
    ds_read_b128 a[64:67], v42 offset:0
    v_mfma_f32_16x16x32_bf16 v[100:103], a[188:191], a[84:87], v[100:103]
    ds_read_b128 a[68:71], v42 offset:2048
    buffer_load_dwordx4 v22, s[64:67], s81 offen offset:1024 lds
    v_mfma_f32_16x16x32_bf16 v[104:107], a[184:187], a[88:91], v[104:107]
    v_mfma_f32_16x16x32_bf16 v[108:111], a[188:191], a[88:91], v[108:111]
    ds_read_b128 a[72:75], v42 offset:4096
    v_mfma_f32_16x16x32_bf16 v[112:115], a[184:187], a[92:95], v[112:115]
    ds_read_b128 a[76:79], v42 offset:6144
    s_waitcnt lgkmcnt(4)
    v_mfma_f32_16x16x32_bf16 v[116:119], a[188:191], a[92:95], v[116:119]
    buffer_load_dwordx4 v23, s[64:67], s81 offen offset:2048 lds
    s_add_u32 m0, s87, 40960
    v_mfma_f32_16x16x32_bf16 v[120:123], a[184:187], a[96:99], v[120:123]
    ds_read_b128 a[80:83], v42 offset:8192
    v_mfma_f32_16x16x32_bf16 v[124:127], a[188:191], a[96:99], v[124:127]
    v_mfma_f32_16x16x32_bf16 v[128:131], a[184:187], a[100:103], v[128:131]
    buffer_load_dwordx4 v24, s[68:71], s81 offen offset:0 lds
    v_mfma_f32_16x16x32_bf16 v[132:135], a[188:191], a[100:103], v[132:135]
    s_waitcnt vmcnt(18) lgkmcnt(2)
    v_mfma_f32_16x16x32_bf16 v[96:99], a[192:195], a[64:67], v[96:99]
    ds_read_b128 a[84:87], v43 offset:0
    v_mfma_f32_16x16x32_bf16 v[100:103], a[196:199], a[64:67], v[100:103]
    ds_read_b128 a[88:91], v43 offset:2048
    buffer_load_dwordx4 v25, s[68:71], s81 offen offset:1024 lds
    s_add_u32 s81, s81, 128
    s_cmp_eq_u32 s81, 1280
    s_cselect_b32 s81, 0, s81
    s_add_u32 m0, s86, 61440
    v_mfma_f32_16x16x32_bf16 v[104:107], a[192:195], a[68:71], v[104:107]
    v_mfma_f32_16x16x32_bf16 v[108:111], a[196:199], a[68:71], v[108:111]
    ds_read_b128 a[92:95], v43 offset:4096
    v_mfma_f32_16x16x32_bf16 v[112:115], a[192:195], a[72:75], v[112:115]
    ds_read_b128 a[96:99], v43 offset:6144
    s_waitcnt lgkmcnt(4)
    v_mfma_f32_16x16x32_bf16 v[116:119], a[196:199], a[72:75], v[116:119]
    buffer_load_dwordx4 a[48:51], v2, s[52:55], s83 offen offset:2048 sc1
    v_mfma_f32_16x16x32_bf16 v[120:123], a[192:195], a[76:79], v[120:123]
    ds_read_b128 a[100:103], v43 offset:8192
    v_mfma_f32_16x16x32_bf16 v[124:127], a[196:199], a[76:79], v[124:127]
    v_mfma_f32_16x16x32_bf16 v[128:131], a[192:195], a[80:83], v[128:131]
    buffer_load_dwordx4 a[52:55], v44, s[52:55], s83 offen offset:2048 sc1
    v_mfma_f32_16x16x32_bf16 v[132:135], a[196:199], a[80:83], v[132:135]
    s_barrier
    s_waitcnt vmcnt(19) lgkmcnt(2)
    v_mfma_f32_16x16x32_bf16 v[96:99], a[200:203], a[84:87], v[96:99]
    ds_read_b128 a[64:67], v32 offset:0
    v_mfma_f32_16x16x32_bf16 v[100:103], a[204:207], a[84:87], v[100:103]
    ds_read_b128 a[68:71], v32 offset:2048
    buffer_load_dwordx4 a[56:59], v2, s[52:55], s83 offen offset:3072 sc1
    v_mfma_f32_16x16x32_bf16 v[104:107], a[200:203], a[88:91], v[104:107]
    v_mfma_f32_16x16x32_bf16 v[108:111], a[204:207], a[88:91], v[108:111]
    ds_read_b128 a[72:75], v32 offset:4096
    v_mfma_f32_16x16x32_bf16 v[112:115], a[200:203], a[92:95], v[112:115]
    ds_read_b128 a[76:79], v32 offset:6144
    s_waitcnt lgkmcnt(4)
    v_mfma_f32_16x16x32_bf16 v[116:119], a[204:207], a[92:95], v[116:119]
    buffer_load_dwordx4 a[60:63], v44, s[52:55], s83 offen offset:3072 sc1
    s_add_u32 s83, s83, 4096
    s_cmp_eq_u32 s83, s85
    s_cselect_b32 s83, s84, s83
    v_mfma_f32_16x16x32_bf16 v[120:123], a[200:203], a[96:99], v[120:123]
    ds_read_b128 a[80:83], v32 offset:8192
    v_mfma_f32_16x16x32_bf16 v[124:127], a[204:207], a[96:99], v[124:127]
    v_mfma_f32_16x16x32_bf16 v[128:131], a[200:203], a[100:103], v[128:131]
    buffer_load_dwordx4 a[144:147], v2, s[52:55], s83 offen offset:0 sc1
    v_mfma_f32_16x16x32_bf16 v[132:135], a[204:207], a[100:103], v[132:135]
    s_waitcnt vmcnt(20) lgkmcnt(2)
    v_mfma_f32_16x16x32_bf16 v[96:99], a[0:3], a[64:67], v[96:99]
    ds_read_b128 a[84:87], v33 offset:0
    v_mfma_f32_16x16x32_bf16 v[100:103], a[4:7], a[64:67], v[100:103]
    ds_read_b128 a[88:91], v33 offset:2048
    v_mfma_f32_16x16x32_bf16 v[104:107], a[0:3], a[68:71], v[104:107]
    buffer_load_dwordx4 a[148:151], v44, s[52:55], s83 offen offset:0 sc1
    v_mfma_f32_16x16x32_bf16 v[108:111], a[4:7], a[68:71], v[108:111]
    ds_read_b128 a[92:95], v33 offset:4096
    v_mfma_f32_16x16x32_bf16 v[112:115], a[0:3], a[72:75], v[112:115]
    ds_read_b128 a[96:99], v33 offset:6144
    s_waitcnt lgkmcnt(4)
    v_mfma_f32_16x16x32_bf16 v[116:119], a[4:7], a[72:75], v[116:119]
    v_mfma_f32_16x16x32_bf16 v[120:123], a[0:3], a[76:79], v[120:123]
    ds_read_b128 a[100:103], v33 offset:8192
    v_mfma_f32_16x16x32_bf16 v[124:127], a[4:7], a[76:79], v[124:127]
    buffer_load_dwordx4 a[152:155], v2, s[52:55], s83 offen offset:1024 sc1
    v_mfma_f32_16x16x32_bf16 v[128:131], a[0:3], a[80:83], v[128:131]
    v_mfma_f32_16x16x32_bf16 v[132:135], a[4:7], a[80:83], v[132:135]
    s_waitcnt vmcnt(20) lgkmcnt(2)
    v_mfma_f32_16x16x32_bf16 v[96:99], a[8:11], a[84:87], v[96:99]
    ds_read_b128 a[64:67], v34 offset:0
    v_mfma_f32_16x16x32_bf16 v[100:103], a[12:15], a[84:87], v[100:103]
    ds_read_b128 a[68:71], v34 offset:2048
    buffer_load_dwordx4 a[156:159], v44, s[52:55], s83 offen offset:1024 sc1
    v_mfma_f32_16x16x32_bf16 v[104:107], a[8:11], a[88:91], v[104:107]
    v_mfma_f32_16x16x32_bf16 v[108:111], a[12:15], a[88:91], v[108:111]
    ds_read_b128 a[72:75], v34 offset:4096
    v_mfma_f32_16x16x32_bf16 v[112:115], a[8:11], a[92:95], v[112:115]
    ds_read_b128 a[76:79], v34 offset:6144
    s_waitcnt lgkmcnt(4)
    v_mfma_f32_16x16x32_bf16 v[116:119], a[12:15], a[92:95], v[116:119]
    buffer_load_dwordx4 v21, s[64:67], s81 offen offset:0 lds
    v_mfma_f32_16x16x32_bf16 v[120:123], a[8:11], a[96:99], v[120:123]
    ds_read_b128 a[80:83], v34 offset:8192
    v_mfma_f32_16x16x32_bf16 v[124:127], a[12:15], a[96:99], v[124:127]
    v_mfma_f32_16x16x32_bf16 v[128:131], a[8:11], a[100:103], v[128:131]
    buffer_load_dwordx4 v22, s[64:67], s81 offen offset:1024 lds
    v_mfma_f32_16x16x32_bf16 v[132:135], a[12:15], a[100:103], v[132:135]
    s_waitcnt vmcnt(21) lgkmcnt(2)
    v_mfma_f32_16x16x32_bf16 v[96:99], a[16:19], a[64:67], v[96:99]
    ds_read_b128 a[84:87], v35 offset:0
    v_mfma_f32_16x16x32_bf16 v[100:103], a[20:23], a[64:67], v[100:103]
    ds_read_b128 a[88:91], v35 offset:2048
    buffer_load_dwordx4 v23, s[64:67], s81 offen offset:2048 lds
    s_add_u32 m0, s87, 61440
    v_mfma_f32_16x16x32_bf16 v[104:107], a[16:19], a[68:71], v[104:107]
    v_mfma_f32_16x16x32_bf16 v[108:111], a[20:23], a[68:71], v[108:111]
    ds_read_b128 a[92:95], v35 offset:4096
    v_mfma_f32_16x16x32_bf16 v[112:115], a[16:19], a[72:75], v[112:115]
    ds_read_b128 a[96:99], v35 offset:6144
    s_waitcnt lgkmcnt(4)
    v_mfma_f32_16x16x32_bf16 v[116:119], a[20:23], a[72:75], v[116:119]
    buffer_load_dwordx4 v24, s[68:71], s81 offen offset:0 lds
    v_mfma_f32_16x16x32_bf16 v[120:123], a[16:19], a[76:79], v[120:123]
    ds_read_b128 a[100:103], v35 offset:8192
    v_mfma_f32_16x16x32_bf16 v[124:127], a[20:23], a[76:79], v[124:127]
    v_mfma_f32_16x16x32_bf16 v[128:131], a[16:19], a[80:83], v[128:131]
    buffer_load_dwordx4 v25, s[68:71], s81 offen offset:1024 lds
    s_add_u32 s81, s81, 128
    s_cmp_eq_u32 s81, 1280
    s_cselect_b32 s81, 0, s81
    s_add_u32 m0, s86, 81920
    v_mfma_f32_16x16x32_bf16 v[132:135], a[20:23], a[80:83], v[132:135]
    s_barrier
    s_waitcnt vmcnt(22) lgkmcnt(2)
    v_mfma_f32_16x16x32_bf16 v[96:99], a[24:27], a[84:87], v[96:99]
    ds_read_b128 a[64:67], v32 offset:20480
    v_mfma_f32_16x16x32_bf16 v[100:103], a[28:31], a[84:87], v[100:103]
    ds_read_b128 a[68:71], v32 offset:22528
    buffer_load_dwordx4 a[160:163], v2, s[52:55], s83 offen offset:2048 sc1
    v_mfma_f32_16x16x32_bf16 v[104:107], a[24:27], a[88:91], v[104:107]
    v_mfma_f32_16x16x32_bf16 v[108:111], a[28:31], a[88:91], v[108:111]
    ds_read_b128 a[72:75], v32 offset:24576
    v_mfma_f32_16x16x32_bf16 v[112:115], a[24:27], a[92:95], v[112:115]
    ds_read_b128 a[76:79], v32 offset:26624
    s_waitcnt lgkmcnt(4)
    v_mfma_f32_16x16x32_bf16 v[116:119], a[28:31], a[92:95], v[116:119]
    buffer_load_dwordx4 a[164:167], v44, s[52:55], s83 offen offset:2048 sc1
    v_mfma_f32_16x16x32_bf16 v[120:123], a[24:27], a[96:99], v[120:123]
    ds_read_b128 a[80:83], v32 offset:28672
    v_mfma_f32_16x16x32_bf16 v[124:127], a[28:31], a[96:99], v[124:127]
    v_mfma_f32_16x16x32_bf16 v[128:131], a[24:27], a[100:103], v[128:131]
    buffer_load_dwordx4 a[168:171], v2, s[52:55], s83 offen offset:3072 sc1
    v_mfma_f32_16x16x32_bf16 v[132:135], a[28:31], a[100:103], v[132:135]
    s_waitcnt vmcnt(23) lgkmcnt(2)
    v_mfma_f32_16x16x32_bf16 v[96:99], a[32:35], a[64:67], v[96:99]
    ds_read_b128 a[84:87], v33 offset:20480
    v_mfma_f32_16x16x32_bf16 v[100:103], a[36:39], a[64:67], v[100:103]
    ds_read_b128 a[88:91], v33 offset:22528
    buffer_load_dwordx4 a[172:175], v44, s[52:55], s83 offen offset:3072 sc1
    s_add_u32 s83, s83, 4096
    s_cmp_eq_u32 s83, s85
    s_cselect_b32 s83, s84, s83
    v_mfma_f32_16x16x32_bf16 v[104:107], a[32:35], a[68:71], v[104:107]
    v_mfma_f32_16x16x32_bf16 v[108:111], a[36:39], a[68:71], v[108:111]
    ds_read_b128 a[92:95], v33 offset:24576
    v_mfma_f32_16x16x32_bf16 v[112:115], a[32:35], a[72:75], v[112:115]
    ds_read_b128 a[96:99], v33 offset:26624
    s_waitcnt lgkmcnt(4)
    v_mfma_f32_16x16x32_bf16 v[116:119], a[36:39], a[72:75], v[116:119]
    buffer_load_dwordx4 a[176:179], v2, s[52:55], s83 offen offset:0 sc1
    v_mfma_f32_16x16x32_bf16 v[120:123], a[32:35], a[76:79], v[120:123]
    ds_read_b128 a[100:103], v33 offset:28672
    v_mfma_f32_16x16x32_bf16 v[124:127], a[36:39], a[76:79], v[124:127]
    v_mfma_f32_16x16x32_bf16 v[128:131], a[32:35], a[80:83], v[128:131]
    buffer_load_dwordx4 a[180:183], v44, s[52:55], s83 offen offset:0 sc1
    v_mfma_f32_16x16x32_bf16 v[132:135], a[36:39], a[80:83], v[132:135]
    s_waitcnt vmcnt(24) lgkmcnt(2)
    v_mfma_f32_16x16x32_bf16 v[96:99], a[40:43], a[84:87], v[96:99]
    ds_read_b128 a[64:67], v34 offset:20480
    v_mfma_f32_16x16x32_bf16 v[100:103], a[44:47], a[84:87], v[100:103]
    ds_read_b128 a[68:71], v34 offset:22528
    buffer_load_dwordx4 a[184:187], v2, s[52:55], s83 offen offset:1024 sc1
    v_mfma_f32_16x16x32_bf16 v[104:107], a[40:43], a[88:91], v[104:107]
    v_mfma_f32_16x16x32_bf16 v[108:111], a[44:47], a[88:91], v[108:111]
    ds_read_b128 a[72:75], v34 offset:24576
    v_mfma_f32_16x16x32_bf16 v[112:115], a[40:43], a[92:95], v[112:115]
    ds_read_b128 a[76:79], v34 offset:26624
    s_waitcnt lgkmcnt(4)
    v_mfma_f32_16x16x32_bf16 v[116:119], a[44:47], a[92:95], v[116:119]
    buffer_load_dwordx4 a[188:191], v44, s[52:55], s83 offen offset:1024 sc1
    v_mfma_f32_16x16x32_bf16 v[120:123], a[40:43], a[96:99], v[120:123]
    ds_read_b128 a[80:83], v34 offset:28672
    v_mfma_f32_16x16x32_bf16 v[124:127], a[44:47], a[96:99], v[124:127]
    v_mfma_f32_16x16x32_bf16 v[128:131], a[40:43], a[100:103], v[128:131]
    buffer_load_dwordx4 v21, s[64:67], s81 offen offset:0 lds
    v_mfma_f32_16x16x32_bf16 v[132:135], a[44:47], a[100:103], v[132:135]
    s_waitcnt vmcnt(20) lgkmcnt(2)
    v_mfma_f32_16x16x32_bf16 v[96:99], a[48:51], a[64:67], v[96:99]
    ds_read_b128 a[84:87], v35 offset:20480
    v_mfma_f32_16x16x32_bf16 v[100:103], a[52:55], a[64:67], v[100:103]
    ds_read_b128 a[88:91], v35 offset:22528
    buffer_load_dwordx4 v22, s[64:67], s81 offen offset:1024 lds
    v_mfma_f32_16x16x32_bf16 v[104:107], a[48:51], a[68:71], v[104:107]
    v_mfma_f32_16x16x32_bf16 v[108:111], a[52:55], a[68:71], v[108:111]
    ds_read_b128 a[92:95], v35 offset:24576
    v_mfma_f32_16x16x32_bf16 v[112:115], a[48:51], a[72:75], v[112:115]
    ds_read_b128 a[96:99], v35 offset:26624
    s_waitcnt lgkmcnt(4)
    v_mfma_f32_16x16x32_bf16 v[116:119], a[52:55], a[72:75], v[116:119]
    buffer_load_dwordx4 v23, s[64:67], s81 offen offset:2048 lds
    s_add_u32 m0, s87, 81920
    v_mfma_f32_16x16x32_bf16 v[120:123], a[48:51], a[76:79], v[120:123]
    ds_read_b128 a[100:103], v35 offset:28672
    v_mfma_f32_16x16x32_bf16 v[124:127], a[52:55], a[76:79], v[124:127]
    v_mfma_f32_16x16x32_bf16 v[128:131], a[48:51], a[80:83], v[128:131]
    buffer_load_dwordx4 v24, s[68:71], s81 offen offset:0 lds
    v_mfma_f32_16x16x32_bf16 v[132:135], a[52:55], a[80:83], v[132:135]
    s_barrier
    s_waitcnt vmcnt(21) lgkmcnt(2)
    v_mfma_f32_16x16x32_bf16 v[96:99], a[56:59], a[84:87], v[96:99]
    ds_read_b128 a[64:67], v32 offset:40960
    v_mfma_f32_16x16x32_bf16 v[100:103], a[60:63], a[84:87], v[100:103]
    ds_read_b128 a[68:71], v32 offset:43008
    buffer_load_dwordx4 v25, s[68:71], s81 offen offset:1024 lds
    s_add_u32 s81, s81, 128
    s_cmp_eq_u32 s81, 1280
    s_cselect_b32 s81, 0, s81
    s_add_u32 m0, s86, 102400
    v_mfma_f32_16x16x32_bf16 v[104:107], a[56:59], a[88:91], v[104:107]
    v_mfma_f32_16x16x32_bf16 v[108:111], a[60:63], a[88:91], v[108:111]
    ds_read_b128 a[72:75], v32 offset:45056
    v_mfma_f32_16x16x32_bf16 v[112:115], a[56:59], a[92:95], v[112:115]
    ds_read_b128 a[76:79], v32 offset:47104
    s_waitcnt lgkmcnt(4)
    v_mfma_f32_16x16x32_bf16 v[116:119], a[60:63], a[92:95], v[116:119]
    buffer_load_dwordx4 v21, s[64:67], s81 offen offset:0 lds
    v_mfma_f32_16x16x32_bf16 v[120:123], a[56:59], a[96:99], v[120:123]
    ds_read_b128 a[80:83], v32 offset:49152
    v_mfma_f32_16x16x32_bf16 v[124:127], a[60:63], a[96:99], v[124:127]
    v_mfma_f32_16x16x32_bf16 v[128:131], a[56:59], a[100:103], v[128:131]
    buffer_load_dwordx4 v22, s[64:67], s81 offen offset:1024 lds
    v_mfma_f32_16x16x32_bf16 v[132:135], a[60:63], a[100:103], v[132:135]
    s_waitcnt vmcnt(22) lgkmcnt(2)
    v_mfma_f32_16x16x32_bf16 v[96:99], a[144:147], a[64:67], v[96:99]
    ds_read_b128 a[84:87], v33 offset:40960
    v_mfma_f32_16x16x32_bf16 v[100:103], a[148:151], a[64:67], v[100:103]
    ds_read_b128 a[88:91], v33 offset:43008
    v_mfma_f32_16x16x32_bf16 v[104:107], a[144:147], a[68:71], v[104:107]
    buffer_load_dwordx4 v23, s[64:67], s81 offen offset:2048 lds
    s_add_u32 m0, s87, 102400
    v_mfma_f32_16x16x32_bf16 v[108:111], a[148:151], a[68:71], v[108:111]
    ds_read_b128 a[92:95], v33 offset:45056
    v_mfma_f32_16x16x32_bf16 v[112:115], a[144:147], a[72:75], v[112:115]
    ds_read_b128 a[96:99], v33 offset:47104
    s_waitcnt lgkmcnt(4)
    v_mfma_f32_16x16x32_bf16 v[116:119], a[148:151], a[72:75], v[116:119]
    v_mfma_f32_16x16x32_bf16 v[120:123], a[144:147], a[76:79], v[120:123]
    ds_read_b128 a[100:103], v33 offset:49152
    v_mfma_f32_16x16x32_bf16 v[124:127], a[148:151], a[76:79], v[124:127]
    buffer_load_dwordx4 v24, s[68:71], s81 offen offset:0 lds
    v_mfma_f32_16x16x32_bf16 v[128:131], a[144:147], a[80:83], v[128:131]
    v_mfma_f32_16x16x32_bf16 v[132:135], a[148:151], a[80:83], v[132:135]
    s_waitcnt vmcnt(22) lgkmcnt(2)
    v_mfma_f32_16x16x32_bf16 v[96:99], a[152:155], a[84:87], v[96:99]
    ds_read_b128 a[64:67], v34 offset:40960
    v_mfma_f32_16x16x32_bf16 v[100:103], a[156:159], a[84:87], v[100:103]
    ds_read_b128 a[68:71], v34 offset:43008
    buffer_load_dwordx4 v25, s[68:71], s81 offen offset:1024 lds
    s_add_u32 s81, s81, 128
    s_cmp_eq_u32 s81, 1280
    s_cselect_b32 s81, 0, s81
    v_mfma_f32_16x16x32_bf16 v[104:107], a[152:155], a[88:91], v[104:107]
    v_mfma_f32_16x16x32_bf16 v[108:111], a[156:159], a[88:91], v[108:111]
    ds_read_b128 a[72:75], v34 offset:45056
    v_mfma_f32_16x16x32_bf16 v[112:115], a[152:155], a[92:95], v[112:115]
    ds_read_b128 a[76:79], v34 offset:47104
    s_waitcnt lgkmcnt(4)
    v_mfma_f32_16x16x32_bf16 v[116:119], a[156:159], a[92:95], v[116:119]
    buffer_load_dwordx4 a[192:195], v2, s[52:55], s83 offen offset:2048 sc1
    v_mfma_f32_16x16x32_bf16 v[120:123], a[152:155], a[96:99], v[120:123]
    ds_read_b128 a[80:83], v34 offset:49152
    v_mfma_f32_16x16x32_bf16 v[124:127], a[156:159], a[96:99], v[124:127]
    v_mfma_f32_16x16x32_bf16 v[128:131], a[152:155], a[100:103], v[128:131]
    buffer_load_dwordx4 a[196:199], v44, s[52:55], s83 offen offset:2048 sc1
    v_mfma_f32_16x16x32_bf16 v[132:135], a[156:159], a[100:103], v[132:135]
    s_waitcnt vmcnt(18) lgkmcnt(2)
    v_mfma_f32_16x16x32_bf16 v[96:99], a[160:163], a[64:67], v[96:99]
    ds_read_b128 a[84:87], v35 offset:40960
    v_mfma_f32_16x16x32_bf16 v[100:103], a[164:167], a[64:67], v[100:103]
    ds_read_b128 a[88:91], v35 offset:43008
    buffer_load_dwordx4 a[200:203], v2, s[52:55], s83 offen offset:3072 sc1
    v_mfma_f32_16x16x32_bf16 v[104:107], a[160:163], a[68:71], v[104:107]
    v_mfma_f32_16x16x32_bf16 v[108:111], a[164:167], a[68:71], v[108:111]
    ds_read_b128 a[92:95], v35 offset:45056
    v_mfma_f32_16x16x32_bf16 v[112:115], a[160:163], a[72:75], v[112:115]
    ds_read_b128 a[96:99], v35 offset:47104
    s_waitcnt lgkmcnt(4)
    v_mfma_f32_16x16x32_bf16 v[116:119], a[164:167], a[72:75], v[116:119]
    buffer_load_dwordx4 a[204:207], v44, s[52:55], s83 offen offset:3072 sc1
    s_add_u32 s83, s83, 4096
    s_cmp_eq_u32 s83, s85
    s_cselect_b32 s83, s84, s83
    v_mfma_f32_16x16x32_bf16 v[120:123], a[160:163], a[76:79], v[120:123]
    ds_read_b128 a[100:103], v35 offset:49152
    v_mfma_f32_16x16x32_bf16 v[124:127], a[164:167], a[76:79], v[124:127]
    v_mfma_f32_16x16x32_bf16 v[128:131], a[160:163], a[80:83], v[128:131]
    buffer_load_dwordx4 a[0:3], v2, s[52:55], s83 offen offset:0 sc1
    v_mfma_f32_16x16x32_bf16 v[132:135], a[164:167], a[80:83], v[132:135]
    s_barrier
    s_waitcnt vmcnt(19) lgkmcnt(2)
    v_mfma_f32_16x16x32_bf16 v[96:99], a[168:171], a[84:87], v[96:99]
    ds_read_b128 a[64:67], v36 offset:0
    v_mfma_f32_16x16x32_bf16 v[100:103], a[172:175], a[84:87], v[100:103]
    ds_read_b128 a[68:71], v36 offset:2048
    buffer_load_dwordx4 a[4:7], v44, s[52:55], s83 offen offset:0 sc1
    v_mfma_f32_16x16x32_bf16 v[104:107], a[168:171], a[88:91], v[104:107]
    v_mfma_f32_16x16x32_bf16 v[108:111], a[172:175], a[88:91], v[108:111]
    ds_read_b128 a[72:75], v36 offset:4096
    v_mfma_f32_16x16x32_bf16 v[112:115], a[168:171], a[92:95], v[112:115]
    ds_read_b128 a[76:79], v36 offset:6144
    s_waitcnt lgkmcnt(4)
    v_mfma_f32_16x16x32_bf16 v[116:119], a[172:175], a[92:95], v[116:119]
    buffer_load_dwordx4 a[8:11], v2, s[52:55], s83 offen offset:1024 sc1
    v_mfma_f32_16x16x32_bf16 v[120:123], a[168:171], a[96:99], v[120:123]
    ds_read_b128 a[80:83], v36 offset:8192
    v_mfma_f32_16x16x32_bf16 v[124:127], a[172:175], a[96:99], v[124:127]
    v_mfma_f32_16x16x32_bf16 v[128:131], a[168:171], a[100:103], v[128:131]
    buffer_load_dwordx4 a[12:15], v44, s[52:55], s83 offen offset:1024 sc1
    v_mfma_f32_16x16x32_bf16 v[132:135], a[172:175], a[100:103], v[132:135]
    s_waitcnt vmcnt(20) lgkmcnt(2)
    v_mfma_f32_16x16x32_bf16 v[96:99], a[176:179], a[64:67], v[96:99]
    ds_read_b128 a[84:87], v37 offset:0
    v_mfma_f32_16x16x32_bf16 v[100:103], a[180:183], a[64:67], v[100:103]
    ds_read_b128 a[88:91], v37 offset:2048
    buffer_load_dwordx4 a[16:19], v2, s[52:55], s83 offen offset:2048 sc1
    v_mfma_f32_16x16x32_bf16 v[104:107], a[176:179], a[68:71], v[104:107]
    v_mfma_f32_16x16x32_bf16 v[108:111], a[180:183], a[68:71], v[108:111]
    ds_read_b128 a[92:95], v37 offset:4096
    v_mfma_f32_16x16x32_bf16 v[112:115], a[176:179], a[72:75], v[112:115]
    ds_read_b128 a[96:99], v37 offset:6144
    s_waitcnt lgkmcnt(4)
    v_mfma_f32_16x16x32_bf16 v[116:119], a[180:183], a[72:75], v[116:119]
    buffer_load_dwordx4 a[20:23], v44, s[52:55], s83 offen offset:2048 sc1
    v_mfma_f32_16x16x32_bf16 v[120:123], a[176:179], a[76:79], v[120:123]
    ds_read_b128 a[100:103], v37 offset:8192
    v_mfma_f32_16x16x32_bf16 v[124:127], a[180:183], a[76:79], v[124:127]
    v_mfma_f32_16x16x32_bf16 v[128:131], a[176:179], a[80:83], v[128:131]
    buffer_load_dwordx4 a[24:27], v2, s[52:55], s83 offen offset:3072 sc1
    v_mfma_f32_16x16x32_bf16 v[132:135], a[180:183], a[80:83], v[132:135]
    s_waitcnt vmcnt(21) lgkmcnt(2)
    v_mfma_f32_16x16x32_bf16 v[96:99], a[184:187], a[84:87], v[96:99]
    ds_read_b128 a[64:67], v38 offset:0
    v_mfma_f32_16x16x32_bf16 v[100:103], a[188:191], a[84:87], v[100:103]
    ds_read_b128 a[68:71], v38 offset:2048
    buffer_load_dwordx4 a[28:31], v44, s[52:55], s83 offen offset:3072 sc1
    s_add_u32 s83, s83, 4096
    s_cmp_eq_u32 s83, s85
    s_cselect_b32 s83, s84, s83
    v_mfma_f32_16x16x32_bf16 v[104:107], a[184:187], a[88:91], v[104:107]
    v_mfma_f32_16x16x32_bf16 v[108:111], a[188:191], a[88:91], v[108:111]
    ds_read_b128 a[72:75], v38 offset:4096
    v_mfma_f32_16x16x32_bf16 v[112:115], a[184:187], a[92:95], v[112:115]
    ds_read_b128 a[76:79], v38 offset:6144
    s_waitcnt lgkmcnt(4)
    v_mfma_f32_16x16x32_bf16 v[116:119], a[188:191], a[92:95], v[116:119]
    buffer_load_dwordx4 a[32:35], v2, s[52:55], s83 offen offset:0 sc1
    v_mfma_f32_16x16x32_bf16 v[120:123], a[184:187], a[96:99], v[120:123]
    ds_read_b128 a[80:83], v38 offset:8192
    v_mfma_f32_16x16x32_bf16 v[124:127], a[188:191], a[96:99], v[124:127]
    v_mfma_f32_16x16x32_bf16 v[128:131], a[184:187], a[100:103], v[128:131]
    buffer_load_dwordx4 a[36:39], v44, s[52:55], s83 offen offset:0 sc1
    v_mfma_f32_16x16x32_bf16 v[132:135], a[188:191], a[100:103], v[132:135]
    s_mov_b32 s72, s40
    s_mov_b32 s73, s41
    s_mov_b32 s74, 5242880
    s_mov_b32 s75, 0x20000
    v_lshrrev_b32 v8, 4, v1
    v_mul_u32_u24 v8, 0x5000, v8
    v_and_b32 v9, 15, v1
    v_lshl_add_u32 v8, v9, 2, v8
    s_mul_i32 s11, s4, 192
    s_sub_u32 s11, 2048, s11
    v_add_u32 v9, s11, v8
    s_lshl_b32 s11, s3, 2
    s_add_u32 s11, s11, s5
    s_mul_i32 s11, s11, 81920
    s_lshl_b32 s12, s4, 8
    s_add_u32 s11, s11, s12
    s_add_u32 s88, s11, 0
    s_add_u32 s89, s11, 10240
    s_add_u32 s90, s11, 2560
    s_add_u32 s91, s11, 12800
    s_add_u32 s94, s11, 5120
    s_add_u32 s95, s11, 15360
    s_add_u32 s96, s11, 7680
    s_add_u32 s97, s11, 17920
    s_lshl_b32 s93, s9, 5
    s_lshl_b32 s11, s5, 13
    s_add_u32 s93, s93, s11
    s_add_u32 s93, s93, 19922944
    s_add_u32 s1, s93, 4096
    s_waitcnt vmcnt(12) lgkmcnt(2)
    v_mfma_f32_16x16x32_bf16 v[96:99], a[192:195], a[64:67], v[96:99]
    ds_read_b128 a[84:87], v39 offset:0
    v_mfma_f32_16x16x32_bf16 v[100:103], a[196:199], a[64:67], v[100:103]
    ds_read_b128 a[88:91], v39 offset:2048
    v_and_b32 v11, 3, v1
    v_lshl_add_u32 v11, s5, 2, v11
    v_lshlrev_b32 v11, 2, v11
    s_add_u32 s46, s9, 512
    buffer_load_dword v10, v11, s[52:55], s46 offen sc1
    v_mfma_f32_16x16x32_bf16 v[104:107], a[192:195], a[68:71], v[104:107]
    v_mfma_f32_16x16x32_bf16 v[108:111], a[196:199], a[68:71], v[108:111]
    ds_read_b128 a[92:95], v39 offset:4096
    v_mfma_f32_16x16x32_bf16 v[112:115], a[192:195], a[72:75], v[112:115]
    ds_read_b128 a[96:99], v39 offset:6144
    s_waitcnt lgkmcnt(4)
    v_mfma_f32_16x16x32_bf16 v[116:119], a[196:199], a[72:75], v[116:119]
    buffer_load_dwordx4 a[40:43], v2, s[52:55], s83 offen offset:1024 sc1
    v_mfma_f32_16x16x32_bf16 v[120:123], a[192:195], a[76:79], v[120:123]
    ds_read_b128 a[100:103], v39 offset:8192
    v_mfma_f32_16x16x32_bf16 v[124:127], a[196:199], a[76:79], v[124:127]
    v_mfma_f32_16x16x32_bf16 v[128:131], a[192:195], a[80:83], v[128:131]
    buffer_load_dwordx4 a[44:47], v44, s[52:55], s83 offen offset:1024 sc1
    v_mfma_f32_16x16x32_bf16 v[132:135], a[196:199], a[80:83], v[132:135]
    s_barrier
    s_waitcnt vmcnt(13) lgkmcnt(2)
    v_mfma_f32_16x16x32_bf16 v[96:99], a[200:203], a[84:87], v[96:99]
    ds_read_b128 a[64:67], v36 offset:20480
    v_mfma_f32_16x16x32_bf16 v[100:103], a[204:207], a[84:87], v[100:103]
    ds_read_b128 a[68:71], v37 offset:20480
    buffer_load_dwordx4 a[48:51], v2, s[52:55], s83 offen offset:2048 sc1
    v_mfma_f32_16x16x32_bf16 v[104:107], a[200:203], a[88:91], v[104:107]
    v_mfma_f32_16x16x32_bf16 v[108:111], a[204:207], a[88:91], v[108:111]
    ds_read_b128 a[72:75], v38 offset:20480
    v_mfma_f32_16x16x32_bf16 v[112:115], a[200:203], a[92:95], v[112:115]
    s_waitcnt lgkmcnt(3)
    v_mfma_f32_16x16x32_bf16 v[116:119], a[204:207], a[92:95], v[116:119]
    ds_read_b128 a[76:79], v39 offset:20480
    buffer_load_dwordx4 a[52:55], v44, s[52:55], s83 offen offset:2048 sc1
    v_mfma_f32_16x16x32_bf16 v[120:123], a[200:203], a[96:99], v[120:123]
    v_mfma_f32_16x16x32_bf16 v[124:127], a[204:207], a[96:99], v[124:127]
    v_mfma_f32_16x16x32_bf16 v[128:131], a[200:203], a[100:103], v[128:131]
    buffer_load_dwordx4 a[56:59], v2, s[52:55], s83 offen offset:3072 sc1
    v_mfma_f32_16x16x32_bf16 v[132:135], a[204:207], a[100:103], v[132:135]
    s_waitcnt vmcnt(12) lgkmcnt(2)
    v_mfma_f32_16x16x32_bf16 v[96:99], a[0:3], a[64:67], v[96:99]
    ds_read_b128 a[84:87], v36 offset:40960
    v_mfma_f32_16x16x32_bf16 v[100:103], a[4:7], a[64:67], v[100:103]
    ds_read_b128 a[88:91], v37 offset:40960
    v_mfma_f32_16x16x32_bf16 v[96:99], a[8:11], a[68:71], v[96:99]
    v_mfma_f32_16x16x32_bf16 v[100:103], a[12:15], a[68:71], v[100:103]
    ds_read_b128 a[92:95], v38 offset:40960
    s_waitcnt vmcnt(8) lgkmcnt(3)
    v_mfma_f32_16x16x32_bf16 v[96:99], a[16:19], a[72:75], v[96:99]
    ds_read_b128 a[96:99], v39 offset:40960
    buffer_load_dwordx4 a[60:63], v44, s[52:55], s83 offen offset:3072 sc1
    s_add_u32 s83, s83, 4096
    s_cmp_eq_u32 s83, s85
    s_cselect_b32 s83, s84, s83
    v_mfma_f32_16x16x32_bf16 v[100:103], a[20:23], a[72:75], v[100:103]
    v_mfma_f32_16x16x32_bf16 v[96:99], a[24:27], a[76:79], v[96:99]
    v_mfma_f32_16x16x32_bf16 v[100:103], a[28:31], a[76:79], v[100:103]
    s_add_u32 s12, s7, 64
    s_waitcnt vmcnt(6)
    v_cmp_eq_u32 vcc, s12, v10
    s_nop 0
    s_cmp_eq_u64 vcc, exec
    s_cbranch_scc1 L_ready_15
    v_and_b32 v11, 3, v1
    v_lshl_add_u32 v11, s5, 2, v11
    v_lshlrev_b32 v11, 2, v11
    s_add_u32 s11, s9, 512
    s_add_u32 s12, s7, 64
L_poll_16:
    buffer_load_dword v10, v11, s[52:55], s11 offen sc1
    s_cmp_eq_u32 s10, 0
    s_waitcnt vmcnt(0)
    s_cbranch_scc1 L_polled_17
    s_sub_u32 s10, s10, 1
    v_cmp_eq_u32 vcc, s12, v10
    s_nop 0
    s_cmp_eq_u64 vcc, exec
    s_cbranch_scc0 L_poll_16
L_polled_17:
L_ready_15:
    buffer_load_dwordx4 v[176:179], v2, s[52:55], s93 offen offset:0 sc1
    buffer_load_dwordx4 v[180:183], v2, s[52:55], s93 offen offset:1024 sc1
    buffer_load_dwordx4 v[184:187], v2, s[52:55], s93 offen offset:2048 sc1
    buffer_load_dwordx4 v[188:191], v2, s[52:55], s93 offen offset:3072 sc1
    buffer_load_dwordx4 v[192:195], v2, s[52:55], s1 offen offset:0 sc1
    buffer_load_dwordx4 v[196:199], v2, s[52:55], s1 offen offset:1024 sc1
    buffer_load_dwordx4 v[200:203], v2, s[52:55], s1 offen offset:2048 sc1
    buffer_load_dwordx4 v[204:207], v2, s[52:55], s1 offen offset:3072 sc1
    s_waitcnt vmcnt(12) lgkmcnt(2)
    v_mfma_f32_16x16x32_bf16 v[96:99], a[32:35], a[84:87], v[96:99]
    ds_read_b128 a[64:67], v36 offset:22528
    v_mfma_f32_16x16x32_bf16 v[100:103], a[36:39], a[84:87], v[100:103]
    ds_read_b128 a[68:71], v37 offset:22528
    v_mfma_f32_16x16x32_bf16 v[96:99], a[40:43], a[88:91], v[96:99]
    v_mfma_f32_16x16x32_bf16 v[100:103], a[44:47], a[88:91], v[100:103]
    ds_read_b128 a[72:75], v38 offset:22528
    s_waitcnt vmcnt(8) lgkmcnt(3)
    v_mfma_f32_16x16x32_bf16 v[96:99], a[48:51], a[92:95], v[96:99]
    ds_read_b128 a[76:79], v39 offset:22528
    v_mfma_f32_16x16x32_bf16 v[100:103], a[52:55], a[92:95], v[100:103]
    v_mfma_f32_16x16x32_bf16 v[96:99], a[56:59], a[96:99], v[96:99]
    v_mfma_f32_16x16x32_bf16 v[100:103], a[60:63], a[96:99], v[100:103]
    s_waitcnt lgkmcnt(2)
    v_mfma_f32_16x16x32_bf16 v[104:107], a[0:3], a[64:67], v[104:107]
    ds_read_b128 a[84:87], v36 offset:43008
    v_mfma_f32_16x16x32_bf16 v[108:111], a[4:7], a[64:67], v[108:111]
    ds_read_b128 a[88:91], v37 offset:43008
    v_mfma_f32_16x16x32_bf16 v[104:107], a[8:11], a[68:71], v[104:107]
    v_mfma_f32_16x16x32_bf16 v[108:111], a[12:15], a[68:71], v[108:111]
    ds_read_b128 a[92:95], v38 offset:43008
    s_waitcnt lgkmcnt(3)
    v_mfma_f32_16x16x32_bf16 v[104:107], a[16:19], a[72:75], v[104:107]
    ds_read_b128 a[96:99], v39 offset:43008
    v_mfma_f32_16x16x32_bf16 v[108:111], a[20:23], a[72:75], v[108:111]
    v_mfma_f32_16x16x32_bf16 v[104:107], a[24:27], a[76:79], v[104:107]
    v_mfma_f32_16x16x32_bf16 v[108:111], a[28:31], a[76:79], v[108:111]
    s_waitcnt lgkmcnt(2)
    v_mfma_f32_16x16x32_bf16 v[104:107], a[32:35], a[84:87], v[104:107]
    ds_read_b128 a[64:67], v36 offset:24576
    v_mfma_f32_16x16x32_bf16 v[108:111], a[36:39], a[84:87], v[108:111]
    ds_read_b128 a[68:71], v37 offset:24576
    v_mfma_f32_16x16x32_bf16 v[104:107], a[40:43], a[88:91], v[104:107]
    v_mfma_f32_16x16x32_bf16 v[108:111], a[44:47], a[88:91], v[108:111]
    ds_read_b128 a[72:75], v38 offset:24576
    s_waitcnt lgkmcnt(3)
    v_mfma_f32_16x16x32_bf16 v[104:107], a[48:51], a[92:95], v[104:107]
    ds_read_b128 a[76:79], v39 offset:24576
    v_mfma_f32_16x16x32_bf16 v[108:111], a[52:55], a[92:95], v[108:111]
    v_mfma_f32_16x16x32_bf16 v[104:107], a[56:59], a[96:99], v[104:107]
    v_mfma_f32_16x16x32_bf16 v[108:111], a[60:63], a[96:99], v[108:111]
    s_waitcnt lgkmcnt(2)
    v_mfma_f32_16x16x32_bf16 v[112:115], a[0:3], a[64:67], v[112:115]
    ds_read_b128 a[84:87], v36 offset:45056
    v_mfma_f32_16x16x32_bf16 v[116:119], a[4:7], a[64:67], v[116:119]
    ds_read_b128 a[88:91], v37 offset:45056
    v_mfma_f32_16x16x32_bf16 v[112:115], a[8:11], a[68:71], v[112:115]
    v_mfma_f32_16x16x32_bf16 v[116:119], a[12:15], a[68:71], v[116:119]
    ds_read_b128 a[92:95], v38 offset:45056
    s_waitcnt lgkmcnt(3)
    v_mfma_f32_16x16x32_bf16 v[112:115], a[16:19], a[72:75], v[112:115]
    ds_read_b128 a[96:99], v39 offset:45056
    v_mfma_f32_16x16x32_bf16 v[116:119], a[20:23], a[72:75], v[116:119]
    v_mfma_f32_16x16x32_bf16 v[112:115], a[24:27], a[76:79], v[112:115]
    v_mfma_f32_16x16x32_bf16 v[116:119], a[28:31], a[76:79], v[116:119]
    s_waitcnt lgkmcnt(2)
    v_mfma_f32_16x16x32_bf16 v[112:115], a[32:35], a[84:87], v[112:115]
    ds_read_b128 a[64:67], v36 offset:26624
    s_waitcnt vmcnt(7)
    v_lshlrev_b32 v12, 16, v176
    v_and_b32 v13, 0xffff0000, v176
    v_mfma_f32_16x16x32_bf16 v[116:119], a[36:39], a[84:87], v[116:119]
    ds_read_b128 a[68:71], v37 offset:26624
    v_add_f32 v96, v96, v12
    v_mfma_f32_16x16x32_bf16 v[112:115], a[40:43], a[88:91], v[112:115]
    v_add_f32 v97, v97, v13
    buffer_store_dword v96, v8, s[72:75], s88 offen offset:0 sc1
    v_mfma_f32_16x16x32_bf16 v[116:119], a[44:47], a[88:91], v[116:119]
    ds_read_b128 a[72:75], v38 offset:26624
    buffer_store_dword v97, v8, s[72:75], s89 offen offset:0 sc1
    s_waitcnt lgkmcnt(3)
    v_mfma_f32_16x16x32_bf16 v[112:115], a[48:51], a[92:95], v[112:115]
    ds_read_b128 a[76:79], v39 offset:26624
    v_lshlrev_b32 v14, 16, v177
    v_and_b32 v15, 0xffff0000, v177
    v_mfma_f32_16x16x32_bf16 v[116:119], a[52:55], a[92:95], v[116:119]
    v_add_f32 v98, v98, v14
    v_mfma_f32_16x16x32_bf16 v[112:115], a[56:59], a[96:99], v[112:115]
    v_add_f32 v99, v99, v15
    buffer_store_dword v98, v8, s[72:75], s90 offen offset:0 sc1
    v_mfma_f32_16x16x32_bf16 v[116:119], a[60:63], a[96:99], v[116:119]
    buffer_store_dword v99, v8, s[72:75], s91 offen offset:0 sc1
    s_waitcnt lgkmcnt(2)
    v_mfma_f32_16x16x32_bf16 v[120:123], a[0:3], a[64:67], v[120:123]
    ds_read_b128 a[84:87], v36 offset:47104
    v_lshlrev_b32 v12, 16, v178
    v_and_b32 v13, 0xffff0000, v178
    v_mfma_f32_16x16x32_bf16 v[124:127], a[4:7], a[64:67], v[124:127]
    ds_read_b128 a[88:91], v37 offset:47104
    v_add_f32 v100, v100, v12
    v_mfma_f32_16x16x32_bf16 v[120:123], a[8:11], a[68:71], v[120:123]
    v_add_f32 v101, v101, v13
    buffer_store_dword v100, v8, s[72:75], s94 offen offset:0 sc1
    v_mfma_f32_16x16x32_bf16 v[124:127], a[12:15], a[68:71], v[124:127]
    ds_read_b128 a[92:95], v38 offset:47104
    buffer_store_dword v101, v8, s[72:75], s95 offen offset:0 sc1
    s_waitcnt lgkmcnt(3)
    v_mfma_f32_16x16x32_bf16 v[120:123], a[16:19], a[72:75], v[120:123]
    ds_read_b128 a[96:99], v39 offset:47104
    v_lshlrev_b32 v14, 16, v179
    v_and_b32 v15, 0xffff0000, v179
    v_mfma_f32_16x16x32_bf16 v[124:127], a[20:23], a[72:75], v[124:127]
    v_add_f32 v102, v102, v14
    v_mfma_f32_16x16x32_bf16 v[120:123], a[24:27], a[76:79], v[120:123]
    v_add_f32 v103, v103, v15
    buffer_store_dword v102, v8, s[72:75], s96 offen offset:0 sc1
    v_mfma_f32_16x16x32_bf16 v[124:127], a[28:31], a[76:79], v[124:127]
    buffer_store_dword v103, v8, s[72:75], s97 offen offset:0 sc1
    s_waitcnt lgkmcnt(2)
    v_mfma_f32_16x16x32_bf16 v[120:123], a[32:35], a[84:87], v[120:123]
    ds_read_b128 a[64:67], v36 offset:28672
    s_waitcnt vmcnt(14)
    v_lshlrev_b32 v12, 16, v180
    v_and_b32 v13, 0xffff0000, v180
    v_mfma_f32_16x16x32_bf16 v[124:127], a[36:39], a[84:87], v[124:127]
    ds_read_b128 a[68:71], v37 offset:28672
    v_add_f32 v104, v104, v12
    v_mfma_f32_16x16x32_bf16 v[120:123], a[40:43], a[88:91], v[120:123]
    v_add_f32 v105, v105, v13
    buffer_store_dword v104, v8, s[72:75], s88 offen offset:64 sc1
    v_mfma_f32_16x16x32_bf16 v[124:127], a[44:47], a[88:91], v[124:127]
    ds_read_b128 a[72:75], v38 offset:28672
    buffer_store_dword v105, v8, s[72:75], s89 offen offset:64 sc1
    s_waitcnt lgkmcnt(3)
    v_mfma_f32_16x16x32_bf16 v[120:123], a[48:51], a[92:95], v[120:123]
    ds_read_b128 a[76:79], v39 offset:28672
    v_lshlrev_b32 v14, 16, v181
    v_and_b32 v15, 0xffff0000, v181
    v_mfma_f32_16x16x32_bf16 v[124:127], a[52:55], a[92:95], v[124:127]
    v_add_f32 v106, v106, v14
    v_mfma_f32_16x16x32_bf16 v[120:123], a[56:59], a[96:99], v[120:123]
    v_add_f32 v107, v107, v15
    buffer_store_dword v106, v8, s[72:75], s90 offen offset:64 sc1
    v_mfma_f32_16x16x32_bf16 v[124:127], a[60:63], a[96:99], v[124:127]
    buffer_store_dword v107, v8, s[72:75], s91 offen offset:64 sc1
    s_waitcnt lgkmcnt(2)
    v_mfma_f32_16x16x32_bf16 v[128:131], a[0:3], a[64:67], v[128:131]
    ds_read_b128 a[84:87], v36 offset:49152
    v_lshlrev_b32 v12, 16, v182
    v_and_b32 v13, 0xffff0000, v182
    v_mfma_f32_16x16x32_bf16 v[132:135], a[4:7], a[64:67], v[132:135]
    ds_read_b128 a[88:91], v37 offset:49152
    v_add_f32 v108, v108, v12
    v_mfma_f32_16x16x32_bf16 v[128:131], a[8:11], a[68:71], v[128:131]
    v_add_f32 v109, v109, v13
    buffer_store_dword v108, v8, s[72:75], s94 offen offset:64 sc1
    v_mfma_f32_16x16x32_bf16 v[132:135], a[12:15], a[68:71], v[132:135]
    ds_read_b128 a[92:95], v38 offset:49152
    buffer_store_dword v109, v8, s[72:75], s95 offen offset:64 sc1
    s_waitcnt lgkmcnt(3)
    v_mfma_f32_16x16x32_bf16 v[128:131], a[16:19], a[72:75], v[128:131]
    ds_read_b128 a[96:99], v39 offset:49152
    v_lshlrev_b32 v14, 16, v183
    v_and_b32 v15, 0xffff0000, v183
    v_mfma_f32_16x16x32_bf16 v[132:135], a[20:23], a[72:75], v[132:135]
    v_add_f32 v110, v110, v14
    v_mfma_f32_16x16x32_bf16 v[128:131], a[24:27], a[76:79], v[128:131]
    v_add_f32 v111, v111, v15
    buffer_store_dword v110, v8, s[72:75], s96 offen offset:64 sc1
    v_mfma_f32_16x16x32_bf16 v[132:135], a[28:31], a[76:79], v[132:135]
    buffer_store_dword v111, v8, s[72:75], s97 offen offset:64 sc1
    s_waitcnt lgkmcnt(2)
    v_mfma_f32_16x16x32_bf16 v[128:131], a[32:35], a[84:87], v[128:131]
    v_mfma_f32_16x16x32_bf16 v[132:135], a[36:39], a[84:87], v[132:135]
    v_mfma_f32_16x16x32_bf16 v[128:131], a[40:43], a[88:91], v[128:131]
    v_mfma_f32_16x16x32_bf16 v[132:135], a[44:47], a[88:91], v[132:135]
    s_waitcnt lgkmcnt(0)
    v_mfma_f32_16x16x32_bf16 v[128:131], a[48:51], a[92:95], v[128:131]
    v_mfma_f32_16x16x32_bf16 v[132:135], a[52:55], a[92:95], v[132:135]
    v_mfma_f32_16x16x32_bf16 v[128:131], a[56:59], a[96:99], v[128:131]
    v_mfma_f32_16x16x32_bf16 v[132:135], a[60:63], a[96:99], v[132:135]
    s_waitcnt vmcnt(21)
    v_lshlrev_b32 v12, 16, v184
    v_and_b32 v13, 0xffff0000, v184
    v_add_f32 v112, v112, v12
    v_add_f32 v113, v113, v13
    buffer_store_dword v112, v8, s[72:75], s88 offen offset:128 sc1
    buffer_store_dword v113, v8, s[72:75], s89 offen offset:128 sc1
    v_lshlrev_b32 v14, 16, v185
    v_and_b32 v15, 0xffff0000, v185
    v_add_f32 v114, v114, v14
    v_add_f32 v115, v115, v15
    buffer_store_dword v114, v8, s[72:75], s90 offen offset:128 sc1
    buffer_store_dword v115, v8, s[72:75], s91 offen offset:128 sc1
    v_lshlrev_b32 v12, 16, v186
    v_and_b32 v13, 0xffff0000, v186
    v_add_f32 v116, v116, v12
    v_add_f32 v117, v117, v13
    buffer_store_dword v116, v8, s[72:75], s94 offen offset:128 sc1
    buffer_store_dword v117, v8, s[72:75], s95 offen offset:128 sc1
    v_lshlrev_b32 v14, 16, v187
    v_and_b32 v15, 0xffff0000, v187
    v_add_f32 v118, v118, v14
    v_add_f32 v119, v119, v15
    buffer_store_dword v118, v8, s[72:75], s96 offen offset:128 sc1
    buffer_store_dword v119, v8, s[72:75], s97 offen offset:128 sc1
    s_waitcnt vmcnt(28)
    v_lshlrev_b32 v12, 16, v188
    v_and_b32 v13, 0xffff0000, v188
    v_add_f32 v120, v120, v12
    v_add_f32 v121, v121, v13
    buffer_store_dword v120, v8, s[72:75], s88 offen offset:192 sc1
    buffer_store_dword v121, v8, s[72:75], s89 offen offset:192 sc1
    v_lshlrev_b32 v14, 16, v189
    v_and_b32 v15, 0xffff0000, v189
    v_add_f32 v122, v122, v14
    v_add_f32 v123, v123, v15
    buffer_store_dword v122, v8, s[72:75], s90 offen offset:192 sc1
    buffer_store_dword v123, v8, s[72:75], s91 offen offset:192 sc1
    v_lshlrev_b32 v12, 16, v190
    v_and_b32 v13, 0xffff0000, v190
    v_add_f32 v124, v124, v12
    v_add_f32 v125, v125, v13
    buffer_store_dword v124, v8, s[72:75], s94 offen offset:192 sc1
    buffer_store_dword v125, v8, s[72:75], s95 offen offset:192 sc1
    v_lshlrev_b32 v14, 16, v191
    v_and_b32 v15, 0xffff0000, v191
    v_add_f32 v126, v126, v14
    v_add_f32 v127, v127, v15
    buffer_store_dword v126, v8, s[72:75], s96 offen offset:192 sc1
    buffer_store_dword v127, v8, s[72:75], s97 offen offset:192 sc1
    s_waitcnt vmcnt(35)
    v_lshlrev_b32 v12, 16, v192
    v_and_b32 v13, 0xffff0000, v192
    v_add_f32 v128, v128, v12
    v_add_f32 v129, v129, v13
    v_lshlrev_b32 v14, 16, v193
    v_and_b32 v15, 0xffff0000, v193
    v_add_f32 v130, v130, v14
    v_add_f32 v131, v131, v15
    v_lshlrev_b32 v12, 16, v194
    v_and_b32 v13, 0xffff0000, v194
    v_add_f32 v132, v132, v12
    v_add_f32 v133, v133, v13
    v_lshlrev_b32 v14, 16, v195
    v_and_b32 v15, 0xffff0000, v195
    v_add_f32 v134, v134, v14
    v_add_f32 v135, v135, v15
    s_waitcnt vmcnt(34)
    v_lshlrev_b32 v12, 16, v196
    v_and_b32 v13, 0xffff0000, v196
    v_add_f32 v128, v128, v12
    v_add_f32 v129, v129, v13
    v_lshlrev_b32 v14, 16, v197
    v_and_b32 v15, 0xffff0000, v197
    v_add_f32 v130, v130, v14
    v_add_f32 v131, v131, v15
    v_lshlrev_b32 v12, 16, v198
    v_and_b32 v13, 0xffff0000, v198
    v_add_f32 v132, v132, v12
    v_add_f32 v133, v133, v13
    v_lshlrev_b32 v14, 16, v199
    v_and_b32 v15, 0xffff0000, v199
    v_add_f32 v134, v134, v14
    v_add_f32 v135, v135, v15
    s_waitcnt vmcnt(33)
    v_lshlrev_b32 v12, 16, v200
    v_and_b32 v13, 0xffff0000, v200
    v_add_f32 v128, v128, v12
    v_add_f32 v129, v129, v13
    v_lshlrev_b32 v14, 16, v201
    v_and_b32 v15, 0xffff0000, v201
    v_add_f32 v130, v130, v14
    v_add_f32 v131, v131, v15
    v_lshlrev_b32 v12, 16, v202
    v_and_b32 v13, 0xffff0000, v202
    v_add_f32 v132, v132, v12
    v_add_f32 v133, v133, v13
    v_lshlrev_b32 v14, 16, v203
    v_and_b32 v15, 0xffff0000, v203
    v_add_f32 v134, v134, v14
    v_add_f32 v135, v135, v15
    s_waitcnt vmcnt(32)
    v_lshlrev_b32 v12, 16, v204
    v_and_b32 v13, 0xffff0000, v204
    v_add_f32 v128, v128, v12
    v_add_f32 v129, v129, v13
    buffer_store_dword v128, v9, s[72:75], s88 offen offset:0 sc1
    buffer_store_dword v129, v9, s[72:75], s89 offen offset:0 sc1
    v_lshlrev_b32 v14, 16, v205
    v_and_b32 v15, 0xffff0000, v205
    v_add_f32 v130, v130, v14
    v_add_f32 v131, v131, v15
    buffer_store_dword v130, v9, s[72:75], s90 offen offset:0 sc1
    buffer_store_dword v131, v9, s[72:75], s91 offen offset:0 sc1
    v_lshlrev_b32 v12, 16, v206
    v_and_b32 v13, 0xffff0000, v206
    v_add_f32 v132, v132, v12
    v_add_f32 v133, v133, v13
    buffer_store_dword v132, v9, s[72:75], s94 offen offset:0 sc1
    buffer_store_dword v133, v9, s[72:75], s95 offen offset:0 sc1
    v_lshlrev_b32 v14, 16, v207
    v_and_b32 v15, 0xffff0000, v207
    v_add_f32 v134, v134, v14
    v_add_f32 v135, v135, v15
    buffer_store_dword v134, v9, s[72:75], s96 offen offset:0 sc1
    buffer_store_dword v135, v9, s[72:75], s97 offen offset:0 sc1
    s_barrier
    s_cmp_lg_u32 s5, 0
    s_cbranch_scc1 L_nobump_18
    s_add_u32 s11, s7, 0x100
    v_mov_b32 v12, s11
    v_mov_b32 v13, 0
    s_mov_b64 exec, 1
    buffer_store_dword v12, v13, s[52:55], s9 offen sc1
    s_mov_b64 exec, -1
L_nobump_18:
    s_endpgm
L_mlp:
    s_mov_b32 s56, s36
    s_mov_b32 s57, s37
    s_mov_b32 s58, 1966080
    s_mov_b32 s59, 0x20000
    s_mov_b32 s64, s38
    s_mov_b32 s65, s39
    s_mov_b32 s66, 1966080
    s_mov_b32 s67, 0x20000
    s_bfe_u32 s93, s9, 0x7000a
    s_lshl_b32 s93, s93, 2
    s_add_u32 s93, s93, s5
    s_mul_i32 s93, s93, 3840
    v_min_u32 v247, 29, v1
    v_lshlrev_b32 v247, 7, v247
    s_lshl_b32 s87, s5, 12
    s_lshl_b32 s15, s5, 10
    s_add_u32 s15, s15, 16384
    v_lshrrev_b32 v12, 3, v1
    v_and_b32 v13, 7, v1
    v_and_b32 v14, 2, v12
    v_xor_b32 v14, v13, v14
    v_lshlrev_b32 v14, 4, v14
    v_mul_u32_u24 v15, 0xc00, v12
    v_add_u32 v14, v14, v15
    s_and_b32 s11, s5, 1
    s_mul_i32 s11, s11, 98304
    s_mul_i32 s12, s4, 384
    s_add_u32 s11, s11, s12
    s_add_u32 s13, s11, 0
    v_add_u32 v16, s13, v14
    s_add_u32 s13, s11, 23552
    v_add_u32 v17, s13, v14
    v_xor_b32 v17, 64, v17
    s_add_u32 s13, s11, 47104
    v_add_u32 v18, s13, v14
    s_add_u32 s13, s11, 70656
    v_add_u32 v19, s13, v14
    v_xor_b32 v19, 64, v19
    s_and_b32 s11, s3, 3
    s_mul_i32 s11, s11, 10
    s_lshr_b32 s11, s11, 2
    s_lshr_b32 s12, s3, 2
    s_add_u32 s11, s11, s12
    s_mul_i32 s12, s4, 10
    s_lshr_b32 s12, s12, 3
    s_add_u32 s11, s11, s12
    s_mul_hi_u32 s12, s11, 429496730
    s_mul_i32 s12, s12, 10
    s_sub_u32 s11, s11, s12
    s_mul_i32 s83, s11, 2048
    s_lshr_b32 s13, s5, 1
    s_lshl_b32 s13, s13, 11
    s_add_u32 s80, s83, s13
    s_cmp_eq_u32 s80, 20480
    s_cselect_b32 s80, 0, s80
    s_mul_i32 s80, s80, 96
    s_bfe_u32 s11, s9, 0x7000a
    s_lshl_b32 s11, s11, 2
    s_add_u32 s11, s11, s5
    s_mul_i32 s11, s11, 10
    v_and_b32 v12, 15, v1
    v_min_u32 v12, 9, v12
    v_add_u32 v12, s11, v12
    v_lshrrev_b32 v13, 3, v12
    v_and_b32 v12, 7, v12
    v_mul_u32_u24 v12, 0x180, v12
    v_mul_u32_u24 v13, 0xc00, v13
    v_add_u32 v246, v12, v13
    v_bfe_u32 v12, v1, 4, 1
    v_lshlrev_b32 v12, 7, v12
    v_sub_u32 v246, v246, v12
    v_add_u32 v246, 0x100, v246
    s_add_u32 m0, s87, 0
    s_nop 0
    buffer_load_dwordx4 v16, s[56:59], s80 offen offset:0 lds
    buffer_load_dwordx4 v17, s[56:59], s80 offen offset:1024 lds
    buffer_load_dwordx4 v18, s[56:59], s80 offen offset:2048 lds
    buffer_load_dwordx4 v19, s[56:59], s80 offen offset:3072 lds
    s_add_u32 s80, s80, 393216
    s_sub_u32 s14, s80, 1966080
    s_cselect_b32 s80, s80, s14
    buffer_load_dword v255, v246, s[56:59], 0 offen
    v_lshrrev_b32 v12, 3, v1
    v_and_b32 v13, 7, v1
    v_and_b32 v14, 6, v12
    v_xor_b32 v14, v13, v14
    v_lshlrev_b32 v14, 4, v14
    v_mul_u32_u24 v15, 0x500, v12
    v_add_u32 v14, v14, v15
    s_add_u32 s11, s4, s5
    s_and_b32 s14, s11, 1
    s_lshl_b32 s14, s14, 5
    s_bfe_u32 s11, s11, 0x10001
    s_mul_i32 s11, s11, 192
    s_add_u32 s11, s11, s14
    s_mul_i32 s11, s11, 1280
    s_lshl_b32 s12, s4, 7
    s_add_u32 s11, s11, s12
    s_add_u32 s12, s11, 0
    v_add_u32 v20, s12, v14
    s_add_u32 s12, s11, 9216
    v_add_u32 v21, s12, v14
    s_add_u32 s12, s11, 18432
    v_add_u32 v22, s12, v14
    s_add_u32 s12, s11, 27648
    v_add_u32 v23, s12, v14
    s_mov_b32 s11, s4
    s_and_b32 s14, s11, 1
    s_lshl_b32 s14, s14, 5
    s_bfe_u32 s11, s11, 0x10001
    s_mul_i32 s11, s11, 192
    s_add_u32 s11, s11, s14
    s_lshl_b32 s12, s5, 3
    s_add_u32 s11, s11, s12
    s_mul_i32 s11, s11, 1280
    s_lshr_b32 s12, s4, 2
    s_lshl_b32 s12, s12, 7
    s_add_u32 s11, s11, s12
    s_add_u32 s11, s11, 1024
    v_add_u32 v24, s11, v14
    s_and_b32 s11, s3, 3
    s_mul_i32 s11, s11, 4
    s_lshr_b32 s11, s11, 2
    s_lshr_b32 s12, s3, 2
    s_add_u32 s11, s11, s12
    s_mul_hi_u32 s12, s11, 1073741824
    s_mul_i32 s12, s12, 4
    s_sub_u32 s11, s11, s12
    s_mul_i32 s91, s11, 4096
    s_mul_i32 s81, s91, 120
    v_bfe_u32 v12, v1, 2, 2
    v_lshrrev_b32 v13, 4, v1
    v_and_b32 v14, 3, v1
    v_lshlrev_b32 v14, 3, v14
    v_and_b32 v10, 1, v13
    v_lshrrev_b32 v11, 1, v12
    v_lshl_add_u32 v10, v10, 1, v11
    v_lshl_add_u32 v14, v10, 5, v14
    v_lshl_add_u32 v15, v13, 3, v12
    v_lshl_add_u32 v15, v15, 7, v14
    v_xor_b32 v26, 0, v15
    v_xor_b32 v27, 32, v15
    v_xor_b32 v28, 64, v15
    v_xor_b32 v29, 96, v15
    v_lshl_add_u32 v15, v13, 2, v12
    v_lshl_add_u32 v15, v15, 7, v14
    v_xor_b32 v30, 0, v15
    v_xor_b32 v31, 32, v15
    v_xor_b32 v32, 64, v15
    v_xor_b32 v33, 96, v15
    s_add_u32 s11, s4, 0
    s_and_b32 s11, s11, 3
    s_lshl_b32 s11, s11, 10
    v_add_u32 v36, s11, v2
    v_add_u32 v37, 49152, v36
    s_add_u32 s11, s4, 1
    s_and_b32 s11, s11, 3
    s_lshl_b32 s11, s11, 10
    v_add_u32 v38, s11, v2
    v_add_u32 v39, 49152, v38
    s_add_u32 s11, s4, 2
    s_and_b32 s11, s11, 3
    s_lshl_b32 s11, s11, 10
    v_add_u32 v40, s11, v2
    v_add_u32 v41, 49152, v40
    s_add_u32 s11, s4, 3
    s_and_b32 s11, s11, 3
    s_lshl_b32 s11, s11, 10
    v_add_u32 v42, s11, v2
    v_add_u32 v43, 49152, v42
    v_add_u32 v34, 20480, v2
    v_add_u32 v35, 49152, v2
    s_mul_i32 s84, s3, 163840
    s_mul_i32 s11, s5, 40960
    s_add_u32 s84, s84, s11
    s_add_u32 s84, s84, 3145728
    s_add_u32 s85, s84, 20480
    s_add_u32 s83, s83, s84
    s_mul_i32 s89, s3, 393216
    s_mul_i32 s11, s5, 98304
    s_add_u32 s89, s89, s11
    s_add_u32 s89, s89, 13631488
    s_lshl_b32 s90, s4, 11
    s_add_u32 s90, s90, s89
    v_and_b32 v10, 7, v9
    v_xor_b32 v10, v8, v10
    v_lshlrev_b32 v10, 4, v10
    v_lshl_add_u32 v10, v9, 7, v10
    v_add_u32 v10, 143360, v10
    v_lshrrev_b32 v8, 3, v0
    v_and_b32 v9, 7, v0
    v_xor_b32 v11, v8, v9
    v_and_b32 v11, 7, v11
    v_lshlrev_b32 v11, 4, v11
    v_lshl_add_u32 v11, v8, 7, v11
    v_add_u32 v11, 143360, v11
    v_lshlrev_b32 v9, 4, v9
    v_lshl_add_u32 v9, v8, 8, v9
    s_mul_i32 s13, s3, 163840
    s_mul_i32 s12, s4, 20480
    s_add_u32 s13, s13, s12
    s_lshl_b32 s12, s8, 7
    s_add_u32 s13, s13, s12
    s_add_u32 s92, s13, 3145728
    s_waitcnt vmcnt(9)
    v_lshlrev_b32 v116, 16, v96
    v_and_b32 v117, 0xffff0000, v96
    v_lshlrev_b32 v118, 16, v97
    v_and_b32 v119, 0xffff0000, v97
    v_pk_add_f32 v[12:13], v[116:117], v[118:119]
    v_lshlrev_b32 v120, 16, v98
    v_and_b32 v121, 0xffff0000, v98
    v_pk_add_f32 v[12:13], v[12:13], v[120:121]
    v_lshlrev_b32 v122, 16, v99
    v_and_b32 v123, 0xffff0000, v99
    v_pk_add_f32 v[12:13], v[12:13], v[122:123]
    s_waitcnt vmcnt(8)
    v_lshlrev_b32 v124, 16, v100
    v_and_b32 v125, 0xffff0000, v100
    v_pk_add_f32 v[12:13], v[12:13], v[124:125]
    v_lshlrev_b32 v126, 16, v101
    v_and_b32 v127, 0xffff0000, v101
    v_pk_add_f32 v[12:13], v[12:13], v[126:127]
    v_lshlrev_b32 v128, 16, v102
    v_and_b32 v129, 0xffff0000, v102
    v_pk_add_f32 v[12:13], v[12:13], v[128:129]
    v_lshlrev_b32 v130, 16, v103
    v_and_b32 v131, 0xffff0000, v103
    v_pk_add_f32 v[12:13], v[12:13], v[130:131]
    s_mov_b64 exec, s[94:95]
    s_waitcnt vmcnt(7)
    v_lshlrev_b32 v132, 16, v104
    v_and_b32 v133, 0xffff0000, v104
    v_pk_add_f32 v[12:13], v[12:13], v[132:133]
    v_lshlrev_b32 v134, 16, v105
    v_and_b32 v135, 0xffff0000, v105
    v_pk_add_f32 v[12:13], v[12:13], v[134:135]
    v_lshlrev_b32 v136, 16, v106
    v_and_b32 v137, 0xffff0000, v106
    v_pk_add_f32 v[12:13], v[12:13], v[136:137]
    v_lshlrev_b32 v138, 16, v107
    v_and_b32 v139, 0xffff0000, v107
    v_pk_add_f32 v[12:13], v[12:13], v[138:139]
    s_mov_b64 exec, -1
    v_add_f32 v12, v12, v13
    s_nop 1
    v_add_f32_dpp v12, v12, v12 row_ror:8 row_mask:0xf bank_mask:0xf
    s_nop 1
    v_add_f32_dpp v12, v12, v12 row_ror:4 row_mask:0xf bank_mask:0xf
    s_nop 1
    v_add_f32_dpp v12, v12, v12 row_ror:2 row_mask:0xf bank_mask:0xf
    s_nop 1
    v_add_f32_dpp v12, v12, v12 row_ror:1 row_mask:0xf bank_mask:0xf
    v_mov_b32 v13, v12
    s_nop 1
    v_permlane16_swap_b32 v12, v13
    v_add_f32 v12, v12, v13
    v_mul_f32 v12, 0x3acccccd, v12
    v_mov_b32 v14, v12
    v_cvt_pk_bf16_f32 v14, v14, v14
    v_lshlrev_b32 v14, 16, v14
    v_sub_f32 v15, v12, v14
    v_pk_add_f32 v[116:117], v[116:117], v[14:15] op_sel_hi:[1,0] neg_lo:[0,1] neg_hi:[0,1]
    v_pk_add_f32 v[118:119], v[118:119], v[14:15] op_sel_hi:[1,0] neg_lo:[0,1] neg_hi:[0,1]
    v_pk_add_f32 v[120:121], v[120:121], v[14:15] op_sel_hi:[1,0] neg_lo:[0,1] neg_hi:[0,1]
    v_pk_add_f32 v[122:123], v[122:123], v[14:15] op_sel_hi:[1,0] neg_lo:[0,1] neg_hi:[0,1]
    v_pk_add_f32 v[124:125], v[124:125], v[14:15] op_sel_hi:[1,0] neg_lo:[0,1] neg_hi:[0,1]
    v_pk_add_f32 v[126:127], v[126:127], v[14:15] op_sel_hi:[1,0] neg_lo:[0,1] neg_hi:[0,1]
    v_pk_add_f32 v[128:129], v[128:129], v[14:15] op_sel_hi:[1,0] neg_lo:[0,1] neg_hi:[0,1]
    v_pk_add_f32 v[130:131], v[130:131], v[14:15] op_sel_hi:[1,0] neg_lo:[0,1] neg_hi:[0,1]
    v_pk_mul_f32 v[12:13], v[116:117], v[116:117]
    v_pk_fma_f32 v[12:13], v[118:119], v[118:119], v[12:13]
    v_pk_fma_f32 v[12:13], v[120:121], v[120:121], v[12:13]
    v_pk_fma_f32 v[12:13], v[122:123], v[122:123], v[12:13]
    v_pk_fma_f32 v[12:13], v[124:125], v[124:125], v[12:13]
    v_pk_fma_f32 v[12:13], v[126:127], v[126:127], v[12:13]
    v_pk_fma_f32 v[12:13], v[128:129], v[128:129], v[12:13]
    v_pk_fma_f32 v[12:13], v[130:131], v[130:131], v[12:13]
    s_mov_b64 exec, s[94:95]
    v_pk_add_f32 v[132:133], v[132:133], v[14:15] op_sel_hi:[1,0] neg_lo:[0,1] neg_hi:[0,1]
    v_pk_add_f32 v[134:135], v[134:135], v[14:15] op_sel_hi:[1,0] neg_lo:[0,1] neg_hi:[0,1]
    v_pk_add_f32 v[136:137], v[136:137], v[14:15] op_sel_hi:[1,0] neg_lo:[0,1] neg_hi:[0,1]
    v_pk_add_f32 v[138:139], v[138:139], v[14:15] op_sel_hi:[1,0] neg_lo:[0,1] neg_hi:[0,1]
    v_pk_fma_f32 v[12:13], v[132:133], v[132:133], v[12:13]
    v_pk_fma_f32 v[12:13], v[134:135], v[134:135], v[12:13]
    v_pk_fma_f32 v[12:13], v[136:137], v[136:137], v[12:13]
    v_pk_fma_f32 v[12:13], v[138:139], v[138:139], v[12:13]
    s_mov_b64 exec, -1
    v_add_f32 v12, v12, v13
    s_nop 1
    v_add_f32_dpp v12, v12, v12 row_ror:8 row_mask:0xf bank_mask:0xf
    s_nop 1
    v_add_f32_dpp v12, v12, v12 row_ror:4 row_mask:0xf bank_mask:0xf
    s_nop 1
    v_add_f32_dpp v12, v12, v12 row_ror:2 row_mask:0xf bank_mask:0xf
    s_nop 1
    v_add_f32_dpp v12, v12, v12 row_ror:1 row_mask:0xf bank_mask:0xf
    v_mov_b32 v13, v12
    s_nop 1
    v_permlane16_swap_b32 v12, v13
    v_add_f32 v12, v12, v13
    v_mul_f32 v12, 0x3acccccd, v12
    v_fma_f32 v12, -v15, v15, v12
    v_max_f32 v12, 0, v12
    v_cvt_pk_bf16_f32 v12, v12, v12
    v_lshlrev_b32 v12, 16, v12
    v_add_f32 v12, 0x3727c5ac, v12
    v_cvt_pk_bf16_f32 v12, v12, v12
    v_lshlrev_b32 v12, 16, v12
    v_sqrt_f32 v12, v12
    s_nop 0
    v_cvt_pk_bf16_f32 v12, v12, v12
    v_lshlrev_b32 v12, 16, v12
    v_rcp_f32 v12, v12
    s_nop 0
    v_pk_mul_f32 v[116:117], v[116:117], v[12:13] op_sel_hi:[1,0]
    v_cvt_pk_bf16_f32 v96, v116, v117
    v_pk_mul_f32 v[118:119], v[118:119], v[12:13] op_sel_hi:[1,0]
    v_cvt_pk_bf16_f32 v97, v118, v119
    v_pk_mul_f32 v[120:121], v[120:121], v[12:13] op_sel_hi:[1,0]
    v_cvt_pk_bf16_f32 v98, v120, v121
    v_pk_mul_f32 v[122:123], v[122:123], v[12:13] op_sel_hi:[1,0]
    v_cvt_pk_bf16_f32 v99, v122, v123
    ds_write_b128 v10, v[96:99] offset:0
    v_pk_mul_f32 v[124:125], v[124:125], v[12:13] op_sel_hi:[1,0]
    v_cvt_pk_bf16_f32 v100, v124, v125
    v_pk_mul_f32 v[126:127], v[126:127], v[12:13] op_sel_hi:[1,0]
    v_cvt_pk_bf16_f32 v101, v126, v127
    v_pk_mul_f32 v[128:129], v[128:129], v[12:13] op_sel_hi:[1,0]
    v_cvt_pk_bf16_f32 v102, v128, v129
    v_pk_mul_f32 v[130:131], v[130:131], v[12:13] op_sel_hi:[1,0]
    v_cvt_pk_bf16_f32 v103, v130, v131
    ds_write_b128 v10, v[100:103] offset:4096
    s_mov_b64 exec, s[94:95]
    v_pk_mul_f32 v[132:133], v[132:133], v[12:13] op_sel_hi:[1,0]
    v_cvt_pk_bf16_f32 v104, v132, v133
    v_pk_mul_f32 v[134:135], v[134:135], v[12:13] op_sel_hi:[1,0]
    v_cvt_pk_bf16_f32 v105, v134, v135
    v_pk_mul_f32 v[136:137], v[136:137], v[12:13] op_sel_hi:[1,0]
    v_cvt_pk_bf16_f32 v106, v136, v137
    v_pk_mul_f32 v[138:139], v[138:139], v[12:13] op_sel_hi:[1,0]
    v_cvt_pk_bf16_f32 v107, v138, v139
    ds_write_b128 v10, v[104:107] offset:8192
    s_mov_b64 exec, -1
    s_waitcnt lgkmcnt(0)
    s_barrier
    ds_read_b128 v[96:99], v11 offset:0
    ds_read_b128 v[100:103], v11 offset:4096
    ds_read_b128 v[104:107], v11 offset:8192
    s_waitcnt lgkmcnt(2)
    buffer_store_dwordx4 v[96:99], v9, s[52:55], s92 offen sc1
    s_add_u32 s13, s92, 8192
    s_add_u32 s14, s92, 16384
    s_waitcnt lgkmcnt(1)
    buffer_store_dwordx4 v[100:103], v9, s[52:55], s13 offen sc1
    s_waitcnt lgkmcnt(0)
    s_cmp_gt_u32 s5, 1
    s_cbranch_scc1 L_third_19
    buffer_store_dwordx4 v[104:107], v9, s[52:55], s14 offen sc1
L_third_19:
    s_waitcnt vmcnt(8)
    v_readlane_b32 s7, v3, s47
    v_readlane_b32 s6, v3, 16
    s_add_u32 m0, s87, 20480
    s_nop 0
    buffer_load_dwordx4 v16, s[56:59], s80 offen offset:0 lds
    buffer_load_dwordx4 v17, s[56:59], s80 offen offset:1024 lds
    buffer_load_dwordx4 v18, s[56:59], s80 offen offset:2048 lds
    buffer_load_dwordx4 v19, s[56:59], s80 offen offset:3072 lds
    s_add_u32 s80, s80, 393216
    s_sub_u32 s14, s80, 1966080
    s_cselect_b32 s80, s80, s14
    s_waitcnt vmcnt(4)
    s_barrier
    s_cmp_lg_u32 s5, 0
    s_cbranch_scc1 L_nosend_20
    v_add_u32 v5, 32, v3
    s_lshl_b32 s11, s47, 2
    s_add_u32 s11, s11, 256
    s_mov_b64 exec, 0xffff
    buffer_store_dword v5, v4, s[52:55], s11 offen sc1
    s_mov_b64 exec, -1
L_nosend_20:
    s_add_u32 m0, s87, 40960
    s_nop 0
    buffer_load_dwordx4 v16, s[56:59], s80 offen offset:0 lds
    buffer_load_dwordx4 v17, s[56:59], s80 offen offset:1024 lds
    buffer_load_dwordx4 v18, s[56:59], s80 offen offset:2048 lds
    buffer_load_dwordx4 v19, s[56:59], s80 offen offset:3072 lds
    s_add_u32 s80, s80, 393216
    s_sub_u32 s14, s80, 1966080
    s_cselect_b32 s80, s80, s14
    s_add_u32 m0, s87, 61440
    s_nop 0
    buffer_load_dwordx4 v16, s[56:59], s80 offen offset:0 lds
    buffer_load_dwordx4 v17, s[56:59], s80 offen offset:1024 lds
    buffer_load_dwordx4 v18, s[56:59], s80 offen offset:2048 lds
    buffer_load_dwordx4 v19, s[56:59], s80 offen offset:3072 lds
    s_add_u32 s80, s80, 393216
    s_sub_u32 s14, s80, 1966080
    s_cselect_b32 s80, s80, s14
    s_add_u32 m0, s87, 81920
    s_nop 0
    buffer_load_dwordx4 v16, s[56:59], s80 offen offset:0 lds
    buffer_load_dwordx4 v17, s[56:59], s80 offen offset:1024 lds
    buffer_load_dwordx4 v18, s[56:59], s80 offen offset:2048 lds
    buffer_load_dwordx4 v19, s[56:59], s80 offen offset:3072 lds
    s_add_u32 s80, s80, 393344
    s_sub_u32 s14, s80, 1966080
    s_cselect_b32 s80, s80, s14
    s_add_u32 m0, s87, 102400
    s_nop 0
    buffer_load_dwordx4 v16, s[56:59], s80 offen offset:0 lds
    buffer_load_dwordx4 v17, s[56:59], s80 offen offset:1024 lds
    buffer_load_dwordx4 v18, s[56:59], s80 offen offset:2048 lds
    buffer_load_dwordx4 v19, s[56:59], s80 offen offset:3072 lds
    s_add_u32 s80, s80, 393216
    s_sub_u32 s14, s80, 1966080
    s_cselect_b32 s80, s80, s14
    s_add_u32 m0, s87, 122880
    s_nop 0
    buffer_load_dwordx4 v16, s[56:59], s80 offen offset:0 lds
    buffer_load_dwordx4 v17, s[56:59], s80 offen offset:1024 lds
    buffer_load_dwordx4 v18, s[56:59], s80 offen offset:2048 lds
    buffer_load_dwordx4 v19, s[56:59], s80 offen offset:3072 lds
    s_add_u32 s80, s80, 393216
    s_sub_u32 s14, s80, 1966080
    s_cselect_b32 s80, s80, s14
    s_add_u32 m0, s87, 143360
    s_nop 0
    buffer_load_dwordx4 v16, s[56:59], s80 offen offset:0 lds
    buffer_load_dwordx4 v17, s[56:59], s80 offen offset:1024 lds
    buffer_load_dwordx4 v18, s[56:59], s80 offen offset:2048 lds
    buffer_load_dwordx4 v19, s[56:59], s80 offen offset:3072 lds
    s_add_u32 s80, s80, 393216
    s_sub_u32 s14, s80, 1966080
    s_cselect_b32 s80, s80, s14
    v_and_b32 v13, 2, v1
    v_and_b32 v15, 1, v1
    v_lshl_add_u32 v13, v13, 2, v15
    v_lshl_add_u32 v13, s5, 1, v13
    v_lshlrev_b32 v13, 2, v13
    s_add_u32 s11, s9, 256
    s_add_u32 s12, s7, 32
L_poll_21:
    buffer_load_dword v12, v13, s[52:55], s11 offen sc1
    s_cmp_eq_u32 s10, 0
    s_waitcnt vmcnt(0)
    s_cbranch_scc1 L_polled_22
    s_sub_u32 s10, s10, 1
    v_cmp_eq_u32 vcc, s12, v12
    s_nop 0
    s_cmp_eq_u64 vcc, exec
    s_cbranch_scc0 L_poll_21
L_polled_22:
    buffer_load_dwordx4 a[0:3], v2, s[52:55], s83 offen offset:0 sc1
    buffer_load_dwordx4 a[4:7], v34, s[52:55], s83 offen offset:0 sc1
    buffer_load_dwordx4 a[8:11], v2, s[52:55], s83 offen offset:1024 sc1
    buffer_load_dwordx4 a[12:15], v34, s[52:55], s83 offen offset:1024 sc1
    s_add_u32 s83, s83, 2048
    s_cmp_eq_u32 s83, s85
    s_cselect_b32 s83, s84, s83
    buffer_load_dwordx4 a[16:19], v2, s[52:55], s83 offen offset:0 sc1
    buffer_load_dwordx4 a[20:23], v34, s[52:55], s83 offen offset:0 sc1
    buffer_load_dwordx4 a[24:27], v2, s[52:55], s83 offen offset:1024 sc1
    buffer_load_dwordx4 a[28:31], v34, s[52:55], s83 offen offset:1024 sc1
    s_add_u32 s83, s83, 2048
    s_cmp_eq_u32 s83, s85
    s_cselect_b32 s83, s84, s83
    ds_read_b64_tr_b16 a[192:193], v26 offset:0
    ds_read_b64_tr_b16 a[194:195], v26 offset:512
    ds_read_b64_tr_b16 a[196:197], v27 offset:0
    ds_read_b64_tr_b16 a[198:199], v27 offset:512
    ds_read_b64_tr_b16 a[200:201], v28 offset:0
    ds_read_b64_tr_b16 a[202:203], v28 offset:512
    ds_read_b64_tr_b16 a[204:205], v29 offset:0
    ds_read_b64_tr_b16 a[206:207], v29 offset:512
    s_waitcnt vmcnt(6) lgkmcnt(4)
    v_mfma_f32_16x16x32_bf16 v[96:99], a[192:195], a[0:3], 0
    ds_read_b64_tr_b16 a[160:161], v26 offset:4096
    ds_read_b64_tr_b16 a[162:163], v26 offset:4608
    v_mfma_f32_16x16x32_bf16 v[100:103], a[192:195], a[4:7], 0
    ds_read_b64_tr_b16 a[164:165], v27 offset:4096
    v_mfma_f32_16x16x32_bf16 v[104:107], a[196:199], a[0:3], 0
    ds_read_b64_tr_b16 a[166:167], v27 offset:4608
    buffer_load_dwordx4 a[32:35], v2, s[52:55], s83 offen offset:0 sc1
    v_mfma_f32_16x16x32_bf16 v[108:111], a[196:199], a[4:7], 0
    ds_read_b64_tr_b16 a[168:169], v28 offset:4096
    ds_read_b64_tr_b16 a[170:171], v28 offset:4608
    s_waitcnt lgkmcnt(6)
    v_mfma_f32_16x16x32_bf16 v[112:115], a[200:203], a[0:3], 0
    ds_read_b64_tr_b16 a[172:173], v29 offset:4096
    v_mfma_f32_16x16x32_bf16 v[116:119], a[200:203], a[4:7], 0
    ds_read_b64_tr_b16 a[174:175], v29 offset:4608
    v_mfma_f32_16x16x32_bf16 v[120:123], a[204:207], a[0:3], 0
    buffer_load_dwordx4 a[36:39], v34, s[52:55], s83 offen offset:0 sc1
    v_mfma_f32_16x16x32_bf16 v[124:127], a[204:207], a[4:7], 0
    s_waitcnt vmcnt(6) lgkmcnt(4)
    v_mfma_f32_16x16x32_bf16 v[96:99], a[160:163], a[8:11], v[96:99]
    ds_read_b64_tr_b16 a[192:193], v26 offset:8192
    ds_read_b64_tr_b16 a[194:195], v26 offset:8704
    v_mfma_f32_16x16x32_bf16 v[100:103], a[160:163], a[12:15], v[100:103]
    ds_read_b64_tr_b16 a[196:197], v27 offset:8192
    v_mfma_f32_16x16x32_bf16 v[104:107], a[164:167], a[8:11], v[104:107]
    ds_read_b64_tr_b16 a[198:199], v27 offset:8704
    buffer_load_dwordx4 a[40:43], v2, s[52:55], s83 offen offset:1024 sc1
    v_mfma_f32_16x16x32_bf16 v[108:111], a[164:167], a[12:15], v[108:111]
    ds_read_b64_tr_b16 a[200:201], v28 offset:8192
    ds_read_b64_tr_b16 a[202:203], v28 offset:8704
    s_waitcnt lgkmcnt(6)
    v_mfma_f32_16x16x32_bf16 v[112:115], a[168:171], a[8:11], v[112:115]
    ds_read_b64_tr_b16 a[204:205], v29 offset:8192
    v_mfma_f32_16x16x32_bf16 v[116:119], a[168:171], a[12:15], v[116:119]
    ds_read_b64_tr_b16 a[206:207], v29 offset:8704
    v_mfma_f32_16x16x32_bf16 v[120:123], a[172:175], a[8:11], v[120:123]
    buffer_load_dwordx4 a[44:47], v34, s[52:55], s83 offen offset:1024 sc1
    s_add_u32 s83, s83, 2048
    s_cmp_eq_u32 s83, s85
    s_cselect_b32 s83, s84, s83
    v_mfma_f32_16x16x32_bf16 v[124:127], a[172:175], a[12:15], v[124:127]
    s_waitcnt vmcnt(6) lgkmcnt(4)
    v_mfma_f32_16x16x32_bf16 v[96:99], a[192:195], a[16:19], v[96:99]
    ds_read_b64_tr_b16 a[160:161], v26 offset:12288
    ds_read_b64_tr_b16 a[162:163], v26 offset:12800
    v_mfma_f32_16x16x32_bf16 v[100:103], a[192:195], a[20:23], v[100:103]
    ds_read_b64_tr_b16 a[164:165], v27 offset:12288
    v_mfma_f32_16x16x32_bf16 v[104:107], a[196:199], a[16:19], v[104:107]
    ds_read_b64_tr_b16 a[166:167], v27 offset:12800
    buffer_load_dwordx4 a[48:51], v2, s[52:55], s83 offen offset:0 sc1
    v_mfma_f32_16x16x32_bf16 v[108:111], a[196:199], a[20:23], v[108:111]
    ds_read_b64_tr_b16 a[168:169], v28 offset:12288
    ds_read_b64_tr_b16 a[170:171], v28 offset:12800
    s_waitcnt lgkmcnt(6)
    v_mfma_f32_16x16x32_bf16 v[112:115], a[200:203], a[16:19], v[112:115]
    ds_read_b64_tr_b16 a[172:173], v29 offset:12288
    v_mfma_f32_16x16x32_bf16 v[116:119], a[200:203], a[20:23], v[116:119]
    ds_read_b64_tr_b16 a[174:175], v29 offset:12800
    v_mfma_f32_16x16x32_bf16 v[120:123], a[204:207], a[16:19], v[120:123]
    buffer_load_dwordx4 a[52:55], v34, s[52:55], s83 offen offset:0 sc1
    v_mfma_f32_16x16x32_bf16 v[124:127], a[204:207], a[20:23], v[124:127]
    s_barrier
    s_waitcnt vmcnt(6) lgkmcnt(4)
    v_mfma_f32_16x16x32_bf16 v[96:99], a[160:163], a[24:27], v[96:99]
    ds_read_b64_tr_b16 a[192:193], v26 offset:20480
    ds_read_b64_tr_b16 a[194:195], v26 offset:20992
    v_mfma_f32_16x16x32_bf16 v[100:103], a[160:163], a[28:31], v[100:103]
    ds_read_b64_tr_b16 a[196:197], v27 offset:20480
    buffer_load_dwordx4 a[56:59], v2, s[52:55], s83 offen offset:1024 sc1
    v_mfma_f32_16x16x32_bf16 v[104:107], a[164:167], a[24:27], v[104:107]
    ds_read_b64_tr_b16 a[198:199], v27 offset:20992
    v_mfma_f32_16x16x32_bf16 v[108:111], a[164:167], a[28:31], v[108:111]
    ds_read_b64_tr_b16 a[200:201], v28 offset:20480
    ds_read_b64_tr_b16 a[202:203], v28 offset:20992
    s_waitcnt lgkmcnt(6)
    v_mfma_f32_16x16x32_bf16 v[112:115], a[168:171], a[24:27], v[112:115]
    ds_read_b64_tr_b16 a[204:205], v29 offset:20480
    buffer_load_dwordx4 a[60:63], v34, s[52:55], s83 offen offset:1024 sc1
    s_add_u32 s83, s83, 2048
    s_cmp_eq_u32 s83, s85
    s_cselect_b32 s83, s84, s83
    v_mfma_f32_16x16x32_bf16 v[116:119], a[168:171], a[28:31], v[116:119]
    ds_read_b64_tr_b16 a[206:207], v29 offset:20992
    v_mfma_f32_16x16x32_bf16 v[120:123], a[172:175], a[24:27], v[120:123]
    buffer_load_dwordx4 a[64:67], v2, s[52:55], s83 offen offset:0 sc1
    v_mfma_f32_16x16x32_bf16 v[124:127], a[172:175], a[28:31], v[124:127]
    s_waitcnt vmcnt(7) lgkmcnt(4)
    v_mfma_f32_16x16x32_bf16 v[96:99], a[192:195], a[32:35], v[96:99]
    ds_read_b64_tr_b16 a[160:161], v26 offset:24576
    ds_read_b64_tr_b16 a[162:163], v26 offset:25088
    v_mfma_f32_16x16x32_bf16 v[100:103], a[192:195], a[36:39], v[100:103]
    ds_read_b64_tr_b16 a[164:165], v27 offset:24576
    v_mfma_f32_16x16x32_bf16 v[104:107], a[196:199], a[32:35], v[104:107]
    ds_read_b64_tr_b16 a[166:167], v27 offset:25088
    buffer_load_dwordx4 a[68:71], v34, s[52:55], s83 offen offset:0 sc1
    v_mfma_f32_16x16x32_bf16 v[108:111], a[196:199], a[36:39], v[108:111]
    ds_read_b64_tr_b16 a[168:169], v28 offset:24576
    ds_read_b64_tr_b16 a[170:171], v28 offset:25088
    s_waitcnt lgkmcnt(6)
    v_mfma_f32_16x16x32_bf16 v[112:115], a[200:203], a[32:35], v[112:115]
    ds_read_b64_tr_b16 a[172:173], v29 offset:24576
    v_mfma_f32_16x16x32_bf16 v[116:119], a[200:203], a[36:39], v[116:119]
    ds_read_b64_tr_b16 a[174:175], v29 offset:25088
    v_mfma_f32_16x16x32_bf16 v[120:123], a[204:207], a[32:35], v[120:123]
    buffer_load_dwordx4 a[72:75], v2, s[52:55], s83 offen offset:1024 sc1
    v_mfma_f32_16x16x32_bf16 v[124:127], a[204:207], a[36:39], v[124:127]
    s_waitcnt vmcnt(7) lgkmcnt(4)
    v_mfma_f32_16x16x32_bf16 v[96:99], a[160:163], a[40:43], v[96:99]
    ds_read_b64_tr_b16 a[192:193], v26 offset:28672
    ds_read_b64_tr_b16 a[194:195], v26 offset:29184
    v_mfma_f32_16x16x32_bf16 v[100:103], a[160:163], a[44:47], v[100:103]
    ds_read_b64_tr_b16 a[196:197], v27 offset:28672
    v_mfma_f32_16x16x32_bf16 v[104:107], a[164:167], a[40:43], v[104:107]
    ds_read_b64_tr_b16 a[198:199], v27 offset:29184
    buffer_load_dwordx4 a[76:79], v34, s[52:55], s83 offen offset:1024 sc1
    s_add_u32 s83, s83, 2048
    s_cmp_eq_u32 s83, s85
    s_cselect_b32 s83, s84, s83
    v_mfma_f32_16x16x32_bf16 v[108:111], a[164:167], a[44:47], v[108:111]
    ds_read_b64_tr_b16 a[200:201], v28 offset:28672
    ds_read_b64_tr_b16 a[202:203], v28 offset:29184
    s_waitcnt lgkmcnt(6)
    v_mfma_f32_16x16x32_bf16 v[112:115], a[168:171], a[40:43], v[112:115]
    ds_read_b64_tr_b16 a[204:205], v29 offset:28672
    v_mfma_f32_16x16x32_bf16 v[116:119], a[168:171], a[44:47], v[116:119]
    ds_read_b64_tr_b16 a[206:207], v29 offset:29184
    v_mfma_f32_16x16x32_bf16 v[120:123], a[172:175], a[40:43], v[120:123]
    buffer_load_dwordx4 a[80:83], v2, s[52:55], s83 offen offset:0 sc1
    v_mfma_f32_16x16x32_bf16 v[124:127], a[172:175], a[44:47], v[124:127]
    s_waitcnt vmcnt(7) lgkmcnt(4)
    v_mfma_f32_16x16x32_bf16 v[96:99], a[192:195], a[48:51], v[96:99]
    ds_read_b64_tr_b16 a[160:161], v26 offset:32768
    ds_read_b64_tr_b16 a[162:163], v26 offset:33280
    v_mfma_f32_16x16x32_bf16 v[100:103], a[192:195], a[52:55], v[100:103]
    ds_read_b64_tr_b16 a[164:165], v27 offset:32768
    buffer_load_dwordx4 a[84:87], v34, s[52:55], s83 offen offset:0 sc1
    v_mfma_f32_16x16x32_bf16 v[104:107], a[196:199], a[48:51], v[104:107]
    ds_read_b64_tr_b16 a[166:167], v27 offset:33280
    v_mfma_f32_16x16x32_bf16 v[108:111], a[196:199], a[52:55], v[108:111]
    ds_read_b64_tr_b16 a[168:169], v28 offset:32768
    ds_read_b64_tr_b16 a[170:171], v28 offset:33280
    s_waitcnt lgkmcnt(6)
    v_mfma_f32_16x16x32_bf16 v[112:115], a[200:203], a[48:51], v[112:115]
    ds_read_b64_tr_b16 a[172:173], v29 offset:32768
    buffer_load_dwordx4 a[88:91], v2, s[52:55], s83 offen offset:1024 sc1
    v_mfma_f32_16x16x32_bf16 v[116:119], a[200:203], a[52:55], v[116:119]
    ds_read_b64_tr_b16 a[174:175], v29 offset:33280
    v_mfma_f32_16x16x32_bf16 v[120:123], a[204:207], a[48:51], v[120:123]
    buffer_load_dwordx4 a[92:95], v34, s[52:55], s83 offen offset:1024 sc1
    s_add_u32 s83, s83, 2048
    s_cmp_eq_u32 s83, s85
    s_cselect_b32 s83, s84, s83
    v_mfma_f32_16x16x32_bf16 v[124:127], a[204:207], a[52:55], v[124:127]
    s_barrier
    s_waitcnt vmcnt(8) lgkmcnt(4)
    v_mfma_f32_16x16x32_bf16 v[96:99], a[160:163], a[56:59], v[96:99]
    ds_read_b64_tr_b16 a[192:193], v26 offset:40960
    ds_read_b64_tr_b16 a[194:195], v26 offset:41472
    v_mfma_f32_16x16x32_bf16 v[100:103], a[160:163], a[60:63], v[100:103]
    ds_read_b64_tr_b16 a[196:197], v27 offset:40960
    v_mfma_f32_16x16x32_bf16 v[104:107], a[164:167], a[56:59], v[104:107]
    ds_read_b64_tr_b16 a[198:199], v27 offset:41472
    buffer_load_dwordx4 a[96:99], v2, s[52:55], s83 offen offset:0 sc1
    v_mfma_f32_16x16x32_bf16 v[108:111], a[164:167], a[60:63], v[108:111]
    ds_read_b64_tr_b16 a[200:201], v28 offset:40960
    ds_read_b64_tr_b16 a[202:203], v28 offset:41472
    s_waitcnt lgkmcnt(6)
    v_mfma_f32_16x16x32_bf16 v[112:115], a[168:171], a[56:59], v[112:115]
    ds_read_b64_tr_b16 a[204:205], v29 offset:40960
    v_mfma_f32_16x16x32_bf16 v[116:119], a[168:171], a[60:63], v[116:119]
    ds_read_b64_tr_b16 a[206:207], v29 offset:41472
    v_mfma_f32_16x16x32_bf16 v[120:123], a[172:175], a[56:59], v[120:123]
    buffer_load_dwordx4 a[100:103], v34, s[52:55], s83 offen offset:0 sc1
    v_mfma_f32_16x16x32_bf16 v[124:127], a[172:175], a[60:63], v[124:127]
    s_waitcnt vmcnt(8) lgkmcnt(4)
    v_mfma_f32_16x16x32_bf16 v[96:99], a[192:195], a[64:67], v[96:99]
    ds_read_b64_tr_b16 a[160:161], v26 offset:45056
    ds_read_b64_tr_b16 a[162:163], v26 offset:45568
    v_mfma_f32_16x16x32_bf16 v[100:103], a[192:195], a[68:71], v[100:103]
    ds_read_b64_tr_b16 a[164:165], v27 offset:45056
    v_mfma_f32_16x16x32_bf16 v[104:107], a[196:199], a[64:67], v[104:107]
    ds_read_b64_tr_b16 a[166:167], v27 offset:45568
    buffer_load_dwordx4 a[104:107], v2, s[52:55], s83 offen offset:1024 sc1
    v_mfma_f32_16x16x32_bf16 v[108:111], a[196:199], a[68:71], v[108:111]
    ds_read_b64_tr_b16 a[168:169], v28 offset:45056
    ds_read_b64_tr_b16 a[170:171], v28 offset:45568
    s_waitcnt lgkmcnt(6)
    v_mfma_f32_16x16x32_bf16 v[112:115], a[200:203], a[64:67], v[112:115]
    ds_read_b64_tr_b16 a[172:173], v29 offset:45056
    v_mfma_f32_16x16x32_bf16 v[116:119], a[200:203], a[68:71], v[116:119]
    ds_read_b64_tr_b16 a[174:175], v29 offset:45568
    v_mfma_f32_16x16x32_bf16 v[120:123], a[204:207], a[64:67], v[120:123]
    buffer_load_dwordx4 a[108:111], v34, s[52:55], s83 offen offset:1024 sc1
    s_add_u32 s83, s83, 2048
    s_cmp_eq_u32 s83, s85
    s_cselect_b32 s83, s84, s83
    v_mfma_f32_16x16x32_bf16 v[124:127], a[204:207], a[68:71], v[124:127]
    s_waitcnt vmcnt(8) lgkmcnt(4)
    v_mfma_f32_16x16x32_bf16 v[96:99], a[160:163], a[72:75], v[96:99]
    ds_read_b64_tr_b16 a[192:193], v26 offset:49152
    ds_read_b64_tr_b16 a[194:195], v26 offset:49664
    v_mfma_f32_16x16x32_bf16 v[100:103], a[160:163], a[76:79], v[100:103]
    ds_read_b64_tr_b16 a[196:197], v27 offset:49152
    v_mfma_f32_16x16x32_bf16 v[104:107], a[164:167], a[72:75], v[104:107]
    ds_read_b64_tr_b16 a[198:199], v27 offset:49664
    buffer_load_dwordx4 a[112:115], v2, s[52:55], s83 offen offset:0 sc1
    v_mfma_f32_16x16x32_bf16 v[108:111], a[164:167], a[76:79], v[108:111]
    ds_read_b64_tr_b16 a[200:201], v28 offset:49152
    ds_read_b64_tr_b16 a[202:203], v28 offset:49664
    s_waitcnt lgkmcnt(6)
    v_mfma_f32_16x16x32_bf16 v[112:115], a[168:171], a[72:75], v[112:115]
    ds_read_b64_tr_b16 a[204:205], v29 offset:49152
    v_mfma_f32_16x16x32_bf16 v[116:119], a[168:171], a[76:79], v[116:119]
    ds_read_b64_tr_b16 a[206:207], v29 offset:49664
    v_mfma_f32_16x16x32_bf16 v[120:123], a[172:175], a[72:75], v[120:123]
    buffer_load_dwordx4 a[116:119], v34, s[52:55], s83 offen offset:0 sc1
    v_mfma_f32_16x16x32_bf16 v[124:127], a[172:175], a[76:79], v[124:127]
    s_waitcnt vmcnt(8) lgkmcnt(4)
    v_mfma_f32_16x16x32_bf16 v[96:99], a[192:195], a[80:83], v[96:99]
    ds_read_b64_tr_b16 a[160:161], v26 offset:53248
    ds_read_b64_tr_b16 a[162:163], v26 offset:53760
    v_mfma_f32_16x16x32_bf16 v[100:103], a[192:195], a[84:87], v[100:103]
    ds_read_b64_tr_b16 a[164:165], v27 offset:53248
    buffer_load_dwordx4 a[120:123], v2, s[52:55], s83 offen offset:1024 sc1
    v_mfma_f32_16x16x32_bf16 v[104:107], a[196:199], a[80:83], v[104:107]
    ds_read_b64_tr_b16 a[166:167], v27 offset:53760
    v_mfma_f32_16x16x32_bf16 v[108:111], a[196:199], a[84:87], v[108:111]
    ds_read_b64_tr_b16 a[168:169], v28 offset:53248
    ds_read_b64_tr_b16 a[170:171], v28 offset:53760
    s_waitcnt lgkmcnt(6)
    v_mfma_f32_16x16x32_bf16 v[112:115], a[200:203], a[80:83], v[112:115]
    ds_read_b64_tr_b16 a[172:173], v29 offset:53248
    buffer_load_dwordx4 a[124:127], v34, s[52:55], s83 offen offset:1024 sc1
    s_add_u32 s83, s83, 2048
    s_cmp_eq_u32 s83, s85
    s_cselect_b32 s83, s84, s83
    v_mfma_f32_16x16x32_bf16 v[116:119], a[200:203], a[84:87], v[116:119]
    ds_read_b64_tr_b16 a[174:175], v29 offset:53760
    v_mfma_f32_16x16x32_bf16 v[120:123], a[204:207], a[80:83], v[120:123]
    buffer_load_dwordx4 a[128:131], v2, s[52:55], s83 offen offset:0 sc1
    v_mfma_f32_16x16x32_bf16 v[124:127], a[204:207], a[84:87], v[124:127]
    s_barrier
    s_waitcnt vmcnt(9) lgkmcnt(4)
    v_mfma_f32_16x16x32_bf16 v[96:99], a[160:163], a[88:91], v[96:99]
    v_add_u32 v26, 61440, v26
    v_add_u32 v27, 61440, v27
    v_mfma_f32_16x16x32_bf16 v[100:103], a[160:163], a[92:95], v[100:103]
    v_add_u32 v28, 61440, v28
    v_add_u32 v29, 61440, v29
    v_mfma_f32_16x16x32_bf16 v[104:107], a[164:167], a[88:91], v[104:107]
    ds_read_b64_tr_b16 a[192:193], v26 offset:0
    ds_read_b64_tr_b16 a[194:195], v26 offset:512
    buffer_load_dwordx4 a[132:135], v34, s[52:55], s83 offen offset:0 sc1
    v_mfma_f32_16x16x32_bf16 v[108:111], a[164:167], a[92:95], v[108:111]
    ds_read_b64_tr_b16 a[196:197], v27 offset:0
    ds_read_b64_tr_b16 a[198:199], v27 offset:512
    s_waitcnt lgkmcnt(4)
    v_mfma_f32_16x16x32_bf16 v[112:115], a[168:171], a[88:91], v[112:115]
    ds_read_b64_tr_b16 a[200:201], v28 offset:0
    ds_read_b64_tr_b16 a[202:203], v28 offset:512
    v_mfma_f32_16x16x32_bf16 v[116:119], a[168:171], a[92:95], v[116:119]
    ds_read_b64_tr_b16 a[204:205], v29 offset:0
    ds_read_b64_tr_b16 a[206:207], v29 offset:512
    v_mfma_f32_16x16x32_bf16 v[120:123], a[172:175], a[88:91], v[120:123]
    buffer_load_dwordx4 a[136:139], v2, s[52:55], s83 offen offset:1024 sc1
    v_mfma_f32_16x16x32_bf16 v[124:127], a[172:175], a[92:95], v[124:127]
    s_waitcnt vmcnt(9) lgkmcnt(4)
    v_mfma_f32_16x16x32_bf16 v[96:99], a[192:195], a[96:99], v[96:99]
    ds_read_b64_tr_b16 a[160:161], v26 offset:4096
    ds_read_b64_tr_b16 a[162:163], v26 offset:4608
    v_mfma_f32_16x16x32_bf16 v[100:103], a[192:195], a[100:103], v[100:103]
    ds_read_b64_tr_b16 a[164:165], v27 offset:4096
    v_mfma_f32_16x16x32_bf16 v[104:107], a[196:199], a[96:99], v[104:107]
    ds_read_b64_tr_b16 a[166:167], v27 offset:4608
    buffer_load_dwordx4 a[140:143], v34, s[52:55], s83 offen offset:1024 sc1
    s_add_u32 s83, s83, 2048
    s_cmp_eq_u32 s83, s85
    s_cselect_b32 s83, s84, s83
    v_mfma_f32_16x16x32_bf16 v[108:111], a[196:199], a[100:103], v[108:111]
    ds_read_b64_tr_b16 a[168:169], v28 offset:4096
    ds_read_b64_tr_b16 a[170:171], v28 offset:4608
    s_waitcnt lgkmcnt(6)
    v_mfma_f32_16x16x32_bf16 v[112:115], a[200:203], a[96:99], v[112:115]
    ds_read_b64_tr_b16 a[172:173], v29 offset:4096
    v_mfma_f32_16x16x32_bf16 v[116:119], a[200:203], a[100:103], v[116:119]
    ds_read_b64_tr_b16 a[174:175], v29 offset:4608
    v_mfma_f32_16x16x32_bf16 v[120:123], a[204:207], a[96:99], v[120:123]
    buffer_load_dwordx4 a[144:147], v2, s[52:55], s83 offen offset:0 sc1
    v_mfma_f32_16x16x32_bf16 v[124:127], a[204:207], a[100:103], v[124:127]
    s_waitcnt vmcnt(9) lgkmcnt(4)
    v_mfma_f32_16x16x32_bf16 v[96:99], a[160:163], a[104:107], v[96:99]
    ds_read_b64_tr_b16 a[192:193], v26 offset:8192
    ds_read_b64_tr_b16 a[194:195], v26 offset:8704
    v_mfma_f32_16x16x32_bf16 v[100:103], a[160:163], a[108:111], v[100:103]
    ds_read_b64_tr_b16 a[196:197], v27 offset:8192
    buffer_load_dwordx4 a[148:151], v34, s[52:55], s83 offen offset:0 sc1
    v_mfma_f32_16x16x32_bf16 v[104:107], a[164:167], a[104:107], v[104:107]
    ds_read_b64_tr_b16 a[198:199], v27 offset:8704
    v_mfma_f32_16x16x32_bf16 v[108:111], a[164:167], a[108:111], v[108:111]
    ds_read_b64_tr_b16 a[200:201], v28 offset:8192
    ds_read_b64_tr_b16 a[202:203], v28 offset:8704
    s_waitcnt lgkmcnt(6)
    v_mfma_f32_16x16x32_bf16 v[112:115], a[168:171], a[104:107], v[112:115]
    ds_read_b64_tr_b16 a[204:205], v29 offset:8192
    buffer_load_dwordx4 a[152:155], v2, s[52:55], s83 offen offset:1024 sc1
    v_mfma_f32_16x16x32_bf16 v[116:119], a[168:171], a[108:111], v[116:119]
    ds_read_b64_tr_b16 a[206:207], v29 offset:8704
    v_mfma_f32_16x16x32_bf16 v[120:123], a[172:175], a[104:107], v[120:123]
    buffer_load_dwordx4 a[156:159], v34, s[52:55], s83 offen offset:1024 sc1
    s_add_u32 s83, s83, 2048
    s_cmp_eq_u32 s83, s85
    s_cselect_b32 s83, s84, s83
    v_mfma_f32_16x16x32_bf16 v[124:127], a[172:175], a[108:111], v[124:127]
    s_waitcnt vmcnt(10) lgkmcnt(4)
    v_mfma_f32_16x16x32_bf16 v[96:99], a[192:195], a[112:115], v[96:99]
    ds_read_b64_tr_b16 a[160:161], v26 offset:12288
    ds_read_b64_tr_b16 a[162:163], v26 offset:12800
    v_mfma_f32_16x16x32_bf16 v[100:103], a[192:195], a[116:119], v[100:103]
    ds_read_b64_tr_b16 a[164:165], v27 offset:12288
    v_mfma_f32_16x16x32_bf16 v[104:107], a[196:199], a[112:115], v[104:107]
    ds_read_b64_tr_b16 a[166:167], v27 offset:12800
    s_add_u32 m0, s87, 0
    s_nop 0
    buffer_load_dwordx4 v16, s[56:59], s80 offen offset:0 lds
    v_mfma_f32_16x16x32_bf16 v[108:111], a[196:199], a[116:119], v[108:111]
    ds_read_b64_tr_b16 a[168:169], v28 offset:12288
    ds_read_b64_tr_b16 a[170:171], v28 offset:12800
    s_waitcnt lgkmcnt(6)
    v_mfma_f32_16x16x32_bf16 v[112:115], a[200:203], a[112:115], v[112:115]
    ds_read_b64_tr_b16 a[172:173], v29 offset:12288
    v_mfma_f32_16x16x32_bf16 v[116:119], a[200:203], a[116:119], v[116:119]
    ds_read_b64_tr_b16 a[174:175], v29 offset:12800
    v_mfma_f32_16x16x32_bf16 v[120:123], a[204:207], a[112:115], v[120:123]
    buffer_load_dwordx4 v17, s[56:59], s80 offen offset:1024 lds
    v_mfma_f32_16x16x32_bf16 v[124:127], a[204:207], a[116:119], v[124:127]
    s_barrier
    s_waitcnt vmcnt(10) lgkmcnt(4)
    v_mfma_f32_16x16x32_bf16 v[96:99], a[160:163], a[120:123], v[96:99]
    ds_read_b64_tr_b16 a[192:193], v26 offset:20480
    ds_read_b64_tr_b16 a[194:195], v26 offset:20992
    v_mfma_f32_16x16x32_bf16 v[100:103], a[160:163], a[124:127], v[100:103]
    ds_read_b64_tr_b16 a[196:197], v27 offset:20480
    v_mfma_f32_16x16x32_bf16 v[104:107], a[164:167], a[120:123], v[104:107]
    ds_read_b64_tr_b16 a[198:199], v27 offset:20992
    buffer_load_dwordx4 v18, s[56:59], s80 offen offset:2048 lds
    v_mfma_f32_16x16x32_bf16 v[108:111], a[164:167], a[124:127], v[108:111]
    ds_read_b64_tr_b16 a[200:201], v28 offset:20480
    ds_read_b64_tr_b16 a[202:203], v28 offset:20992
    s_waitcnt lgkmcnt(6)
    v_mfma_f32_16x16x32_bf16 v[112:115], a[168:171], a[120:123], v[112:115]
    ds_read_b64_tr_b16 a[204:205], v29 offset:20480
    v_mfma_f32_16x16x32_bf16 v[116:119], a[168:171], a[124:127], v[116:119]
    ds_read_b64_tr_b16 a[206:207], v29 offset:20992
    v_mfma_f32_16x16x32_bf16 v[120:123], a[172:175], a[120:123], v[120:123]
    buffer_load_dwordx4 v19, s[56:59], s80 offen offset:3072 lds
    s_add_u32 s80, s80, 393216
    s_sub_u32 s14, s80, 1966080
    s_cselect_b32 s80, s80, s14
    s_add_u32 m0, s87, 20480
    v_mfma_f32_16x16x32_bf16 v[124:127], a[172:175], a[124:127], v[124:127]
    s_waitcnt vmcnt(10) lgkmcnt(4)
    v_mfma_f32_16x16x32_bf16 v[96:99], a[192:195], a[128:131], v[96:99]
    ds_read_b64_tr_b16 a[160:161], v26 offset:24576
    ds_read_b64_tr_b16 a[162:163], v26 offset:25088
    v_mfma_f32_16x16x32_bf16 v[100:103], a[192:195], a[132:135], v[100:103]
    ds_read_b64_tr_b16 a[164:165], v27 offset:24576
    buffer_load_dwordx4 v16, s[56:59], s80 offen offset:0 lds
    v_mfma_f32_16x16x32_bf16 v[104:107], a[196:199], a[128:131], v[104:107]
    ds_read_b64_tr_b16 a[166:167], v27 offset:25088
    v_mfma_f32_16x16x32_bf16 v[108:111], a[196:199], a[132:135], v[108:111]
    ds_read_b64_tr_b16 a[168:169], v28 offset:24576
    ds_read_b64_tr_b16 a[170:171], v28 offset:25088
    s_waitcnt lgkmcnt(6)
    v_mfma_f32_16x16x32_bf16 v[112:115], a[200:203], a[128:131], v[112:115]
    ds_read_b64_tr_b16 a[172:173], v29 offset:24576
    buffer_load_dwordx4 v17, s[56:59], s80 offen offset:1024 lds
    v_mfma_f32_16x16x32_bf16 v[116:119], a[200:203], a[132:135], v[116:119]
    ds_read_b64_tr_b16 a[174:175], v29 offset:25088
    v_mfma_f32_16x16x32_bf16 v[120:123], a[204:207], a[128:131], v[120:123]
    buffer_load_dwordx4 v18, s[56:59], s80 offen offset:2048 lds
    v_mfma_f32_16x16x32_bf16 v[124:127], a[204:207], a[132:135], v[124:127]
    s_waitcnt vmcnt(11) lgkmcnt(4)
    v_mfma_f32_16x16x32_bf16 v[96:99], a[160:163], a[136:139], v[96:99]
    ds_read_b64_tr_b16 a[192:193], v26 offset:28672
    ds_read_b64_tr_b16 a[194:195], v26 offset:29184
    v_mfma_f32_16x16x32_bf16 v[100:103], a[160:163], a[140:143], v[100:103]
    ds_read_b64_tr_b16 a[196:197], v27 offset:28672
    v_mfma_f32_16x16x32_bf16 v[104:107], a[164:167], a[136:139], v[104:107]
    ds_read_b64_tr_b16 a[198:199], v27 offset:29184
    buffer_load_dwordx4 v19, s[56:59], s80 offen offset:3072 lds
    s_add_u32 s80, s80, 393344
    s_sub_u32 s14, s80, 1966080
    s_cselect_b32 s80, s80, s14
    s_add_u32 m0, s87, 40960
    v_mfma_f32_16x16x32_bf16 v[108:111], a[164:167], a[140:143], v[108:111]
    ds_read_b64_tr_b16 a[200:201], v28 offset:28672
    ds_read_b64_tr_b16 a[202:203], v28 offset:29184
    s_waitcnt lgkmcnt(6)
    v_mfma_f32_16x16x32_bf16 v[112:115], a[168:171], a[136:139], v[112:115]
    ds_read_b64_tr_b16 a[204:205], v29 offset:28672
    v_mfma_f32_16x16x32_bf16 v[116:119], a[168:171], a[140:143], v[116:119]
    ds_read_b64_tr_b16 a[206:207], v29 offset:29184
    v_mfma_f32_16x16x32_bf16 v[120:123], a[172:175], a[136:139], v[120:123]
    buffer_load_dwordx4 v16, s[56:59], s80 offen offset:0 lds
    v_mfma_f32_16x16x32_bf16 v[124:127], a[172:175], a[140:143], v[124:127]
    s_waitcnt vmcnt(11) lgkmcnt(4)
    v_mfma_f32_16x16x32_bf16 v[96:99], a[192:195], a[144:147], v[96:99]
    ds_read_b64_tr_b16 a[160:161], v26 offset:32768
    ds_read_b64_tr_b16 a[162:163], v26 offset:33280
    v_mfma_f32_16x16x32_bf16 v[100:103], a[192:195], a[148:151], v[100:103]
    ds_read_b64_tr_b16 a[164:165], v27 offset:32768
    v_mfma_f32_16x16x32_bf16 v[104:107], a[196:199], a[144:147], v[104:107]
    ds_read_b64_tr_b16 a[166:167], v27 offset:33280
    buffer_load_dwordx4 v17, s[56:59], s80 offen offset:1024 lds
    v_mfma_f32_16x16x32_bf16 v[108:111], a[196:199], a[148:151], v[108:111]
    ds_read_b64_tr_b16 a[168:169], v28 offset:32768
    ds_read_b64_tr_b16 a[170:171], v28 offset:33280
    s_waitcnt lgkmcnt(6)
    v_mfma_f32_16x16x32_bf16 v[112:115], a[200:203], a[144:147], v[112:115]
    ds_read_b64_tr_b16 a[172:173], v29 offset:32768
    v_mfma_f32_16x16x32_bf16 v[116:119], a[200:203], a[148:151], v[116:119]
    ds_read_b64_tr_b16 a[174:175], v29 offset:33280
    v_mfma_f32_16x16x32_bf16 v[120:123], a[204:207], a[144:147], v[120:123]
    buffer_load_dwordx4 v18, s[56:59], s80 offen offset:2048 lds
    v_mfma_f32_16x16x32_bf16 v[124:127], a[204:207], a[148:151], v[124:127]
    s_barrier
    s_waitcnt vmcnt(11) lgkmcnt(4)
    v_mfma_f32_16x16x32_bf16 v[96:99], a[160:163], a[152:155], v[96:99]
    ds_read_b64_tr_b16 a[192:193], v26 offset:40960
    ds_read_b64_tr_b16 a[194:195], v26 offset:41472
    v_mfma_f32_16x16x32_bf16 v[100:103], a[160:163], a[156:159], v[100:103]
    ds_read_b64_tr_b16 a[196:197], v27 offset:40960
    v_mfma_f32_16x16x32_bf16 v[104:107], a[164:167], a[152:155], v[104:107]
    ds_read_b64_tr_b16 a[198:199], v27 offset:41472
    buffer_load_dwordx4 v19, s[56:59], s80 offen offset:3072 lds
    s_add_u32 s80, s80, 393216
    s_sub_u32 s14, s80, 1966080
    s_cselect_b32 s80, s80, s14
    s_add_u32 m0, s87, 61440
    v_mfma_f32_16x16x32_bf16 v[108:111], a[164:167], a[156:159], v[108:111]
    ds_read_b64_tr_b16 a[200:201], v28 offset:40960
    ds_read_b64_tr_b16 a[202:203], v28 offset:41472
    s_waitcnt lgkmcnt(6)
    v_mfma_f32_16x16x32_bf16 v[112:115], a[168:171], a[152:155], v[112:115]
    ds_read_b64_tr_b16 a[204:205], v29 offset:40960
    v_mfma_f32_16x16x32_bf16 v[116:119], a[168:171], a[156:159], v[116:119]
    ds_read_b64_tr_b16 a[206:207], v29 offset:41472
    v_mfma_f32_16x16x32_bf16 v[120:123], a[172:175], a[152:155], v[120:123]
    buffer_load_dwordx4 v16, s[56:59], s80 offen offset:0 lds
    v_mfma_f32_16x16x32_bf16 v[124:127], a[172:175], a[156:159], v[124:127]
    s_waitcnt lgkmcnt(4)
    v_mfma_f32_16x16x32_bf16 v[128:131], a[192:195], a[0:3], 0
    ds_read_b64_tr_b16 a[160:161], v26 offset:45056
    ds_read_b64_tr_b16 a[162:163], v26 offset:45568
    v_mfma_f32_16x16x32_bf16 v[132:135], a[192:195], a[4:7], 0
    ds_read_b64_tr_b16 a[164:165], v27 offset:45056
    buffer_load_dwordx4 v17, s[56:59], s80 offen offset:1024 lds
    v_mfma_f32_16x16x32_bf16 v[136:139], a[196:199], a[0:3], 0
    ds_read_b64_tr_b16 a[166:167], v27 offset:45568
    v_mfma_f32_16x16x32_bf16 v[140:143], a[196:199], a[4:7], 0
    ds_read_b64_tr_b16 a[168:169], v28 offset:45056
    ds_read_b64_tr_b16 a[170:171], v28 offset:45568
    s_waitcnt lgkmcnt(6)
    v_mfma_f32_16x16x32_bf16 v[144:147], a[200:203], a[0:3], 0
    ds_read_b64_tr_b16 a[172:173], v29 offset:45056
    buffer_load_dwordx4 v18, s[56:59], s80 offen offset:2048 lds
    v_mfma_f32_16x16x32_bf16 v[148:151], a[200:203], a[4:7], 0
    ds_read_b64_tr_b16 a[174:175], v29 offset:45568
    v_mfma_f32_16x16x32_bf16 v[152:155], a[204:207], a[0:3], 0
    buffer_load_dwordx4 v19, s[56:59], s80 offen offset:3072 lds
    s_add_u32 s80, s80, 393216
    s_sub_u32 s14, s80, 1966080
    s_cselect_b32 s80, s80, s14
    s_add_u32 m0, s87, 81920
    v_mfma_f32_16x16x32_bf16 v[156:159], a[204:207], a[4:7], 0
    s_waitcnt lgkmcnt(4)
    v_mfma_f32_16x16x32_bf16 v[128:131], a[160:163], a[8:11], v[128:131]
    ds_read_b64_tr_b16 a[192:193], v26 offset:49152
    ds_read_b64_tr_b16 a[194:195], v26 offset:49664
    v_cvt_pk_bf16_f32 v192, v96, v97
    v_mfma_f32_16x16x32_bf16 v[132:135], a[160:163], a[12:15], v[132:135]
    ds_read_b64_tr_b16 a[196:197], v27 offset:49152
    v_cvt_pk_bf16_f32 v193, v98, v99
    v_mfma_f32_16x16x32_bf16 v[136:139], a[164:167], a[8:11], v[136:139]
    ds_read_b64_tr_b16 a[198:199], v27 offset:49664
    v_cvt_pk_bf16_f32 v194, v104, v105
    v_mfma_f32_16x16x32_bf16 v[140:143], a[164:167], a[12:15], v[140:143]
    ds_read_b64_tr_b16 a[200:201], v28 offset:49152
    ds_read_b64_tr_b16 a[202:203], v28 offset:49664
    v_cvt_pk_bf16_f32 v195, v106, v107
    s_waitcnt lgkmcnt(6)
    v_mfma_f32_16x16x32_bf16 v[144:147], a[168:171], a[8:11], v[144:147]
    ds_read_b64_tr_b16 a[204:205], v29 offset:49152
    v_pk_max_i16 v192, v192, 0
    v_mfma_f32_16x16x32_bf16 v[148:151], a[168:171], a[12:15], v[148:151]
    ds_read_b64_tr_b16 a[206:207], v29 offset:49664
    v_pk_max_i16 v193, v193, 0
    v_mfma_f32_16x16x32_bf16 v[152:155], a[172:175], a[8:11], v[152:155]
    v_pk_max_i16 v194, v194, 0
    v_mfma_f32_16x16x32_bf16 v[156:159], a[172:175], a[12:15], v[156:159]
    v_pk_max_i16 v195, v195, 0
    buffer_store_dwordx4 v[192:195], v2, s[52:55], s90 offen offset:0 sc1
    s_waitcnt lgkmcnt(4)
    v_mfma_f32_16x16x32_bf16 v[128:131], a[192:195], a[16:19], v[128:131]
    ds_read_b64_tr_b16 a[160:161], v26 offset:53248
    ds_read_b64_tr_b16 a[162:163], v26 offset:53760
    v_mfma_f32_16x16x32_bf16 v[132:135], a[192:195], a[20:23], v[132:135]
    ds_read_b64_tr_b16 a[164:165], v27 offset:53248
    v_mfma_f32_16x16x32_bf16 v[136:139], a[196:199], a[16:19], v[136:139]
    ds_read_b64_tr_b16 a[166:167], v27 offset:53760
    v_mfma_f32_16x16x32_bf16 v[140:143], a[196:199], a[20:23], v[140:143]
    ds_read_b64_tr_b16 a[168:169], v28 offset:53248
    ds_read_b64_tr_b16 a[170:171], v28 offset:53760
    s_waitcnt lgkmcnt(6)
    v_mfma_f32_16x16x32_bf16 v[144:147], a[200:203], a[16:19], v[144:147]
    ds_read_b64_tr_b16 a[172:173], v29 offset:53248
    v_mfma_f32_16x16x32_bf16 v[148:151], a[200:203], a[20:23], v[148:151]
    ds_read_b64_tr_b16 a[174:175], v29 offset:53760
    v_mfma_f32_16x16x32_bf16 v[152:155], a[204:207], a[16:19], v[152:155]
    v_mfma_f32_16x16x32_bf16 v[156:159], a[204:207], a[20:23], v[156:159]
    s_barrier
    s_waitcnt lgkmcnt(4)
    v_mfma_f32_16x16x32_bf16 v[128:131], a[160:163], a[24:27], v[128:131]
    v_add_u32 v26, 61440, v26
    v_add_u32 v27, 61440, v27
    v_cvt_pk_bf16_f32 v196, v100, v101
    v_mfma_f32_16x16x32_bf16 v[132:135], a[160:163], a[28:31], v[132:135]
    v_add_u32 v28, 61440, v28
    v_add_u32 v29, 61440, v29
    v_cvt_pk_bf16_f32 v197, v102, v103
    v_mfma_f32_16x16x32_bf16 v[136:139], a[164:167], a[24:27], v[136:139]
    ds_read_b64_tr_b16 a[192:193], v26 offset:0
    ds_read_b64_tr_b16 a[194:195], v26 offset:512
    v_cvt_pk_bf16_f32 v198, v108, v109
    buffer_load_dwordx4 v16, s[56:59], s80 offen offset:0 lds
    v_mfma_f32_16x16x32_bf16 v[140:143], a[164:167], a[28:31], v[140:143]
    ds_read_b64_tr_b16 a[196:197], v27 offset:0
    ds_read_b64_tr_b16 a[198:199], v27 offset:512
    v_cvt_pk_bf16_f32 v199, v110, v111
    s_waitcnt lgkmcnt(4)
    v_mfma_f32_16x16x32_bf16 v[144:147], a[168:171], a[24:27], v[144:147]
    ds_read_b64_tr_b16 a[200:201], v28 offset:0
    ds_read_b64_tr_b16 a[202:203], v28 offset:512
    v_pk_max_i16 v196, v196, 0
    v_mfma_f32_16x16x32_bf16 v[148:151], a[168:171], a[28:31], v[148:151]
    ds_read_b64_tr_b16 a[204:205], v29 offset:0
    ds_read_b64_tr_b16 a[206:207], v29 offset:512
    v_pk_max_i16 v197, v197, 0
    v_mfma_f32_16x16x32_bf16 v[152:155], a[172:175], a[24:27], v[152:155]
    v_pk_max_i16 v198, v198, 0
    buffer_load_dwordx4 v17, s[56:59], s80 offen offset:1024 lds
    v_mfma_f32_16x16x32_bf16 v[156:159], a[172:175], a[28:31], v[156:159]
    v_pk_max_i16 v199, v199, 0
    buffer_store_dwordx4 v[196:199], v35, s[52:55], s90 offen offset:0 sc1
    s_waitcnt lgkmcnt(4)
    v_mfma_f32_16x16x32_bf16 v[128:131], a[192:195], a[32:35], v[128:131]
    ds_read_b64_tr_b16 a[160:161], v26 offset:4096
    ds_read_b64_tr_b16 a[162:163], v26 offset:4608
    v_mfma_f32_16x16x32_bf16 v[132:135], a[192:195], a[36:39], v[132:135]
    ds_read_b64_tr_b16 a[164:165], v27 offset:4096
    v_mfma_f32_16x16x32_bf16 v[136:139], a[196:199], a[32:35], v[136:139]
    ds_read_b64_tr_b16 a[166:167], v27 offset:4608
    buffer_load_dwordx4 v18, s[56:59], s80 offen offset:2048 lds
    v_mfma_f32_16x16x32_bf16 v[140:143], a[196:199], a[36:39], v[140:143]
    ds_read_b64_tr_b16 a[168:169], v28 offset:4096
    ds_read_b64_tr_b16 a[170:171], v28 offset:4608
    s_waitcnt lgkmcnt(6)
    v_mfma_f32_16x16x32_bf16 v[144:147], a[200:203], a[32:35], v[144:147]
    ds_read_b64_tr_b16 a[172:173], v29 offset:4096
    v_mfma_f32_16x16x32_bf16 v[148:151], a[200:203], a[36:39], v[148:151]
    ds_read_b64_tr_b16 a[174:175], v29 offset:4608
    v_mfma_f32_16x16x32_bf16 v[152:155], a[204:207], a[32:35], v[152:155]
    buffer_load_dwordx4 v19, s[56:59], s80 offen offset:3072 lds
    s_add_u32 s80, s80, 393216
    s_sub_u32 s14, s80, 1966080
    s_cselect_b32 s80, s80, s14
    s_add_u32 m0, s87, 102400
    v_mfma_f32_16x16x32_bf16 v[156:159], a[204:207], a[36:39], v[156:159]
    s_waitcnt lgkmcnt(4)
    v_mfma_f32_16x16x32_bf16 v[128:131], a[160:163], a[40:43], v[128:131]
    ds_read_b64_tr_b16 a[192:193], v26 offset:8192
    ds_read_b64_tr_b16 a[194:195], v26 offset:8704
    v_cvt_pk_bf16_f32 v200, v112, v113
    v_mfma_f32_16x16x32_bf16 v[132:135], a[160:163], a[44:47], v[132:135]
    ds_read_b64_tr_b16 a[196:197], v27 offset:8192
    v_cvt_pk_bf16_f32 v201, v114, v115
    v_mfma_f32_16x16x32_bf16 v[136:139], a[164:167], a[40:43], v[136:139]
    ds_read_b64_tr_b16 a[198:199], v27 offset:8704
    v_cvt_pk_bf16_f32 v202, v120, v121
    v_mfma_f32_16x16x32_bf16 v[140:143], a[164:167], a[44:47], v[140:143]
    ds_read_b64_tr_b16 a[200:201], v28 offset:8192
    ds_read_b64_tr_b16 a[202:203], v28 offset:8704
    v_cvt_pk_bf16_f32 v203, v122, v123
    s_waitcnt lgkmcnt(6)
    v_mfma_f32_16x16x32_bf16 v[144:147], a[168:171], a[40:43], v[144:147]
    ds_read_b64_tr_b16 a[204:205], v29 offset:8192
    v_pk_max_i16 v200, v200, 0
    v_mfma_f32_16x16x32_bf16 v[148:151], a[168:171], a[44:47], v[148:151]
    ds_read_b64_tr_b16 a[206:207], v29 offset:8704
    v_pk_max_i16 v201, v201, 0
    v_mfma_f32_16x16x32_bf16 v[152:155], a[172:175], a[40:43], v[152:155]
    v_pk_max_i16 v202, v202, 0
    v_mfma_f32_16x16x32_bf16 v[156:159], a[172:175], a[44:47], v[156:159]
    v_pk_max_i16 v203, v203, 0
    buffer_store_dwordx4 v[200:203], v2, s[52:55], s90 offen offset:1024 sc1
    s_waitcnt lgkmcnt(4)
    v_mfma_f32_16x16x32_bf16 v[128:131], a[192:195], a[48:51], v[128:131]
    ds_read_b64_tr_b16 a[160:161], v26 offset:12288
    ds_read_b64_tr_b16 a[162:163], v26 offset:12800
    v_mfma_f32_16x16x32_bf16 v[132:135], a[192:195], a[52:55], v[132:135]
    ds_read_b64_tr_b16 a[164:165], v27 offset:12288
    v_mfma_f32_16x16x32_bf16 v[136:139], a[196:199], a[48:51], v[136:139]
    ds_read_b64_tr_b16 a[166:167], v27 offset:12800
    v_mfma_f32_16x16x32_bf16 v[140:143], a[196:199], a[52:55], v[140:143]
    ds_read_b64_tr_b16 a[168:169], v28 offset:12288
    ds_read_b64_tr_b16 a[170:171], v28 offset:12800
    s_waitcnt lgkmcnt(6)
    v_mfma_f32_16x16x32_bf16 v[144:147], a[200:203], a[48:51], v[144:147]
    ds_read_b64_tr_b16 a[172:173], v29 offset:12288
    v_mfma_f32_16x16x32_bf16 v[148:151], a[200:203], a[52:55], v[148:151]
    ds_read_b64_tr_b16 a[174:175], v29 offset:12800
    v_mfma_f32_16x16x32_bf16 v[152:155], a[204:207], a[48:51], v[152:155]
    v_mfma_f32_16x16x32_bf16 v[156:159], a[204:207], a[52:55], v[156:159]
    s_barrier
    s_waitcnt lgkmcnt(4)
    v_mfma_f32_16x16x32_bf16 v[128:131], a[160:163], a[56:59], v[128:131]
    ds_read_b64_tr_b16 a[192:193], v26 offset:20480
    ds_read_b64_tr_b16 a[194:195], v26 offset:20992
    v_cvt_pk_bf16_f32 v204, v116, v117
    v_mfma_f32_16x16x32_bf16 v[132:135], a[160:163], a[60:63], v[132:135]
    ds_read_b64_tr_b16 a[196:197], v27 offset:20480
    v_cvt_pk_bf16_f32 v205, v118, v119
    v_mfma_f32_16x16x32_bf16 v[136:139], a[164:167], a[56:59], v[136:139]
    ds_read_b64_tr_b16 a[198:199], v27 offset:20992
    v_cvt_pk_bf16_f32 v206, v124, v125
    buffer_load_dwordx4 v16, s[56:59], s80 offen offset:0 lds
    v_mfma_f32_16x16x32_bf16 v[140:143], a[164:167], a[60:63], v[140:143]
    ds_read_b64_tr_b16 a[200:201], v28 offset:20480
    ds_read_b64_tr_b16 a[202:203], v28 offset:20992
    v_cvt_pk_bf16_f32 v207, v126, v127
    s_waitcnt lgkmcnt(6)
    v_mfma_f32_16x16x32_bf16 v[144:147], a[168:171], a[56:59], v[144:147]
    ds_read_b64_tr_b16 a[204:205], v29 offset:20480
    v_pk_max_i16 v204, v204, 0
    v_mfma_f32_16x16x32_bf16 v[148:151], a[168:171], a[60:63], v[148:151]
    ds_read_b64_tr_b16 a[206:207], v29 offset:20992
    v_pk_max_i16 v205, v205, 0
    v_mfma_f32_16x16x32_bf16 v[152:155], a[172:175], a[56:59], v[152:155]
    v_pk_max_i16 v206, v206, 0
    buffer_load_dwordx4 v17, s[56:59], s80 offen offset:1024 lds
    v_mfma_f32_16x16x32_bf16 v[156:159], a[172:175], a[60:63], v[156:159]
    v_pk_max_i16 v207, v207, 0
    buffer_store_dwordx4 v[204:207], v35, s[52:55], s90 offen offset:1024 sc1
    s_add_u32 s90, s90, 16384
    s_waitcnt lgkmcnt(4)
    v_mfma_f32_16x16x32_bf16 v[128:131], a[192:195], a[64:67], v[128:131]
    ds_read_b64_tr_b16 a[160:161], v26 offset:24576
    ds_read_b64_tr_b16 a[162:163], v26 offset:25088
    v_mfma_f32_16x16x32_bf16 v[132:135], a[192:195], a[68:71], v[132:135]
    ds_read_b64_tr_b16 a[164:165], v27 offset:24576
    v_mfma_f32_16x16x32_bf16 v[136:139], a[196:199], a[64:67], v[136:139]
    ds_read_b64_tr_b16 a[166:167], v27 offset:25088
    buffer_load_dwordx4 v18, s[56:59], s80 offen offset:2048 lds
    v_mfma_f32_16x16x32_bf16 v[140:143], a[196:199], a[68:71], v[140:143]
    ds_read_b64_tr_b16 a[168:169], v28 offset:24576
    ds_read_b64_tr_b16 a[170:171], v28 offset:25088
    s_waitcnt lgkmcnt(6)
    v_mfma_f32_16x16x32_bf16 v[144:147], a[200:203], a[64:67], v[144:147]
    ds_read_b64_tr_b16 a[172:173], v29 offset:24576
    v_mfma_f32_16x16x32_bf16 v[148:151], a[200:203], a[68:71], v[148:151]
    ds_read_b64_tr_b16 a[174:175], v29 offset:25088
    v_mfma_f32_16x16x32_bf16 v[152:155], a[204:207], a[64:67], v[152:155]
    buffer_load_dwordx4 v19, s[56:59], s80 offen offset:3072 lds
    s_add_u32 s80, s80, 393216
    s_sub_u32 s14, s80, 1966080
    s_cselect_b32 s80, s80, s14
    s_add_u32 m0, s87, 122880
    v_mfma_f32_16x16x32_bf16 v[156:159], a[204:207], a[68:71], v[156:159]
    s_waitcnt lgkmcnt(4)
    v_mfma_f32_16x16x32_bf16 v[128:131], a[160:163], a[72:75], v[128:131]
    ds_read_b64_tr_b16 a[192:193], v26 offset:28672
    ds_read_b64_tr_b16 a[194:195], v26 offset:29184
    v_mfma_f32_16x16x32_bf16 v[132:135], a[160:163], a[76:79], v[132:135]
    ds_read_b64_tr_b16 a[196:197], v27 offset:28672
    v_mfma_f32_16x16x32_bf16 v[136:139], a[164:167], a[72:75], v[136:139]
    ds_read_b64_tr_b16 a[198:199], v27 offset:29184
    v_mfma_f32_16x16x32_bf16 v[140:143], a[164:167], a[76:79], v[140:143]
    ds_read_b64_tr_b16 a[200:201], v28 offset:28672
    ds_read_b64_tr_b16 a[202:203], v28 offset:29184
    s_waitcnt lgkmcnt(6)
    v_mfma_f32_16x16x32_bf16 v[144:147], a[168:171], a[72:75], v[144:147]
    ds_read_b64_tr_b16 a[204:205], v29 offset:28672
    buffer_load_dword v255, v247, s[64:67], s93 offen
    v_mfma_f32_16x16x32_bf16 v[148:151], a[168:171], a[76:79], v[148:151]
    ds_read_b64_tr_b16 a[206:207], v29 offset:29184
    v_mfma_f32_16x16x32_bf16 v[152:155], a[172:175], a[72:75], v[152:155]
    v_mfma_f32_16x16x32_bf16 v[156:159], a[172:175], a[76:79], v[156:159]
    s_waitcnt lgkmcnt(4)
    v_mfma_f32_16x16x32_bf16 v[128:131], a[192:195], a[80:83], v[128:131]
    ds_read_b64_tr_b16 a[160:161], v26 offset:32768
    ds_read_b64_tr_b16 a[162:163], v26 offset:33280
    v_mfma_f32_16x16x32_bf16 v[132:135], a[192:195], a[84:87], v[132:135]
    ds_read_b64_tr_b16 a[164:165], v27 offset:32768
    v_mfma_f32_16x16x32_bf16 v[136:139], a[196:199], a[80:83], v[136:139]
    ds_read_b64_tr_b16 a[166:167], v27 offset:33280
    v_mfma_f32_16x16x32_bf16 v[140:143], a[196:199], a[84:87], v[140:143]
    ds_read_b64_tr_b16 a[168:169], v28 offset:32768
    ds_read_b64_tr_b16 a[170:171], v28 offset:33280
    s_waitcnt lgkmcnt(6)
    v_mfma_f32_16x16x32_bf16 v[144:147], a[200:203], a[80:83], v[144:147]
    ds_read_b64_tr_b16 a[172:173], v29 offset:32768
    v_mfma_f32_16x16x32_bf16 v[148:151], a[200:203], a[84:87], v[148:151]
    ds_read_b64_tr_b16 a[174:175], v29 offset:33280
    v_mfma_f32_16x16x32_bf16 v[152:155], a[204:207], a[80:83], v[152:155]
    v_mfma_f32_16x16x32_bf16 v[156:159], a[204:207], a[84:87], v[156:159]
    s_waitcnt vmcnt(25)
    s_barrier
    s_waitcnt lgkmcnt(4)
    v_mfma_f32_16x16x32_bf16 v[128:131], a[160:163], a[88:91], v[128:131]
    v_add_u32 v26, 4294844416, v26
    v_add_u32 v27, 4294844416, v27
    v_mfma_f32_16x16x32_bf16 v[132:135], a[160:163], a[92:95], v[132:135]
    v_add_u32 v28, 4294844416, v28
    v_add_u32 v29, 4294844416, v29
    v_mfma_f32_16x16x32_bf16 v[136:139], a[164:167], a[88:91], v[136:139]
    ds_read_b64_tr_b16 a[192:193], v26 offset:0
    ds_read_b64_tr_b16 a[194:195], v26 offset:512
    v_mfma_f32_16x16x32_bf16 v[140:143], a[164:167], a[92:95], v[140:143]
    ds_read_b64_tr_b16 a[196:197], v27 offset:0
    ds_read_b64_tr_b16 a[198:199], v27 offset:512
    s_waitcnt lgkmcnt(4)
    v_mfma_f32_16x16x32_bf16 v[144:147], a[168:171], a[88:91], v[144:147]
    ds_read_b64_tr_b16 a[200:201], v28 offset:0
    ds_read_b64_tr_b16 a[202:203], v28 offset:512
    v_mfma_f32_16x16x32_bf16 v[148:151], a[168:171], a[92:95], v[148:151]
    ds_read_b64_tr_b16 a[204:205], v29 offset:0
    ds_read_b64_tr_b16 a[206:207], v29 offset:512
    v_mfma_f32_16x16x32_bf16 v[152:155], a[172:175], a[88:91], v[152:155]
    v_mfma_f32_16x16x32_bf16 v[156:159], a[172:175], a[92:95], v[156:159]
    s_waitcnt lgkmcnt(4)
    v_mfma_f32_16x16x32_bf16 v[128:131], a[192:195], a[96:99], v[128:131]
    ds_read_b64_tr_b16 a[160:161], v26 offset:4096
    ds_read_b64_tr_b16 a[162:163], v26 offset:4608
    v_mfma_f32_16x16x32_bf16 v[132:135], a[192:195], a[100:103], v[132:135]
    ds_read_b64_tr_b16 a[164:165], v27 offset:4096
    v_mfma_f32_16x16x32_bf16 v[136:139], a[196:199], a[96:99], v[136:139]
    ds_read_b64_tr_b16 a[166:167], v27 offset:4608
    v_mfma_f32_16x16x32_bf16 v[140:143], a[196:199], a[100:103], v[140:143]
    ds_read_b64_tr_b16 a[168:169], v28 offset:4096
    ds_read_b64_tr_b16 a[170:171], v28 offset:4608
    s_waitcnt lgkmcnt(6)
    v_mfma_f32_16x16x32_bf16 v[144:147], a[200:203], a[96:99], v[144:147]
    ds_read_b64_tr_b16 a[172:173], v29 offset:4096
    v_mfma_f32_16x16x32_bf16 v[148:151], a[200:203], a[100:103], v[148:151]
    ds_read_b64_tr_b16 a[174:175], v29 offset:4608
    v_mfma_f32_16x16x32_bf16 v[152:155], a[204:207], a[96:99], v[152:155]
    v_mfma_f32_16x16x32_bf16 v[156:159], a[204:207], a[100:103], v[156:159]
    s_waitcnt lgkmcnt(4)
    v_mfma_f32_16x16x32_bf16 v[128:131], a[160:163], a[104:107], v[128:131]
    ds_read_b64_tr_b16 a[192:193], v26 offset:8192
    ds_read_b64_tr_b16 a[194:195], v26 offset:8704
    v_mfma_f32_16x16x32_bf16 v[132:135], a[160:163], a[108:111], v[132:135]
    ds_read_b64_tr_b16 a[196:197], v27 offset:8192
    v_mfma_f32_16x16x32_bf16 v[136:139], a[164:167], a[104:107], v[136:139]
    ds_read_b64_tr_b16 a[198:199], v27 offset:8704
    v_mfma_f32_16x16x32_bf16 v[140:143], a[164:167], a[108:111], v[140:143]
    ds_read_b64_tr_b16 a[200:201], v28 offset:8192
    ds_read_b64_tr_b16 a[202:203], v28 offset:8704
    s_waitcnt lgkmcnt(6)
    v_mfma_f32_16x16x32_bf16 v[144:147], a[168:171], a[104:107], v[144:147]
    ds_read_b64_tr_b16 a[204:205], v29 offset:8192
    v_mfma_f32_16x16x32_bf16 v[148:151], a[168:171], a[108:111], v[148:151]
    ds_read_b64_tr_b16 a[206:207], v29 offset:8704
    v_mfma_f32_16x16x32_bf16 v[152:155], a[172:175], a[104:107], v[152:155]
    v_mfma_f32_16x16x32_bf16 v[156:159], a[172:175], a[108:111], v[156:159]
    s_waitcnt lgkmcnt(4)
    v_mfma_f32_16x16x32_bf16 v[128:131], a[192:195], a[112:115], v[128:131]
    ds_read_b64_tr_b16 a[160:161], v26 offset:12288
    ds_read_b64_tr_b16 a[162:163], v26 offset:12800
    v_mfma_f32_16x16x32_bf16 v[132:135], a[192:195], a[116:119], v[132:135]
    ds_read_b64_tr_b16 a[164:165], v27 offset:12288
    v_mfma_f32_16x16x32_bf16 v[136:139], a[196:199], a[112:115], v[136:139]
    ds_read_b64_tr_b16 a[166:167], v27 offset:12800
    v_mfma_f32_16x16x32_bf16 v[140:143], a[196:199], a[116:119], v[140:143]
    ds_read_b64_tr_b16 a[168:169], v28 offset:12288
    ds_read_b64_tr_b16 a[170:171], v28 offset:12800
    s_waitcnt lgkmcnt(6)
    v_mfma_f32_16x16x32_bf16 v[144:147], a[200:203], a[112:115], v[144:147]
    ds_read_b64_tr_b16 a[172:173], v29 offset:12288
    v_mfma_f32_16x16x32_bf16 v[148:151], a[200:203], a[116:119], v[148:151]
    ds_read_b64_tr_b16 a[174:175], v29 offset:12800
    v_mfma_f32_16x16x32_bf16 v[152:155], a[204:207], a[112:115], v[152:155]
    v_mfma_f32_16x16x32_bf16 v[156:159], a[204:207], a[116:119], v[156:159]
    s_waitcnt vmcnt(21)
    s_waitcnt vmcnt(3)
    s_barrier
    s_cmp_lg_u32 s5, 0
    s_cbranch_scc1 L_nosend_23
    v_add_u32 v5, 48, v3
    s_lshl_b32 s11, s4, 2
    s_add_u32 s11, s11, 384
    s_mov_b64 exec, 0xff00
    buffer_store_dword v5, v4, s[52:55], s11 offen sc1
    s_mov_b64 exec, -1
L_nosend_23:
    s_waitcnt lgkmcnt(4)
    v_mfma_f32_16x16x32_bf16 v[128:131], a[160:163], a[120:123], v[128:131]
    ds_read_b64_tr_b16 a[192:193], v26 offset:20480
    ds_read_b64_tr_b16 a[194:195], v26 offset:20992
    v_mfma_f32_16x16x32_bf16 v[132:135], a[160:163], a[124:127], v[132:135]
    ds_read_b64_tr_b16 a[196:197], v27 offset:20480
    buffer_load_dwordx4 v16, s[56:59], s80 offen offset:0 lds
    v_mfma_f32_16x16x32_bf16 v[136:139], a[164:167], a[120:123], v[136:139]
    ds_read_b64_tr_b16 a[198:199], v27 offset:20992
    v_mfma_f32_16x16x32_bf16 v[140:143], a[164:167], a[124:127], v[140:143]
    ds_read_b64_tr_b16 a[200:201], v28 offset:20480
    ds_read_b64_tr_b16 a[202:203], v28 offset:20992
    s_waitcnt lgkmcnt(6)
    v_mfma_f32_16x16x32_bf16 v[144:147], a[168:171], a[120:123], v[144:147]
    ds_read_b64_tr_b16 a[204:205], v29 offset:20480
    buffer_load_dwordx4 v17, s[56:59], s80 offen offset:1024 lds
    v_mfma_f32_16x16x32_bf16 v[148:151], a[168:171], a[124:127], v[148:151]
    ds_read_b64_tr_b16 a[206:207], v29 offset:20992
    v_mfma_f32_16x16x32_bf16 v[152:155], a[172:175], a[120:123], v[152:155]
    buffer_load_dwordx4 v18, s[56:59], s80 offen offset:2048 lds
    v_mfma_f32_16x16x32_bf16 v[156:159], a[172:175], a[124:127], v[156:159]
    s_waitcnt lgkmcnt(4)
    v_mfma_f32_16x16x32_bf16 v[128:131], a[192:195], a[128:131], v[128:131]
    ds_read_b64_tr_b16 a[160:161], v26 offset:24576
    ds_read_b64_tr_b16 a[162:163], v26 offset:25088
    v_mfma_f32_16x16x32_bf16 v[132:135], a[192:195], a[132:135], v[132:135]
    ds_read_b64_tr_b16 a[164:165], v27 offset:24576
    v_mfma_f32_16x16x32_bf16 v[136:139], a[196:199], a[128:131], v[136:139]
    ds_read_b64_tr_b16 a[166:167], v27 offset:25088
    buffer_load_dwordx4 v19, s[56:59], s80 offen offset:3072 lds
    s_add_u32 s80, s80, 393344
    s_sub_u32 s14, s80, 1966080
    s_cselect_b32 s80, s80, s14
    s_add_u32 m0, s87, 143360
    v_mfma_f32_16x16x32_bf16 v[140:143], a[196:199], a[132:135], v[140:143]
    ds_read_b64_tr_b16 a[168:169], v28 offset:24576
    ds_read_b64_tr_b16 a[170:171], v28 offset:25088
    s_waitcnt lgkmcnt(6)
    v_mfma_f32_16x16x32_bf16 v[144:147], a[200:203], a[128:131], v[144:147]
    ds_read_b64_tr_b16 a[172:173], v29 offset:24576
    v_mfma_f32_16x16x32_bf16 v[148:151], a[200:203], a[132:135], v[148:151]
    ds_read_b64_tr_b16 a[174:175], v29 offset:25088
    v_mfma_f32_16x16x32_bf16 v[152:155], a[204:207], a[128:131], v[152:155]
    buffer_load_dwordx4 v20, s[64:67], s81 offen offset:0 lds
    v_mfma_f32_16x16x32_bf16 v[156:159], a[204:207], a[132:135], v[156:159]
    s_waitcnt lgkmcnt(4)
    v_mfma_f32_16x16x32_bf16 v[128:131], a[160:163], a[136:139], v[128:131]
    ds_read_b64_tr_b16 a[192:193], v26 offset:28672
    ds_read_b64_tr_b16 a[194:195], v26 offset:29184
    v_mfma_f32_16x16x32_bf16 v[132:135], a[160:163], a[140:143], v[132:135]
    ds_read_b64_tr_b16 a[196:197], v27 offset:28672
    v_mfma_f32_16x16x32_bf16 v[136:139], a[164:167], a[136:139], v[136:139]
    ds_read_b64_tr_b16 a[198:199], v27 offset:29184
    buffer_load_dwordx4 v21, s[64:67], s81 offen offset:1024 lds
    v_mfma_f32_16x16x32_bf16 v[140:143], a[164:167], a[140:143], v[140:143]
    ds_read_b64_tr_b16 a[200:201], v28 offset:28672
    ds_read_b64_tr_b16 a[202:203], v28 offset:29184
    s_waitcnt lgkmcnt(6)
    v_mfma_f32_16x16x32_bf16 v[144:147], a[168:171], a[136:139], v[144:147]
    ds_read_b64_tr_b16 a[204:205], v29 offset:28672
    v_mfma_f32_16x16x32_bf16 v[148:151], a[168:171], a[140:143], v[148:151]
    ds_read_b64_tr_b16 a[206:207], v29 offset:29184
    v_mfma_f32_16x16x32_bf16 v[152:155], a[172:175], a[136:139], v[152:155]
    buffer_load_dwordx4 v22, s[64:67], s81 offen offset:2048 lds
    v_mfma_f32_16x16x32_bf16 v[156:159], a[172:175], a[140:143], v[156:159]
    s_waitcnt lgkmcnt(4)
    v_mfma_f32_16x16x32_bf16 v[128:131], a[192:195], a[144:147], v[128:131]
    ds_read_b64_tr_b16 a[160:161], v26 offset:32768
    ds_read_b64_tr_b16 a[162:163], v26 offset:33280
    v_mfma_f32_16x16x32_bf16 v[132:135], a[192:195], a[148:151], v[132:135]
    ds_read_b64_tr_b16 a[164:165], v27 offset:32768
    v_mfma_f32_16x16x32_bf16 v[136:139], a[196:199], a[144:147], v[136:139]
    ds_read_b64_tr_b16 a[166:167], v27 offset:33280
    buffer_load_dwordx4 v23, s[64:67], s81 offen offset:3072 lds
    s_add_u32 m0, s15, 143360
    v_mfma_f32_16x16x32_bf16 v[140:143], a[196:199], a[148:151], v[140:143]
    ds_read_b64_tr_b16 a[168:169], v28 offset:32768
    ds_read_b64_tr_b16 a[170:171], v28 offset:33280
    s_waitcnt lgkmcnt(6)
    v_mfma_f32_16x16x32_bf16 v[144:147], a[200:203], a[144:147], v[144:147]
    ds_read_b64_tr_b16 a[172:173], v29 offset:32768
    v_mfma_f32_16x16x32_bf16 v[148:151], a[200:203], a[148:151], v[148:151]
    ds_read_b64_tr_b16 a[174:175], v29 offset:33280
    v_mfma_f32_16x16x32_bf16 v[152:155], a[204:207], a[144:147], v[152:155]
    buffer_load_dwordx4 v24, s[64:67], s81 offen offset:0 lds
    s_add_u32 s81, s81, 491520
    s_sub_u32 s14, s81, 1966080
    s_cselect_b32 s81, s81, s14
    s_add_u32 m0, s87, 0
    v_mfma_f32_16x16x32_bf16 v[156:159], a[204:207], a[148:151], v[156:159]
    s_barrier
    s_waitcnt lgkmcnt(4)
    v_mfma_f32_16x16x32_bf16 v[128:131], a[160:163], a[152:155], v[128:131]
    ds_read_b64_tr_b16 a[192:193], v26 offset:40960
    ds_read_b64_tr_b16 a[194:195], v26 offset:41472
    v_mfma_f32_16x16x32_bf16 v[132:135], a[160:163], a[156:159], v[132:135]
    ds_read_b64_tr_b16 a[196:197], v27 offset:40960
    buffer_load_dwordx4 v20, s[64:67], s81 offen offset:0 lds
    v_mfma_f32_16x16x32_bf16 v[136:139], a[164:167], a[152:155], v[136:139]
    ds_read_b64_tr_b16 a[198:199], v27 offset:41472
    v_mfma_f32_16x16x32_bf16 v[140:143], a[164:167], a[156:159], v[140:143]
    ds_read_b64_tr_b16 a[200:201], v28 offset:40960
    ds_read_b64_tr_b16 a[202:203], v28 offset:41472
    s_waitcnt lgkmcnt(6)
    v_mfma_f32_16x16x32_bf16 v[144:147], a[168:171], a[152:155], v[144:147]
    ds_read_b64_tr_b16 a[204:205], v29 offset:40960
    buffer_load_dwordx4 v21, s[64:67], s81 offen offset:1024 lds
    v_mfma_f32_16x16x32_bf16 v[148:151], a[168:171], a[156:159], v[148:151]
    ds_read_b64_tr_b16 a[206:207], v29 offset:41472
    v_mfma_f32_16x16x32_bf16 v[152:155], a[172:175], a[152:155], v[152:155]
    buffer_load_dwordx4 v22, s[64:67], s81 offen offset:2048 lds
    v_mfma_f32_16x16x32_bf16 v[156:159], a[172:175], a[156:159], v[156:159]
    s_waitcnt lgkmcnt(4)
    v_mfma_f32_16x16x32_bf16 v[96:99], a[192:195], a[0:3], 0
    ds_read_b64_tr_b16 a[160:161], v26 offset:45056
    ds_read_b64_tr_b16 a[162:163], v26 offset:45568
    v_mfma_f32_16x16x32_bf16 v[100:103], a[192:195], a[4:7], 0
    ds_read_b64_tr_b16 a[164:165], v27 offset:45056
    v_mfma_f32_16x16x32_bf16 v[104:107], a[196:199], a[0:3], 0
    ds_read_b64_tr_b16 a[166:167], v27 offset:45568
    buffer_load_dwordx4 v23, s[64:67], s81 offen offset:3072 lds
    s_add_u32 m0, s15, 0
    v_mfma_f32_16x16x32_bf16 v[108:111], a[196:199], a[4:7], 0
    ds_read_b64_tr_b16 a[168:169], v28 offset:45056
    ds_read_b64_tr_b16 a[170:171], v28 offset:45568
    s_waitcnt lgkmcnt(6)
    v_mfma_f32_16x16x32_bf16 v[112:115], a[200:203], a[0:3], 0
    ds_read_b64_tr_b16 a[172:173], v29 offset:45056
    v_mfma_f32_16x16x32_bf16 v[116:119], a[200:203], a[4:7], 0
    ds_read_b64_tr_b16 a[174:175], v29 offset:45568
    v_mfma_f32_16x16x32_bf16 v[120:123], a[204:207], a[0:3], 0
    buffer_load_dwordx4 v24, s[64:67], s81 offen offset:0 lds
    s_add_u32 s81, s81, 491520
    s_sub_u32 s14, s81, 1966080
    s_cselect_b32 s81, s81, s14
    s_add_u32 m0, s87, 20480
    v_mfma_f32_16x16x32_bf16 v[124:127], a[204:207], a[4:7], 0
    s_waitcnt lgkmcnt(4)
    v_mfma_f32_16x16x32_bf16 v[96:99], a[160:163], a[8:11], v[96:99]
    ds_read_b64_tr_b16 a[192:193], v26 offset:49152
    ds_read_b64_tr_b16 a[194:195], v26 offset:49664
    v_cvt_pk_bf16_f32 v192, v128, v129
    v_mfma_f32_16x16x32_bf16 v[100:103], a[160:163], a[12:15], v[100:103]
    ds_read_b64_tr_b16 a[196:197], v27 offset:49152
    v_cvt_pk_bf16_f32 v193, v130, v131
    v_mfma_f32_16x16x32_bf16 v[104:107], a[164:167], a[8:11], v[104:107]
    ds_read_b64_tr_b16 a[198:199], v27 offset:49664
    v_cvt_pk_bf16_f32 v194, v136, v137
    v_mfma_f32_16x16x32_bf16 v[108:111], a[164:167], a[12:15], v[108:111]
    ds_read_b64_tr_b16 a[200:201], v28 offset:49152
    ds_read_b64_tr_b16 a[202:203], v28 offset:49664
    v_cvt_pk_bf16_f32 v195, v138, v139
    s_waitcnt lgkmcnt(6)
    v_mfma_f32_16x16x32_bf16 v[112:115], a[168:171], a[8:11], v[112:115]
    ds_read_b64_tr_b16 a[204:205], v29 offset:49152
    v_pk_max_i16 v192, v192, 0
    v_and_b32 v11, 7, v1
    v_lshlrev_b32 v11, 2, v11
    s_add_u32 s46, s9, 384
    buffer_load_dword v10, v11, s[52:55], s46 offen sc1
    v_mfma_f32_16x16x32_bf16 v[116:119], a[168:171], a[12:15], v[116:119]
    ds_read_b64_tr_b16 a[206:207], v29 offset:49664
    v_pk_max_i16 v193, v193, 0
    v_mfma_f32_16x16x32_bf16 v[120:123], a[172:175], a[8:11], v[120:123]
    v_pk_max_i16 v194, v194, 0
    v_mfma_f32_16x16x32_bf16 v[124:127], a[172:175], a[12:15], v[124:127]
    v_pk_max_i16 v195, v195, 0
    buffer_store_dwordx4 v[192:195], v2, s[52:55], s90 offen offset:0 sc1
    s_waitcnt lgkmcnt(4)
    v_mfma_f32_16x16x32_bf16 v[96:99], a[192:195], a[16:19], v[96:99]
    ds_read_b64_tr_b16 a[160:161], v26 offset:53248
    ds_read_b64_tr_b16 a[162:163], v26 offset:53760
    v_mfma_f32_16x16x32_bf16 v[100:103], a[192:195], a[20:23], v[100:103]
    ds_read_b64_tr_b16 a[164:165], v27 offset:53248
    v_mfma_f32_16x16x32_bf16 v[104:107], a[196:199], a[16:19], v[104:107]
    ds_read_b64_tr_b16 a[166:167], v27 offset:53760
    v_mfma_f32_16x16x32_bf16 v[108:111], a[196:199], a[20:23], v[108:111]
    ds_read_b64_tr_b16 a[168:169], v28 offset:53248
    ds_read_b64_tr_b16 a[170:171], v28 offset:53760
    s_waitcnt lgkmcnt(6)
    v_mfma_f32_16x16x32_bf16 v[112:115], a[200:203], a[16:19], v[112:115]
    ds_read_b64_tr_b16 a[172:173], v29 offset:53248
    v_mfma_f32_16x16x32_bf16 v[116:119], a[200:203], a[20:23], v[116:119]
    ds_read_b64_tr_b16 a[174:175], v29 offset:53760
    v_mfma_f32_16x16x32_bf16 v[120:123], a[204:207], a[16:19], v[120:123]
    v_mfma_f32_16x16x32_bf16 v[124:127], a[204:207], a[20:23], v[124:127]
    s_barrier
    s_waitcnt lgkmcnt(4)
    v_mfma_f32_16x16x32_bf16 v[96:99], a[160:163], a[24:27], v[96:99]
    v_add_u32 v26, 61440, v26
    v_add_u32 v27, 61440, v27
    v_cvt_pk_bf16_f32 v196, v132, v133
    v_mfma_f32_16x16x32_bf16 v[100:103], a[160:163], a[28:31], v[100:103]
    v_add_u32 v28, 61440, v28
    v_add_u32 v29, 61440, v29
    v_cvt_pk_bf16_f32 v197, v134, v135
    v_mfma_f32_16x16x32_bf16 v[104:107], a[164:167], a[24:27], v[104:107]
    ds_read_b64_tr_b16 a[192:193], v26 offset:0
    ds_read_b64_tr_b16 a[194:195], v26 offset:512
    v_cvt_pk_bf16_f32 v198, v140, v141
    buffer_load_dwordx4 v20, s[64:67], s81 offen offset:0 lds
    v_mfma_f32_16x16x32_bf16 v[108:111], a[164:167], a[28:31], v[108:111]
    ds_read_b64_tr_b16 a[196:197], v27 offset:0
    ds_read_b64_tr_b16 a[198:199], v27 offset:512
    v_cvt_pk_bf16_f32 v199, v142, v143
    s_waitcnt lgkmcnt(4)
    v_mfma_f32_16x16x32_bf16 v[112:115], a[168:171], a[24:27], v[112:115]
    ds_read_b64_tr_b16 a[200:201], v28 offset:0
    ds_read_b64_tr_b16 a[202:203], v28 offset:512
    v_pk_max_i16 v196, v196, 0
    v_mfma_f32_16x16x32_bf16 v[116:119], a[168:171], a[28:31], v[116:119]
    ds_read_b64_tr_b16 a[204:205], v29 offset:0
    ds_read_b64_tr_b16 a[206:207], v29 offset:512
    v_pk_max_i16 v197, v197, 0
    v_mfma_f32_16x16x32_bf16 v[120:123], a[172:175], a[24:27], v[120:123]
    v_pk_max_i16 v198, v198, 0
    buffer_load_dwordx4 v21, s[64:67], s81 offen offset:1024 lds
    v_mfma_f32_16x16x32_bf16 v[124:127], a[172:175], a[28:31], v[124:127]
    v_pk_max_i16 v199, v199, 0
    buffer_store_dwordx4 v[196:199], v35, s[52:55], s90 offen offset:0 sc1
    s_waitcnt lgkmcnt(4)
    v_mfma_f32_16x16x32_bf16 v[96:99], a[192:195], a[32:35], v[96:99]
    ds_read_b64_tr_b16 a[160:161], v26 offset:4096
    ds_read_b64_tr_b16 a[162:163], v26 offset:4608
    v_mfma_f32_16x16x32_bf16 v[100:103], a[192:195], a[36:39], v[100:103]
    ds_read_b64_tr_b16 a[164:165], v27 offset:4096
    v_mfma_f32_16x16x32_bf16 v[104:107], a[196:199], a[32:35], v[104:107]
    ds_read_b64_tr_b16 a[166:167], v27 offset:4608
    buffer_load_dwordx4 v22, s[64:67], s81 offen offset:2048 lds
    v_mfma_f32_16x16x32_bf16 v[108:111], a[196:199], a[36:39], v[108:111]
    ds_read_b64_tr_b16 a[168:169], v28 offset:4096
    ds_read_b64_tr_b16 a[170:171], v28 offset:4608
    s_waitcnt lgkmcnt(6)
    v_mfma_f32_16x16x32_bf16 v[112:115], a[200:203], a[32:35], v[112:115]
    ds_read_b64_tr_b16 a[172:173], v29 offset:4096
    v_mfma_f32_16x16x32_bf16 v[116:119], a[200:203], a[36:39], v[116:119]
    ds_read_b64_tr_b16 a[174:175], v29 offset:4608
    v_mfma_f32_16x16x32_bf16 v[120:123], a[204:207], a[32:35], v[120:123]
    buffer_load_dwordx4 v23, s[64:67], s81 offen offset:3072 lds
    s_add_u32 m0, s15, 20480
    v_mfma_f32_16x16x32_bf16 v[124:127], a[204:207], a[36:39], v[124:127]
    s_waitcnt lgkmcnt(4)
    v_mfma_f32_16x16x32_bf16 v[96:99], a[160:163], a[40:43], v[96:99]
    ds_read_b64_tr_b16 a[192:193], v26 offset:8192
    ds_read_b64_tr_b16 a[194:195], v26 offset:8704
    v_cvt_pk_bf16_f32 v200, v144, v145
    v_mfma_f32_16x16x32_bf16 v[100:103], a[160:163], a[44:47], v[100:103]
    ds_read_b64_tr_b16 a[196:197], v27 offset:8192
    v_cvt_pk_bf16_f32 v201, v146, v147
    v_mfma_f32_16x16x32_bf16 v[104:107], a[164:167], a[40:43], v[104:107]
    ds_read_b64_tr_b16 a[198:199], v27 offset:8704
    v_cvt_pk_bf16_f32 v202, v152, v153
    v_mfma_f32_16x16x32_bf16 v[108:111], a[164:167], a[44:47], v[108:111]
    ds_read_b64_tr_b16 a[200:201], v28 offset:8192
    ds_read_b64_tr_b16 a[202:203], v28 offset:8704
    v_cvt_pk_bf16_f32 v203, v154, v155
    s_waitcnt lgkmcnt(6)
    v_mfma_f32_16x16x32_bf16 v[112:115], a[168:171], a[40:43], v[112:115]
    ds_read_b64_tr_b16 a[204:205], v29 offset:8192
    v_pk_max_i16 v200, v200, 0
    buffer_load_dwordx4 v24, s[64:67], s81 offen offset:0 lds
    s_add_u32 s81, s81, 491520
    s_sub_u32 s14, s81, 1966080
    s_cselect_b32 s81, s81, s14
    s_add_u32 m0, s87, 40960
    v_mfma_f32_16x16x32_bf16 v[116:119], a[168:171], a[44:47], v[116:119]
    ds_read_b64_tr_b16 a[206:207], v29 offset:8704
    v_pk_max_i16 v201, v201, 0
    v_mfma_f32_16x16x32_bf16 v[120:123], a[172:175], a[40:43], v[120:123]
    v_pk_max_i16 v202, v202, 0
    v_mfma_f32_16x16x32_bf16 v[124:127], a[172:175], a[44:47], v[124:127]
    v_pk_max_i16 v203, v203, 0
    buffer_store_dwordx4 v[200:203], v2, s[52:55], s90 offen offset:1024 sc1
    s_add_u32 s12, s7, 48
    s_waitcnt vmcnt(8)
    v_cmp_eq_u32 vcc, s12, v10
    s_nop 0
    s_cmp_eq_u64 vcc, exec
    s_cbranch_scc1 L_ready_24
    v_and_b32 v11, 7, v1
    v_lshlrev_b32 v11, 2, v11
    s_add_u32 s11, s9, 384
    s_add_u32 s12, s7, 48
L_poll_25:
    buffer_load_dword v10, v11, s[52:55], s11 offen sc1
    s_cmp_eq_u32 s10, 0
    s_waitcnt vmcnt(0)
    s_cbranch_scc1 L_polled_26
    s_sub_u32 s10, s10, 1
    v_cmp_eq_u32 vcc, s12, v10
    s_nop 0
    s_cmp_eq_u64 vcc, exec
    s_cbranch_scc0 L_poll_25
L_polled_26:
L_ready_24:
    s_waitcnt lgkmcnt(4)
    v_mfma_f32_16x16x32_bf16 v[96:99], a[192:195], a[48:51], v[96:99]
    ds_read_b64_tr_b16 a[160:161], v26 offset:12288
    ds_read_b64_tr_b16 a[162:163], v26 offset:12800
    v_mfma_f32_16x16x32_bf16 v[100:103], a[192:195], a[52:55], v[100:103]
    ds_read_b64_tr_b16 a[164:165], v27 offset:12288
    s_add_u32 s84, s89, 0
    s_add_u32 s85, s84, 16384
    s_add_u32 s83, s91, s84
    buffer_load_dwordx4 a[0:3], v36, s[52:55], s83 offen sc1
    v_mfma_f32_16x16x32_bf16 v[104:107], a[196:199], a[48:51], v[104:107]
    ds_read_b64_tr_b16 a[166:167], v27 offset:12800
    v_mfma_f32_16x16x32_bf16 v[108:111], a[196:199], a[52:55], v[108:111]
    ds_read_b64_tr_b16 a[168:169], v28 offset:12288
    ds_read_b64_tr_b16 a[170:171], v28 offset:12800
    s_waitcnt lgkmcnt(6)
    v_mfma_f32_16x16x32_bf16 v[112:115], a[200:203], a[48:51], v[112:115]
    ds_read_b64_tr_b16 a[172:173], v29 offset:12288
    buffer_load_dwordx4 a[4:7], v37, s[52:55], s83 offen sc1
    v_mfma_f32_16x16x32_bf16 v[116:119], a[200:203], a[52:55], v[116:119]
    ds_read_b64_tr_b16 a[174:175], v29 offset:12800
    v_mfma_f32_16x16x32_bf16 v[120:123], a[204:207], a[48:51], v[120:123]
    buffer_load_dwordx4 a[8:11], v38, s[52:55], s83 offen sc1
    v_mfma_f32_16x16x32_bf16 v[124:127], a[204:207], a[52:55], v[124:127]
    s_barrier
    s_waitcnt lgkmcnt(4)
    v_mfma_f32_16x16x32_bf16 v[96:99], a[160:163], a[56:59], v[96:99]
    ds_read_b64_tr_b16 a[192:193], v26 offset:20480
    ds_read_b64_tr_b16 a[194:195], v26 offset:20992
    v_cvt_pk_bf16_f32 v204, v148, v149
    v_mfma_f32_16x16x32_bf16 v[100:103], a[160:163], a[60:63], v[100:103]
    ds_read_b64_tr_b16 a[196:197], v27 offset:20480
    v_cvt_pk_bf16_f32 v205, v150, v151
    v_mfma_f32_16x16x32_bf16 v[104:107], a[164:167], a[56:59], v[104:107]
    ds_read_b64_tr_b16 a[198:199], v27 offset:20992
    v_cvt_pk_bf16_f32 v206, v156, v157
    v_mfma_f32_16x16x32_bf16 v[108:111], a[164:167], a[60:63], v[108:111]
    ds_read_b64_tr_b16 a[200:201], v28 offset:20480
    ds_read_b64_tr_b16 a[202:203], v28 offset:20992
    v_cvt_pk_bf16_f32 v207, v158, v159
    s_waitcnt lgkmcnt(6)
    v_mfma_f32_16x16x32_bf16 v[112:115], a[168:171], a[56:59], v[112:115]
    ds_read_b64_tr_b16 a[204:205], v29 offset:20480
    v_pk_max_i16 v204, v204, 0
    buffer_load_dwordx4 a[12:15], v39, s[52:55], s83 offen sc1
    v_mfma_f32_16x16x32_bf16 v[116:119], a[168:171], a[60:63], v[116:119]
    ds_read_b64_tr_b16 a[206:207], v29 offset:20992
    v_pk_max_i16 v205, v205, 0
    v_mfma_f32_16x16x32_bf16 v[120:123], a[172:175], a[56:59], v[120:123]
    v_pk_max_i16 v206, v206, 0
    v_mfma_f32_16x16x32_bf16 v[124:127], a[172:175], a[60:63], v[124:127]
    v_pk_max_i16 v207, v207, 0
    buffer_store_dwordx4 v[204:207], v35, s[52:55], s90 offen offset:1024 sc1
    s_add_u32 s90, s90, 16384
    s_waitcnt lgkmcnt(4)
    v_mfma_f32_16x16x32_bf16 v[96:99], a[192:195], a[64:67], v[96:99]
    ds_read_b64_tr_b16 a[160:161], v26 offset:24576
    ds_read_b64_tr_b16 a[162:163], v26 offset:25088
    v_mfma_f32_16x16x32_bf16 v[100:103], a[192:195], a[68:71], v[100:103]
    ds_read_b64_tr_b16 a[164:165], v27 offset:24576
    v_mfma_f32_16x16x32_bf16 v[104:107], a[196:199], a[64:67], v[104:107]
    ds_read_b64_tr_b16 a[166:167], v27 offset:25088
    buffer_load_dwordx4 a[16:19], v40, s[52:55], s83 offen sc1
    v_mfma_f32_16x16x32_bf16 v[108:111], a[196:199], a[68:71], v[108:111]
    ds_read_b64_tr_b16 a[168:169], v28 offset:24576
    ds_read_b64_tr_b16 a[170:171], v28 offset:25088
    s_waitcnt lgkmcnt(6)
    v_mfma_f32_16x16x32_bf16 v[112:115], a[200:203], a[64:67], v[112:115]
    ds_read_b64_tr_b16 a[172:173], v29 offset:24576
    v_mfma_f32_16x16x32_bf16 v[116:119], a[200:203], a[68:71], v[116:119]
    ds_read_b64_tr_b16 a[174:175], v29 offset:25088
    v_mfma_f32_16x16x32_bf16 v[120:123], a[204:207], a[64:67], v[120:123]
    buffer_load_dwordx4 a[20:23], v41, s[52:55], s83 offen sc1
    v_mfma_f32_16x16x32_bf16 v[124:127], a[204:207], a[68:71], v[124:127]
    s_waitcnt lgkmcnt(4)
    v_mfma_f32_16x16x32_bf16 v[96:99], a[160:163], a[72:75], v[96:99]
    ds_read_b64_tr_b16 a[192:193], v26 offset:28672
    ds_read_b64_tr_b16 a[194:195], v26 offset:29184
    v_mfma_f32_16x16x32_bf16 v[100:103], a[160:163], a[76:79], v[100:103]
    ds_read_b64_tr_b16 a[196:197], v27 offset:28672
    buffer_load_dwordx4 a[24:27], v42, s[52:55], s83 offen sc1
    v_mfma_f32_16x16x32_bf16 v[104:107], a[164:167], a[72:75], v[104:107]
    ds_read_b64_tr_b16 a[198:199], v27 offset:29184
    v_mfma_f32_16x16x32_bf16 v[108:111], a[164:167], a[76:79], v[108:111]
    ds_read_b64_tr_b16 a[200:201], v28 offset:28672
    ds_read_b64_tr_b16 a[202:203], v28 offset:29184
    s_waitcnt lgkmcnt(6)
    v_mfma_f32_16x16x32_bf16 v[112:115], a[168:171], a[72:75], v[112:115]
    ds_read_b64_tr_b16 a[204:205], v29 offset:28672
    buffer_load_dwordx4 a[28:31], v43, s[52:55], s83 offen sc1
    s_add_u32 s83, s83, 4096
    s_cmp_eq_u32 s83, s85
    s_cselect_b32 s83, s84, s83
    v_mfma_f32_16x16x32_bf16 v[116:119], a[168:171], a[76:79], v[116:119]
    ds_read_b64_tr_b16 a[206:207], v29 offset:29184
    v_mfma_f32_16x16x32_bf16 v[120:123], a[172:175], a[72:75], v[120:123]
    buffer_load_dwordx4 a[32:35], v36, s[52:55], s83 offen sc1
    v_mfma_f32_16x16x32_bf16 v[124:127], a[172:175], a[76:79], v[124:127]
    s_waitcnt lgkmcnt(4)
    v_mfma_f32_16x16x32_bf16 v[96:99], a[192:195], a[80:83], v[96:99]
    ds_read_b64_tr_b16 a[160:161], v26 offset:32768
    ds_read_b64_tr_b16 a[162:163], v26 offset:33280
    v_mfma_f32_16x16x32_bf16 v[100:103], a[192:195], a[84:87], v[100:103]
    ds_read_b64_tr_b16 a[164:165], v27 offset:32768
    v_mfma_f32_16x16x32_bf16 v[104:107], a[196:199], a[80:83], v[104:107]
    ds_read_b64_tr_b16 a[166:167], v27 offset:33280
    buffer_load_dwordx4 a[36:39], v37, s[52:55], s83 offen sc1
    v_mfma_f32_16x16x32_bf16 v[108:111], a[196:199], a[84:87], v[108:111]
    ds_read_b64_tr_b16 a[168:169], v28 offset:32768
    ds_read_b64_tr_b16 a[170:171], v28 offset:33280
    s_waitcnt lgkmcnt(6)
    v_mfma_f32_16x16x32_bf16 v[112:115], a[200:203], a[80:83], v[112:115]
    ds_read_b64_tr_b16 a[172:173], v29 offset:32768
    v_mfma_f32_16x16x32_bf16 v[116:119], a[200:203], a[84:87], v[116:119]
    ds_read_b64_tr_b16 a[174:175], v29 offset:33280
    v_mfma_f32_16x16x32_bf16 v[120:123], a[204:207], a[80:83], v[120:123]
    buffer_load_dwordx4 a[40:43], v38, s[52:55], s83 offen sc1
    v_mfma_f32_16x16x32_bf16 v[124:127], a[204:207], a[84:87], v[124:127]
    s_barrier
    s_waitcnt lgkmcnt(4)
    v_mfma_f32_16x16x32_bf16 v[96:99], a[160:163], a[88:91], v[96:99]
    ds_read_b64_tr_b16 a[192:193], v26 offset:40960
    ds_read_b64_tr_b16 a[194:195], v26 offset:41472
    v_mfma_f32_16x16x32_bf16 v[100:103], a[160:163], a[92:95], v[100:103]
    ds_read_b64_tr_b16 a[196:197], v27 offset:40960
    v_mfma_f32_16x16x32_bf16 v[104:107], a[164:167], a[88:91], v[104:107]
    ds_read_b64_tr_b16 a[198:199], v27 offset:41472
    buffer_load_dwordx4 a[44:47], v39, s[52:55], s83 offen sc1
    v_mfma_f32_16x16x32_bf16 v[108:111], a[164:167], a[92:95], v[108:111]
    ds_read_b64_tr_b16 a[200:201], v28 offset:40960
    ds_read_b64_tr_b16 a[202:203], v28 offset:41472
    s_waitcnt lgkmcnt(6)
    v_mfma_f32_16x16x32_bf16 v[112:115], a[168:171], a[88:91], v[112:115]
    ds_read_b64_tr_b16 a[204:205], v29 offset:40960
    v_mfma_f32_16x16x32_bf16 v[116:119], a[168:171], a[92:95], v[116:119]
    ds_read_b64_tr_b16 a[206:207], v29 offset:41472
    v_mfma_f32_16x16x32_bf16 v[120:123], a[172:175], a[88:91], v[120:123]
    buffer_load_dwordx4 a[48:51], v40, s[52:55], s83 offen sc1
    v_mfma_f32_16x16x32_bf16 v[124:127], a[172:175], a[92:95], v[124:127]
    s_waitcnt lgkmcnt(4)
    v_mfma_f32_16x16x32_bf16 v[96:99], a[192:195], a[96:99], v[96:99]
    ds_read_b64_tr_b16 a[160:161], v26 offset:45056
    ds_read_b64_tr_b16 a[162:163], v26 offset:45568
    v_mfma_f32_16x16x32_bf16 v[100:103], a[192:195], a[100:103], v[100:103]
    ds_read_b64_tr_b16 a[164:165], v27 offset:45056
    v_mfma_f32_16x16x32_bf16 v[104:107], a[196:199], a[96:99], v[104:107]
    ds_read_b64_tr_b16 a[166:167], v27 offset:45568
    buffer_load_dwordx4 a[52:55], v41, s[52:55], s83 offen sc1
    v_mfma_f32_16x16x32_bf16 v[108:111], a[196:199], a[100:103], v[108:111]
    ds_read_b64_tr_b16 a[168:169], v28 offset:45056
    ds_read_b64_tr_b16 a[170:171], v28 offset:45568
    s_waitcnt lgkmcnt(6)
    v_mfma_f32_16x16x32_bf16 v[112:115], a[200:203], a[96:99], v[112:115]
    ds_read_b64_tr_b16 a[172:173], v29 offset:45056
    v_mfma_f32_16x16x32_bf16 v[116:119], a[200:203], a[100:103], v[116:119]
    ds_read_b64_tr_b16 a[174:175], v29 offset:45568
    v_mfma_f32_16x16x32_bf16 v[120:123], a[204:207], a[96:99], v[120:123]
    buffer_load_dwordx4 a[56:59], v42, s[52:55], s83 offen sc1
    v_mfma_f32_16x16x32_bf16 v[124:127], a[204:207], a[100:103], v[124:127]
    s_waitcnt lgkmcnt(4)
    v_mfma_f32_16x16x32_bf16 v[96:99], a[160:163], a[104:107], v[96:99]
    ds_read_b64_tr_b16 a[192:193], v26 offset:49152
    ds_read_b64_tr_b16 a[194:195], v26 offset:49664
    v_mfma_f32_16x16x32_bf16 v[100:103], a[160:163], a[108:111], v[100:103]
    ds_read_b64_tr_b16 a[196:197], v27 offset:49152
    buffer_load_dwordx4 a[60:63], v43, s[52:55], s83 offen sc1
    s_add_u32 s83, s83, 4096
    s_cmp_eq_u32 s83, s85
    s_cselect_b32 s83, s84, s83
    v_mfma_f32_16x16x32_bf16 v[104:107], a[164:167], a[104:107], v[104:107]
    ds_read_b64_tr_b16 a[198:199], v27 offset:49664
    v_mfma_f32_16x16x32_bf16 v[108:111], a[164:167], a[108:111], v[108:111]
    ds_read_b64_tr_b16 a[200:201], v28 offset:49152
    ds_read_b64_tr_b16 a[202:203], v28 offset:49664
    s_waitcnt lgkmcnt(6)
    v_mfma_f32_16x16x32_bf16 v[112:115], a[168:171], a[104:107], v[112:115]
    ds_read_b64_tr_b16 a[204:205], v29 offset:49152
    buffer_load_dwordx4 a[64:67], v36, s[52:55], s83 offen sc1
    v_mfma_f32_16x16x32_bf16 v[116:119], a[168:171], a[108:111], v[116:119]
    ds_read_b64_tr_b16 a[206:207], v29 offset:49664
    v_mfma_f32_16x16x32_bf16 v[120:123], a[172:175], a[104:107], v[120:123]
    buffer_load_dwordx4 a[68:71], v37, s[52:55], s83 offen sc1
    v_mfma_f32_16x16x32_bf16 v[124:127], a[172:175], a[108:111], v[124:127]
    s_waitcnt lgkmcnt(4)
    v_mfma_f32_16x16x32_bf16 v[96:99], a[192:195], a[112:115], v[96:99]
    ds_read_b64_tr_b16 a[160:161], v26 offset:53248
    ds_read_b64_tr_b16 a[162:163], v26 offset:53760
    v_mfma_f32_16x16x32_bf16 v[100:103], a[192:195], a[116:119], v[100:103]
    ds_read_b64_tr_b16 a[164:165], v27 offset:53248
    v_mfma_f32_16x16x32_bf16 v[104:107], a[196:199], a[112:115], v[104:107]
    ds_read_b64_tr_b16 a[166:167], v27 offset:53760
    buffer_load_dwordx4 a[72:75], v38, s[52:55], s83 offen sc1
    v_mfma_f32_16x16x32_bf16 v[108:111], a[196:199], a[116:119], v[108:111]
    ds_read_b64_tr_b16 a[168:169], v28 offset:53248
    ds_read_b64_tr_b16 a[170:171], v28 offset:53760
    s_waitcnt lgkmcnt(6)
    v_mfma_f32_16x16x32_bf16 v[112:115], a[200:203], a[112:115], v[112:115]
    ds_read_b64_tr_b16 a[172:173], v29 offset:53248
    v_mfma_f32_16x16x32_bf16 v[116:119], a[200:203], a[116:119], v[116:119]
    ds_read_b64_tr_b16 a[174:175], v29 offset:53760
    v_mfma_f32_16x16x32_bf16 v[120:123], a[204:207], a[112:115], v[120:123]
    buffer_load_dwordx4 a[76:79], v39, s[52:55], s83 offen sc1
    v_mfma_f32_16x16x32_bf16 v[124:127], a[204:207], a[116:119], v[124:127]
    s_waitcnt vmcnt(16)
    s_barrier
    s_cmp_lg_u32 s5, 0
    s_cbranch_scc1 L_nosend_27
    v_add_u32 v5, 16, v3
    s_lshl_b32 s11, s4, 2
    s_add_u32 s11, s11, 640
    s_mov_b64 exec, 0xff00
    buffer_store_dword v5, v4, s[52:55], s11 offen sc1
    s_mov_b64 exec, -1
L_nosend_27:
    s_waitcnt lgkmcnt(4)
    v_mfma_f32_16x16x32_bf16 v[96:99], a[160:163], a[120:123], v[96:99]
    v_add_u32 v26, 61440, v26
    v_add_u32 v27, 61440, v27
    v_mfma_f32_16x16x32_bf16 v[100:103], a[160:163], a[124:127], v[100:103]
    v_add_u32 v28, 61440, v28
    v_add_u32 v29, 61440, v29
    v_mfma_f32_16x16x32_bf16 v[104:107], a[164:167], a[120:123], v[104:107]
    ds_read_b64_tr_b16 a[192:193], v26 offset:0
    ds_read_b64_tr_b16 a[194:195], v26 offset:512
    buffer_load_dwordx4 v20, s[64:67], s81 offen offset:0 lds
    v_mfma_f32_16x16x32_bf16 v[108:111], a[164:167], a[124:127], v[108:111]
    ds_read_b64_tr_b16 a[196:197], v27 offset:0
    ds_read_b64_tr_b16 a[198:199], v27 offset:512
    s_waitcnt lgkmcnt(4)
    v_mfma_f32_16x16x32_bf16 v[112:115], a[168:171], a[120:123], v[112:115]
    ds_read_b64_tr_b16 a[200:201], v28 offset:0
    ds_read_b64_tr_b16 a[202:203], v28 offset:512
    v_mfma_f32_16x16x32_bf16 v[116:119], a[168:171], a[124:127], v[116:119]
    ds_read_b64_tr_b16 a[204:205], v29 offset:0
    ds_read_b64_tr_b16 a[206:207], v29 offset:512
    v_mfma_f32_16x16x32_bf16 v[120:123], a[172:175], a[120:123], v[120:123]
    buffer_load_dwordx4 v21, s[64:67], s81 offen offset:1024 lds
    v_mfma_f32_16x16x32_bf16 v[124:127], a[172:175], a[124:127], v[124:127]
    s_waitcnt lgkmcnt(4)
    v_mfma_f32_16x16x32_bf16 v[96:99], a[192:195], a[128:131], v[96:99]
    ds_read_b64_tr_b16 a[160:161], v26 offset:4096
    ds_read_b64_tr_b16 a[162:163], v26 offset:4608
    v_mfma_f32_16x16x32_bf16 v[100:103], a[192:195], a[132:135], v[100:103]
    ds_read_b64_tr_b16 a[164:165], v27 offset:4096
    buffer_load_dwordx4 v22, s[64:67], s81 offen offset:2048 lds
    v_mfma_f32_16x16x32_bf16 v[104:107], a[196:199], a[128:131], v[104:107]
    ds_read_b64_tr_b16 a[166:167], v27 offset:4608
    v_mfma_f32_16x16x32_bf16 v[108:111], a[196:199], a[132:135], v[108:111]
    ds_read_b64_tr_b16 a[168:169], v28 offset:4096
    ds_read_b64_tr_b16 a[170:171], v28 offset:4608
    s_waitcnt lgkmcnt(6)
    v_mfma_f32_16x16x32_bf16 v[112:115], a[200:203], a[128:131], v[112:115]
    ds_read_b64_tr_b16 a[172:173], v29 offset:4096
    buffer_load_dwordx4 v23, s[64:67], s81 offen offset:3072 lds
    s_add_u32 m0, s15, 40960
    v_mfma_f32_16x16x32_bf16 v[116:119], a[200:203], a[132:135], v[116:119]
    ds_read_b64_tr_b16 a[174:175], v29 offset:4608
    v_mfma_f32_16x16x32_bf16 v[120:123], a[204:207], a[128:131], v[120:123]
    buffer_load_dwordx4 v24, s[64:67], s81 offen offset:0 lds
    s_add_u32 s81, s81, 573440
    s_sub_u32 s14, s81, 1966080
    s_cselect_b32 s81, s81, s14
    s_add_u32 m0, s87, 61440
    v_mfma_f32_16x16x32_bf16 v[124:127], a[204:207], a[132:135], v[124:127]
    s_waitcnt lgkmcnt(4)
    v_mfma_f32_16x16x32_bf16 v[96:99], a[160:163], a[136:139], v[96:99]
    ds_read_b64_tr_b16 a[192:193], v26 offset:8192
    ds_read_b64_tr_b16 a[194:195], v26 offset:8704
    v_mfma_f32_16x16x32_bf16 v[100:103], a[160:163], a[140:143], v[100:103]
    ds_read_b64_tr_b16 a[196:197], v27 offset:8192
    v_mfma_f32_16x16x32_bf16 v[104:107], a[164:167], a[136:139], v[104:107]
    ds_read_b64_tr_b16 a[198:199], v27 offset:8704
    buffer_load_dwordx4 a[80:83], v40, s[52:55], s83 offen sc1
    v_mfma_f32_16x16x32_bf16 v[108:111], a[164:167], a[140:143], v[108:111]
    ds_read_b64_tr_b16 a[200:201], v28 offset:8192
    ds_read_b64_tr_b16 a[202:203], v28 offset:8704
    s_waitcnt lgkmcnt(6)
    v_mfma_f32_16x16x32_bf16 v[112:115], a[168:171], a[136:139], v[112:115]
    ds_read_b64_tr_b16 a[204:205], v29 offset:8192
    v_mfma_f32_16x16x32_bf16 v[116:119], a[168:171], a[140:143], v[116:119]
    ds_read_b64_tr_b16 a[206:207], v29 offset:8704
    v_mfma_f32_16x16x32_bf16 v[120:123], a[172:175], a[136:139], v[120:123]
    buffer_load_dwordx4 a[84:87], v41, s[52:55], s83 offen sc1
    v_mfma_f32_16x16x32_bf16 v[124:127], a[172:175], a[140:143], v[124:127]
    s_waitcnt lgkmcnt(4)
    v_mfma_f32_16x16x32_bf16 v[96:99], a[192:195], a[144:147], v[96:99]
    ds_read_b64_tr_b16 a[160:161], v26 offset:12288
    ds_read_b64_tr_b16 a[162:163], v26 offset:12800
    v_mfma_f32_16x16x32_bf16 v[100:103], a[192:195], a[148:151], v[100:103]
    ds_read_b64_tr_b16 a[164:165], v27 offset:12288
    v_mfma_f32_16x16x32_bf16 v[104:107], a[196:199], a[144:147], v[104:107]
    ds_read_b64_tr_b16 a[166:167], v27 offset:12800
    buffer_load_dwordx4 a[88:91], v42, s[52:55], s83 offen sc1
    v_mfma_f32_16x16x32_bf16 v[108:111], a[196:199], a[148:151], v[108:111]
    ds_read_b64_tr_b16 a[168:169], v28 offset:12288
    ds_read_b64_tr_b16 a[170:171], v28 offset:12800
    s_waitcnt lgkmcnt(6)
    v_mfma_f32_16x16x32_bf16 v[112:115], a[200:203], a[144:147], v[112:115]
    ds_read_b64_tr_b16 a[172:173], v29 offset:12288
    v_mfma_f32_16x16x32_bf16 v[116:119], a[200:203], a[148:151], v[116:119]
    ds_read_b64_tr_b16 a[174:175], v29 offset:12800
    v_mfma_f32_16x16x32_bf16 v[120:123], a[204:207], a[144:147], v[120:123]
    buffer_load_dwordx4 a[92:95], v43, s[52:55], s83 offen sc1
    s_add_u32 s83, s83, 4096
    s_cmp_eq_u32 s83, s85
    s_cselect_b32 s83, s84, s83
    v_mfma_f32_16x16x32_bf16 v[124:127], a[204:207], a[148:151], v[124:127]
    s_barrier
    s_waitcnt lgkmcnt(4)
    v_mfma_f32_16x16x32_bf16 v[96:99], a[160:163], a[152:155], v[96:99]
    v_add_u32 v30, 122880, v30
    v_add_u32 v31, 122880, v31
    v_add_u32 v32, 122880, v32
    v_add_u32 v33, 122880, v33
    v_mfma_f32_16x16x32_bf16 v[100:103], a[160:163], a[156:159], v[100:103]
    ds_read_b64_tr_b16 a[192:193], v30 offset:20480
    ds_read_b64_tr_b16 a[194:195], v30 offset:22528
    ds_read_b64_tr_b16 a[196:197], v31 offset:20480
    buffer_load_dwordx4 a[96:99], v36, s[52:55], s83 offen sc1
    v_mfma_f32_16x16x32_bf16 v[104:107], a[164:167], a[152:155], v[104:107]
    ds_read_b64_tr_b16 a[198:199], v31 offset:22528
    ds_read_b64_tr_b16 a[200:201], v32 offset:20480
    ds_read_b64_tr_b16 a[202:203], v32 offset:22528
    v_mfma_f32_16x16x32_bf16 v[108:111], a[164:167], a[156:159], v[108:111]
    ds_read_b64_tr_b16 a[204:205], v33 offset:20480
    ds_read_b64_tr_b16 a[206:207], v33 offset:22528
    ds_read_b64_tr_b16 a[208:209], v30 offset:36864
    ds_read_b64_tr_b16 a[210:211], v30 offset:38912
    s_waitcnt lgkmcnt(10)
    v_mfma_f32_16x16x32_bf16 v[112:115], a[168:171], a[152:155], v[112:115]
    ds_read_b64_tr_b16 a[212:213], v31 offset:36864
    ds_read_b64_tr_b16 a[214:215], v31 offset:38912
    ds_read_b64_tr_b16 a[216:217], v32 offset:36864
    buffer_load_dwordx4 a[100:103], v37, s[52:55], s83 offen sc1
    v_mfma_f32_16x16x32_bf16 v[116:119], a[168:171], a[156:159], v[116:119]
    ds_read_b64_tr_b16 a[218:219], v32 offset:38912
    ds_read_b64_tr_b16 a[220:221], v33 offset:36864
    ds_read_b64_tr_b16 a[222:223], v33 offset:38912
    v_mfma_f32_16x16x32_bf16 v[120:123], a[172:175], a[152:155], v[120:123]
    buffer_load_dwordx4 a[104:107], v38, s[52:55], s83 offen sc1
    v_mfma_f32_16x16x32_bf16 v[124:127], a[172:175], a[156:159], v[124:127]
    s_waitcnt lgkmcnt(8)
    v_mfma_f32_16x16x32_bf16 v[128:131], a[0:3], a[192:195], 0
    ds_read_b64_tr_b16 a[160:161], v30 offset:24576
    v_mfma_f32_16x16x32_bf16 v[132:135], a[4:7], a[192:195], 0
    ds_read_b64_tr_b16 a[162:163], v30 offset:26624
    v_mfma_f32_16x16x32_bf16 v[136:139], a[0:3], a[196:199], 0
    buffer_load_dwordx4 a[108:111], v39, s[52:55], s83 offen sc1
    v_mfma_f32_16x16x32_bf16 v[140:143], a[4:7], a[196:199], 0
    ds_read_b64_tr_b16 a[164:165], v31 offset:24576
    v_mfma_f32_16x16x32_bf16 v[144:147], a[0:3], a[200:203], 0
    ds_read_b64_tr_b16 a[166:167], v31 offset:26624
    v_mfma_f32_16x16x32_bf16 v[148:151], a[4:7], a[200:203], 0
    v_mfma_f32_16x16x32_bf16 v[152:155], a[0:3], a[204:207], 0
    ds_read_b64_tr_b16 a[168:169], v32 offset:24576
    buffer_load_dwordx4 v20, s[64:67], s81 offen offset:0 lds
    v_mfma_f32_16x16x32_bf16 v[156:159], a[4:7], a[204:207], 0
    ds_read_b64_tr_b16 a[170:171], v32 offset:26624
    s_waitcnt lgkmcnt(6)
    v_mfma_f32_16x16x32_bf16 v[160:163], a[0:3], a[208:211], 0
    v_mfma_f32_16x16x32_bf16 v[164:167], a[4:7], a[208:211], 0
    ds_read_b64_tr_b16 a[172:173], v33 offset:24576
    v_mfma_f32_16x16x32_bf16 v[168:171], a[0:3], a[212:215], 0
    ds_read_b64_tr_b16 a[174:175], v33 offset:26624
    buffer_load_dwordx4 v21, s[64:67], s81 offen offset:1024 lds
    v_mfma_f32_16x16x32_bf16 v[172:175], a[4:7], a[212:215], 0
    v_mfma_f32_16x16x32_bf16 v[176:179], a[0:3], a[216:219], 0
    v_mfma_f32_16x16x32_bf16 v[180:183], a[4:7], a[216:219], 0
    v_mfma_f32_16x16x32_bf16 v[184:187], a[0:3], a[220:223], 0
    buffer_load_dwordx4 v22, s[64:67], s81 offen offset:2048 lds
    v_mfma_f32_16x16x32_bf16 v[188:191], a[4:7], a[220:223], 0
    s_waitcnt lgkmcnt(4)
    v_mfma_f32_16x16x32_bf16 v[128:131], a[8:11], a[160:163], v[128:131]
    ds_read_b64_tr_b16 a[192:193], v30 offset:28672
    ds_read_b64_tr_b16 a[194:195], v30 offset:30720
    v_cvt_pk_bf16_f32 v192, v96, v97
    v_mfma_f32_16x16x32_bf16 v[132:135], a[12:15], a[160:163], v[132:135]
    ds_read_b64_tr_b16 a[196:197], v31 offset:28672
    v_cvt_pk_bf16_f32 v193, v98, v99
    v_mfma_f32_16x16x32_bf16 v[136:139], a[8:11], a[164:167], v[136:139]
    ds_read_b64_tr_b16 a[198:199], v31 offset:30720
    v_cvt_pk_bf16_f32 v194, v104, v105
    v_mfma_f32_16x16x32_bf16 v[140:143], a[12:15], a[164:167], v[140:143]
    ds_read_b64_tr_b16 a[200:201], v32 offset:28672
    ds_read_b64_tr_b16 a[202:203], v32 offset:30720
    v_cvt_pk_bf16_f32 v195, v106, v107
    s_waitcnt lgkmcnt(6)
    v_mfma_f32_16x16x32_bf16 v[144:147], a[8:11], a[168:171], v[144:147]
    ds_read_b64_tr_b16 a[204:205], v33 offset:28672
    v_pk_max_i16 v192, v192, 0
    buffer_load_dwordx4 v23, s[64:67], s81 offen offset:3072 lds
    s_add_u32 m0, s15, 61440
    v_mfma_f32_16x16x32_bf16 v[148:151], a[12:15], a[168:171], v[148:151]
    ds_read_b64_tr_b16 a[206:207], v33 offset:30720
    v_pk_max_i16 v193, v193, 0
    v_mfma_f32_16x16x32_bf16 v[152:155], a[8:11], a[172:175], v[152:155]
    v_pk_max_i16 v194, v194, 0
    v_mfma_f32_16x16x32_bf16 v[156:159], a[12:15], a[172:175], v[156:159]
    v_pk_max_i16 v195, v195, 0
    buffer_store_dwordx4 v[192:195], v2, s[52:55], s90 offen offset:0 sc1
    s_waitcnt vmcnt(32) lgkmcnt(4)
    v_mfma_f32_16x16x32_bf16 v[128:131], a[16:19], a[192:195], v[128:131]
    ds_read_b64_tr_b16 a[160:161], v30 offset:32768
    ds_read_b64_tr_b16 a[162:163], v30 offset:34816
    v_mfma_f32_16x16x32_bf16 v[132:135], a[20:23], a[192:195], v[132:135]
    ds_read_b64_tr_b16 a[164:165], v31 offset:32768
    buffer_load_dwordx4 v24, s[64:67], s81 offen offset:0 lds
    s_add_u32 s81, s81, 491520
    s_sub_u32 s14, s81, 1966080
    s_cselect_b32 s81, s81, s14
    s_add_u32 m0, s87, 81920
    v_mfma_f32_16x16x32_bf16 v[136:139], a[16:19], a[196:199], v[136:139]
    ds_read_b64_tr_b16 a[166:167], v31 offset:34816
    v_mfma_f32_16x16x32_bf16 v[140:143], a[20:23], a[196:199], v[140:143]
    ds_read_b64_tr_b16 a[168:169], v32 offset:32768
    ds_read_b64_tr_b16 a[170:171], v32 offset:34816
    s_waitcnt lgkmcnt(6)
    v_mfma_f32_16x16x32_bf16 v[144:147], a[16:19], a[200:203], v[144:147]
    ds_read_b64_tr_b16 a[172:173], v33 offset:32768
    buffer_load_dwordx4 a[112:115], v40, s[52:55], s83 offen sc1
    v_mfma_f32_16x16x32_bf16 v[148:151], a[20:23], a[200:203], v[148:151]
    ds_read_b64_tr_b16 a[174:175], v33 offset:34816
    v_mfma_f32_16x16x32_bf16 v[152:155], a[16:19], a[204:207], v[152:155]
    buffer_load_dwordx4 a[116:119], v41, s[52:55], s83 offen sc1
    v_mfma_f32_16x16x32_bf16 v[156:159], a[20:23], a[204:207], v[156:159]
    s_barrier
    s_waitcnt vmcnt(33) lgkmcnt(4)
    v_mfma_f32_16x16x32_bf16 v[128:131], a[24:27], a[160:163], v[128:131]
    v_add_u32 v30, 4294844416, v30
    v_add_u32 v31, 4294844416, v31
    v_add_u32 v32, 4294844416, v32
    v_add_u32 v33, 4294844416, v33
    v_cvt_pk_bf16_f32 v196, v100, v101
    v_mfma_f32_16x16x32_bf16 v[132:135], a[28:31], a[160:163], v[132:135]
    ds_read_b64_tr_b16 a[192:193], v30 offset:0
    ds_read_b64_tr_b16 a[194:195], v30 offset:2048
    ds_read_b64_tr_b16 a[196:197], v31 offset:0
    v_cvt_pk_bf16_f32 v197, v102, v103
    v_mfma_f32_16x16x32_bf16 v[136:139], a[24:27], a[164:167], v[136:139]
    ds_read_b64_tr_b16 a[198:199], v31 offset:2048
    ds_read_b64_tr_b16 a[200:201], v32 offset:0
    ds_read_b64_tr_b16 a[202:203], v32 offset:2048
    v_cvt_pk_bf16_f32 v198, v108, v109
    v_mfma_f32_16x16x32_bf16 v[140:143], a[28:31], a[164:167], v[140:143]
    ds_read_b64_tr_b16 a[204:205], v33 offset:0
    ds_read_b64_tr_b16 a[206:207], v33 offset:2048
    ds_read_b64_tr_b16 a[208:209], v30 offset:16384
    ds_read_b64_tr_b16 a[210:211], v30 offset:18432
    v_cvt_pk_bf16_f32 v199, v110, v111
    s_waitcnt lgkmcnt(10)
    v_mfma_f32_16x16x32_bf16 v[144:147], a[24:27], a[168:171], v[144:147]
    ds_read_b64_tr_b16 a[212:213], v31 offset:16384
    ds_read_b64_tr_b16 a[214:215], v31 offset:18432
    ds_read_b64_tr_b16 a[216:217], v32 offset:16384
    v_pk_max_i16 v196, v196, 0
    v_and_b32 v11, 7, v1
    v_lshlrev_b32 v11, 2, v11
    s_add_u32 s46, s9, 640
    buffer_load_dword v10, v11, s[52:55], s46 offen sc1
    v_mfma_f32_16x16x32_bf16 v[148:151], a[28:31], a[168:171], v[148:151]
    ds_read_b64_tr_b16 a[218:219], v32 offset:18432
    ds_read_b64_tr_b16 a[220:221], v33 offset:16384
    ds_read_b64_tr_b16 a[222:223], v33 offset:18432
    v_pk_max_i16 v197, v197, 0
    v_mfma_f32_16x16x32_bf16 v[152:155], a[24:27], a[172:175], v[152:155]
    v_pk_max_i16 v198, v198, 0
    v_mfma_f32_16x16x32_bf16 v[156:159], a[28:31], a[172:175], v[156:159]
    v_pk_max_i16 v199, v199, 0
    buffer_store_dwordx4 v[196:199], v35, s[52:55], s90 offen offset:0 sc1
    s_waitcnt vmcnt(33) lgkmcnt(8)
    v_mfma_f32_16x16x32_bf16 v[128:131], a[32:35], a[192:195], v[128:131]
    ds_read_b64_tr_b16 a[160:161], v30 offset:4096
    v_mfma_f32_16x16x32_bf16 v[132:135], a[36:39], a[192:195], v[132:135]
    ds_read_b64_tr_b16 a[162:163], v30 offset:6144
    buffer_load_dwordx4 a[120:123], v42, s[52:55], s83 offen sc1
    v_mfma_f32_16x16x32_bf16 v[136:139], a[32:35], a[196:199], v[136:139]
    v_mfma_f32_16x16x32_bf16 v[140:143], a[36:39], a[196:199], v[140:143]
    ds_read_b64_tr_b16 a[164:165], v31 offset:4096
    v_mfma_f32_16x16x32_bf16 v[144:147], a[32:35], a[200:203], v[144:147]
    ds_read_b64_tr_b16 a[166:167], v31 offset:6144
    buffer_load_dwordx4 a[124:127], v43, s[52:55], s83 offen sc1
    s_add_u32 s83, s83, 4096
    s_cmp_eq_u32 s83, s85
    s_cselect_b32 s83, s84, s83
    v_mfma_f32_16x16x32_bf16 v[148:151], a[36:39], a[200:203], v[148:151]
    v_mfma_f32_16x16x32_bf16 v[152:155], a[32:35], a[204:207], v[152:155]
    ds_read_b64_tr_b16 a[168:169], v32 offset:4096
    v_mfma_f32_16x16x32_bf16 v[156:159], a[36:39], a[204:207], v[156:159]
    ds_read_b64_tr_b16 a[170:171], v32 offset:6144
    s_waitcnt lgkmcnt(6)
    v_mfma_f32_16x16x32_bf16 v[160:163], a[32:35], a[208:211], v[160:163]
    buffer_load_dwordx4 v20, s[64:67], s81 offen offset:0 lds
    v_mfma_f32_16x16x32_bf16 v[164:167], a[36:39], a[208:211], v[164:167]
    ds_read_b64_tr_b16 a[172:173], v33 offset:4096
    v_mfma_f32_16x16x32_bf16 v[168:171], a[32:35], a[212:215], v[168:171]
    ds_read_b64_tr_b16 a[174:175], v33 offset:6144
    v_mfma_f32_16x16x32_bf16 v[172:175], a[36:39], a[212:215], v[172:175]
    buffer_load_dwordx4 v21, s[64:67], s81 offen offset:1024 lds
    v_mfma_f32_16x16x32_bf16 v[176:179], a[32:35], a[216:219], v[176:179]
    v_mfma_f32_16x16x32_bf16 v[180:183], a[36:39], a[216:219], v[180:183]
    v_mfma_f32_16x16x32_bf16 v[184:187], a[32:35], a[220:223], v[184:187]
    buffer_load_dwordx4 v22, s[64:67], s81 offen offset:2048 lds
    v_mfma_f32_16x16x32_bf16 v[188:191], a[36:39], a[220:223], v[188:191]
    s_waitcnt vmcnt(36) lgkmcnt(4)
    v_mfma_f32_16x16x32_bf16 v[128:131], a[40:43], a[160:163], v[128:131]
    ds_read_b64_tr_b16 a[192:193], v30 offset:8192
    ds_read_b64_tr_b16 a[194:195], v30 offset:10240
    v_cvt_pk_bf16_f32 v200, v112, v113
    v_mfma_f32_16x16x32_bf16 v[132:135], a[44:47], a[160:163], v[132:135]
    ds_read_b64_tr_b16 a[196:197], v31 offset:8192
    v_cvt_pk_bf16_f32 v201, v114, v115
    v_mfma_f32_16x16x32_bf16 v[136:139], a[40:43], a[164:167], v[136:139]
    ds_read_b64_tr_b16 a[198:199], v31 offset:10240
    v_cvt_pk_bf16_f32 v202, v120, v121
    v_mfma_f32_16x16x32_bf16 v[140:143], a[44:47], a[164:167], v[140:143]
    ds_read_b64_tr_b16 a[200:201], v32 offset:8192
    ds_read_b64_tr_b16 a[202:203], v32 offset:10240
    v_cvt_pk_bf16_f32 v203, v122, v123
    s_waitcnt lgkmcnt(6)
    v_mfma_f32_16x16x32_bf16 v[144:147], a[40:43], a[168:171], v[144:147]
    ds_read_b64_tr_b16 a[204:205], v33 offset:8192
    v_pk_max_i16 v200, v200, 0
    buffer_load_dwordx4 v23, s[64:67], s81 offen offset:3072 lds
    s_add_u32 m0, s15, 81920
    v_mfma_f32_16x16x32_bf16 v[148:151], a[44:47], a[168:171], v[148:151]
    ds_read_b64_tr_b16 a[206:207], v33 offset:10240
    v_pk_max_i16 v201, v201, 0
    v_mfma_f32_16x16x32_bf16 v[152:155], a[40:43], a[172:175], v[152:155]
    v_pk_max_i16 v202, v202, 0
    v_mfma_f32_16x16x32_bf16 v[156:159], a[44:47], a[172:175], v[156:159]
    v_pk_max_i16 v203, v203, 0
    buffer_store_dwordx4 v[200:203], v2, s[52:55], s90 offen offset:1024 sc1
    s_waitcnt vmcnt(36) lgkmcnt(4)
    v_mfma_f32_16x16x32_bf16 v[128:131], a[48:51], a[192:195], v[128:131]
    ds_read_b64_tr_b16 a[160:161], v30 offset:12288
    ds_read_b64_tr_b16 a[162:163], v30 offset:14336
    v_mfma_f32_16x16x32_bf16 v[132:135], a[52:55], a[192:195], v[132:135]
    ds_read_b64_tr_b16 a[164:165], v31 offset:12288
    v_mfma_f32_16x16x32_bf16 v[136:139], a[48:51], a[196:199], v[136:139]
    ds_read_b64_tr_b16 a[166:167], v31 offset:14336
    buffer_load_dwordx4 v24, s[64:67], s81 offen offset:0 lds
    s_add_u32 s81, s81, 491520
    s_sub_u32 s14, s81, 1966080
    s_cselect_b32 s81, s81, s14
    s_add_u32 m0, s87, 102400
    v_mfma_f32_16x16x32_bf16 v[140:143], a[52:55], a[196:199], v[140:143]
    ds_read_b64_tr_b16 a[168:169], v32 offset:12288
    ds_read_b64_tr_b16 a[170:171], v32 offset:14336
    s_waitcnt lgkmcnt(6)
    v_mfma_f32_16x16x32_bf16 v[144:147], a[48:51], a[200:203], v[144:147]
    ds_read_b64_tr_b16 a[172:173], v33 offset:12288
    v_mfma_f32_16x16x32_bf16 v[148:151], a[52:55], a[200:203], v[148:151]
    ds_read_b64_tr_b16 a[174:175], v33 offset:14336
    v_mfma_f32_16x16x32_bf16 v[152:155], a[48:51], a[204:207], v[152:155]
    buffer_load_dwordx4 v20, s[64:67], s81 offen offset:0 lds
    v_mfma_f32_16x16x32_bf16 v[156:159], a[52:55], a[204:207], v[156:159]
    s_barrier
    s_waitcnt vmcnt(36) lgkmcnt(4)
    v_mfma_f32_16x16x32_bf16 v[128:131], a[56:59], a[160:163], v[128:131]
    ds_read_b64_tr_b16 a[192:193], v30 offset:20480
    ds_read_b64_tr_b16 a[194:195], v30 offset:22528
    ds_read_b64_tr_b16 a[196:197], v31 offset:20480
    v_cvt_pk_bf16_f32 v204, v116, v117
    v_mfma_f32_16x16x32_bf16 v[132:135], a[60:63], a[160:163], v[132:135]
    ds_read_b64_tr_b16 a[198:199], v31 offset:22528
    ds_read_b64_tr_b16 a[200:201], v32 offset:20480
    ds_read_b64_tr_b16 a[202:203], v32 offset:22528
    v_cvt_pk_bf16_f32 v205, v118, v119
    v_mfma_f32_16x16x32_bf16 v[136:139], a[56:59], a[164:167], v[136:139]
    ds_read_b64_tr_b16 a[204:205], v33 offset:20480
    ds_read_b64_tr_b16 a[206:207], v33 offset:22528
    v_cvt_pk_bf16_f32 v206, v124, v125
    buffer_load_dwordx4 v21, s[64:67], s81 offen offset:1024 lds
    v_mfma_f32_16x16x32_bf16 v[140:143], a[60:63], a[164:167], v[140:143]
    ds_read_b64_tr_b16 a[208:209], v30 offset:36864
    ds_read_b64_tr_b16 a[210:211], v30 offset:38912
    ds_read_b64_tr_b16 a[212:213], v31 offset:36864
    v_cvt_pk_bf16_f32 v207, v126, v127
    s_waitcnt lgkmcnt(11)
    v_mfma_f32_16x16x32_bf16 v[144:147], a[56:59], a[168:171], v[144:147]
    ds_read_b64_tr_b16 a[214:215], v31 offset:38912
    ds_read_b64_tr_b16 a[216:217], v32 offset:36864
    ds_read_b64_tr_b16 a[218:219], v32 offset:38912
    v_pk_max_i16 v204, v204, 0
    v_mfma_f32_16x16x32_bf16 v[148:151], a[60:63], a[168:171], v[148:151]
    ds_read_b64_tr_b16 a[220:221], v33 offset:36864
    ds_read_b64_tr_b16 a[222:223], v33 offset:38912
    v_pk_max_i16 v205, v205, 0
    v_mfma_f32_16x16x32_bf16 v[152:155], a[56:59], a[172:175], v[152:155]
    v_pk_max_i16 v206, v206, 0
    buffer_load_dwordx4 v22, s[64:67], s81 offen offset:2048 lds
    v_mfma_f32_16x16x32_bf16 v[156:159], a[60:63], a[172:175], v[156:159]
    v_pk_max_i16 v207, v207, 0
    buffer_store_dwordx4 v[204:207], v35, s[52:55], s90 offen offset:1024 sc1
    s_add_u32 s90, s90, 16384
    s_add_u32 s12, s7, 16
    s_waitcnt vmcnt(13)
    v_cmp_eq_u32 vcc, s12, v10
    s_nop 0
    s_cmp_eq_u64 vcc, exec
    s_cbranch_scc1 L_ready_28
    v_and_b32 v11, 7, v1
    v_lshlrev_b32 v11, 2, v11
    s_add_u32 s11, s9, 640
    s_add_u32 s12, s7, 16
L_poll_29:
    buffer_load_dword v10, v11, s[52:55], s11 offen sc1
    s_cmp_eq_u32 s10, 0
    s_waitcnt vmcnt(0)
    s_cbranch_scc1 L_polled_30
    s_sub_u32 s10, s10, 1
    v_cmp_eq_u32 vcc, s12, v10
    s_nop 0
    s_cmp_eq_u64 vcc, exec
    s_cbranch_scc0 L_poll_29
L_polled_30:
L_ready_28:
    s_waitcnt lgkmcnt(8)
    v_mfma_f32_16x16x32_bf16 v[128:131], a[64:67], a[192:195], v[128:131]
    ds_read_b64_tr_b16 a[160:161], v30 offset:24576
    v_mfma_f32_16x16x32_bf16 v[132:135], a[68:71], a[192:195], v[132:135]
    ds_read_b64_tr_b16 a[162:163], v30 offset:26624
    v_mfma_f32_16x16x32_bf16 v[136:139], a[64:67], a[196:199], v[136:139]
    s_add_u32 s84, s89, 16384
    s_add_u32 s85, s84, 16384
    s_add_u32 s83, s91, s84
    buffer_load_dwordx4 a[0:3], v36, s[52:55], s83 offen sc1
    v_mfma_f32_16x16x32_bf16 v[140:143], a[68:71], a[196:199], v[140:143]
    ds_read_b64_tr_b16 a[164:165], v31 offset:24576
    v_mfma_f32_16x16x32_bf16 v[144:147], a[64:67], a[200:203], v[144:147]
    ds_read_b64_tr_b16 a[166:167], v31 offset:26624
    v_mfma_f32_16x16x32_bf16 v[148:151], a[68:71], a[200:203], v[148:151]
    v_mfma_f32_16x16x32_bf16 v[152:155], a[64:67], a[204:207], v[152:155]
    ds_read_b64_tr_b16 a[168:169], v32 offset:24576
    buffer_load_dwordx4 a[4:7], v37, s[52:55], s83 offen sc1
    v_mfma_f32_16x16x32_bf16 v[156:159], a[68:71], a[204:207], v[156:159]
    ds_read_b64_tr_b16 a[170:171], v32 offset:26624
    s_waitcnt lgkmcnt(6)
    v_mfma_f32_16x16x32_bf16 v[160:163], a[64:67], a[208:211], v[160:163]
    v_mfma_f32_16x16x32_bf16 v[164:167], a[68:71], a[208:211], v[164:167]
    ds_read_b64_tr_b16 a[172:173], v33 offset:24576
    v_mfma_f32_16x16x32_bf16 v[168:171], a[64:67], a[212:215], v[168:171]
    ds_read_b64_tr_b16 a[174:175], v33 offset:26624
    buffer_load_dwordx4 a[8:11], v38, s[52:55], s83 offen sc1
    v_mfma_f32_16x16x32_bf16 v[172:175], a[68:71], a[212:215], v[172:175]
    v_mfma_f32_16x16x32_bf16 v[176:179], a[64:67], a[216:219], v[176:179]
    v_mfma_f32_16x16x32_bf16 v[180:183], a[68:71], a[216:219], v[180:183]
    v_mfma_f32_16x16x32_bf16 v[184:187], a[64:67], a[220:223], v[184:187]
    buffer_load_dwordx4 a[12:15], v39, s[52:55], s83 offen sc1
    v_mfma_f32_16x16x32_bf16 v[188:191], a[68:71], a[220:223], v[188:191]
    s_waitcnt lgkmcnt(4)
    v_mfma_f32_16x16x32_bf16 v[128:131], a[72:75], a[160:163], v[128:131]
    ds_read_b64_tr_b16 a[192:193], v30 offset:28672
    ds_read_b64_tr_b16 a[194:195], v30 offset:30720
    v_mfma_f32_16x16x32_bf16 v[132:135], a[76:79], a[160:163], v[132:135]
    ds_read_b64_tr_b16 a[196:197], v31 offset:28672
    v_mfma_f32_16x16x32_bf16 v[136:139], a[72:75], a[164:167], v[136:139]
    ds_read_b64_tr_b16 a[198:199], v31 offset:30720
    buffer_load_dwordx4 a[16:19], v40, s[52:55], s83 offen sc1
    v_mfma_f32_16x16x32_bf16 v[140:143], a[76:79], a[164:167], v[140:143]
    ds_read_b64_tr_b16 a[200:201], v32 offset:28672
    ds_read_b64_tr_b16 a[202:203], v32 offset:30720
    s_waitcnt lgkmcnt(6)
    v_mfma_f32_16x16x32_bf16 v[144:147], a[72:75], a[168:171], v[144:147]
    ds_read_b64_tr_b16 a[204:205], v33 offset:28672
    v_mfma_f32_16x16x32_bf16 v[148:151], a[76:79], a[168:171], v[148:151]
    ds_read_b64_tr_b16 a[206:207], v33 offset:30720
    v_mfma_f32_16x16x32_bf16 v[152:155], a[72:75], a[172:175], v[152:155]
    buffer_load_dwordx4 a[20:23], v41, s[52:55], s83 offen sc1
    v_mfma_f32_16x16x32_bf16 v[156:159], a[76:79], a[172:175], v[156:159]
    s_waitcnt lgkmcnt(4)
    v_mfma_f32_16x16x32_bf16 v[128:131], a[80:83], a[192:195], v[128:131]
    ds_read_b64_tr_b16 a[160:161], v30 offset:32768
    ds_read_b64_tr_b16 a[162:163], v30 offset:34816
    v_mfma_f32_16x16x32_bf16 v[132:135], a[84:87], a[192:195], v[132:135]
    ds_read_b64_tr_b16 a[164:165], v31 offset:32768
    buffer_load_dwordx4 a[24:27], v42, s[52:55], s83 offen sc1
    v_mfma_f32_16x16x32_bf16 v[136:139], a[80:83], a[196:199], v[136:139]
    ds_read_b64_tr_b16 a[166:167], v31 offset:34816
    v_mfma_f32_16x16x32_bf16 v[140:143], a[84:87], a[196:199], v[140:143]
    ds_read_b64_tr_b16 a[168:169], v32 offset:32768
    ds_read_b64_tr_b16 a[170:171], v32 offset:34816
    s_waitcnt lgkmcnt(6)
    v_mfma_f32_16x16x32_bf16 v[144:147], a[80:83], a[200:203], v[144:147]
    ds_read_b64_tr_b16 a[172:173], v33 offset:32768
    buffer_load_dwordx4 a[28:31], v43, s[52:55], s83 offen sc1
    s_add_u32 s83, s83, 4096
    s_cmp_eq_u32 s83, s85
    s_cselect_b32 s83, s84, s83
    v_mfma_f32_16x16x32_bf16 v[148:151], a[84:87], a[200:203], v[148:151]
    ds_read_b64_tr_b16 a[174:175], v33 offset:34816
    v_mfma_f32_16x16x32_bf16 v[152:155], a[80:83], a[204:207], v[152:155]
    buffer_load_dwordx4 a[32:35], v36, s[52:55], s83 offen sc1
    v_mfma_f32_16x16x32_bf16 v[156:159], a[84:87], a[204:207], v[156:159]
    s_barrier
    s_waitcnt lgkmcnt(4)
    v_mfma_f32_16x16x32_bf16 v[128:131], a[88:91], a[160:163], v[128:131]
    ds_read_b64_tr_b16 a[192:193], v30 offset:40960
    ds_read_b64_tr_b16 a[194:195], v30 offset:43008
    ds_read_b64_tr_b16 a[196:197], v31 offset:40960
    v_mfma_f32_16x16x32_bf16 v[132:135], a[92:95], a[160:163], v[132:135]
    ds_read_b64_tr_b16 a[198:199], v31 offset:43008
    ds_read_b64_tr_b16 a[200:201], v32 offset:40960
    ds_read_b64_tr_b16 a[202:203], v32 offset:43008
    v_mfma_f32_16x16x32_bf16 v[136:139], a[88:91], a[164:167], v[136:139]
    ds_read_b64_tr_b16 a[204:205], v33 offset:40960
    ds_read_b64_tr_b16 a[206:207], v33 offset:43008
    buffer_load_dwordx4 a[36:39], v37, s[52:55], s83 offen sc1
    v_mfma_f32_16x16x32_bf16 v[140:143], a[92:95], a[164:167], v[140:143]
    ds_read_b64_tr_b16 a[208:209], v30 offset:57344
    ds_read_b64_tr_b16 a[210:211], v30 offset:59392
    ds_read_b64_tr_b16 a[212:213], v31 offset:57344
    s_waitcnt lgkmcnt(11)
    v_mfma_f32_16x16x32_bf16 v[144:147], a[88:91], a[168:171], v[144:147]
    ds_read_b64_tr_b16 a[214:215], v31 offset:59392
    ds_read_b64_tr_b16 a[216:217], v32 offset:57344
    ds_read_b64_tr_b16 a[218:219], v32 offset:59392
    v_mfma_f32_16x16x32_bf16 v[148:151], a[92:95], a[168:171], v[148:151]
    ds_read_b64_tr_b16 a[220:221], v33 offset:57344
    ds_read_b64_tr_b16 a[222:223], v33 offset:59392
    v_mfma_f32_16x16x32_bf16 v[152:155], a[88:91], a[172:175], v[152:155]
    buffer_load_dwordx4 a[40:43], v38, s[52:55], s83 offen sc1
    v_mfma_f32_16x16x32_bf16 v[156:159], a[92:95], a[172:175], v[156:159]
    s_waitcnt lgkmcnt(8)
    v_mfma_f32_16x16x32_bf16 v[128:131], a[96:99], a[192:195], v[128:131]
    ds_read_b64_tr_b16 a[160:161], v30 offset:45056
    v_mfma_f32_16x16x32_bf16 v[132:135], a[100:103], a[192:195], v[132:135]
    ds_read_b64_tr_b16 a[162:163], v30 offset:47104
    buffer_load_dwordx4 a[44:47], v39, s[52:55], s83 offen sc1
    v_mfma_f32_16x16x32_bf16 v[136:139], a[96:99], a[196:199], v[136:139]
    v_mfma_f32_16x16x32_bf16 v[140:143], a[100:103], a[196:199], v[140:143]
    ds_read_b64_tr_b16 a[164:165], v31 offset:45056
    v_mfma_f32_16x16x32_bf16 v[144:147], a[96:99], a[200:203], v[144:147]
    ds_read_b64_tr_b16 a[166:167], v31 offset:47104
    buffer_load_dwordx4 v23, s[64:67], s81 offen offset:3072 lds
    s_add_u32 m0, s15, 102400
    v_mfma_f32_16x16x32_bf16 v[148:151], a[100:103], a[200:203], v[148:151]
    v_mfma_f32_16x16x32_bf16 v[152:155], a[96:99], a[204:207], v[152:155]
    ds_read_b64_tr_b16 a[168:169], v32 offset:45056
    v_mfma_f32_16x16x32_bf16 v[156:159], a[100:103], a[204:207], v[156:159]
    ds_read_b64_tr_b16 a[170:171], v32 offset:47104
    s_waitcnt lgkmcnt(6)
    v_mfma_f32_16x16x32_bf16 v[160:163], a[96:99], a[208:211], v[160:163]
    buffer_load_dwordx4 v24, s[64:67], s81 offen offset:0 lds
    s_add_u32 s81, s81, 491520
    s_sub_u32 s14, s81, 1966080
    s_cselect_b32 s81, s81, s14
    s_add_u32 m0, s87, 122880
    v_mfma_f32_16x16x32_bf16 v[164:167], a[100:103], a[208:211], v[164:167]
    ds_read_b64_tr_b16 a[172:173], v33 offset:45056
    v_mfma_f32_16x16x32_bf16 v[168:171], a[96:99], a[212:215], v[168:171]
    ds_read_b64_tr_b16 a[174:175], v33 offset:47104
    v_mfma_f32_16x16x32_bf16 v[172:175], a[100:103], a[212:215], v[172:175]
    buffer_load_dwordx4 a[48:51], v40, s[52:55], s83 offen sc1
    v_mfma_f32_16x16x32_bf16 v[176:179], a[96:99], a[216:219], v[176:179]
    v_mfma_f32_16x16x32_bf16 v[180:183], a[100:103], a[216:219], v[180:183]
    v_mfma_f32_16x16x32_bf16 v[184:187], a[96:99], a[220:223], v[184:187]
    buffer_load_dwordx4 a[52:55], v41, s[52:55], s83 offen sc1
    v_mfma_f32_16x16x32_bf16 v[188:191], a[100:103], a[220:223], v[188:191]
    s_waitcnt lgkmcnt(4)
    v_mfma_f32_16x16x32_bf16 v[128:131], a[104:107], a[160:163], v[128:131]
    ds_read_b64_tr_b16 a[192:193], v30 offset:49152
    ds_read_b64_tr_b16 a[194:195], v30 offset:51200
    v_mfma_f32_16x16x32_bf16 v[132:135], a[108:111], a[160:163], v[132:135]
    ds_read_b64_tr_b16 a[196:197], v31 offset:49152
    v_mfma_f32_16x16x32_bf16 v[136:139], a[104:107], a[164:167], v[136:139]
    ds_read_b64_tr_b16 a[198:199], v31 offset:51200
    buffer_load_dwordx4 a[56:59], v42, s[52:55], s83 offen sc1
    v_mfma_f32_16x16x32_bf16 v[140:143], a[108:111], a[164:167], v[140:143]
    ds_read_b64_tr_b16 a[200:201], v32 offset:49152
    ds_read_b64_tr_b16 a[202:203], v32 offset:51200
    s_waitcnt lgkmcnt(6)
    v_mfma_f32_16x16x32_bf16 v[144:147], a[104:107], a[168:171], v[144:147]
    ds_read_b64_tr_b16 a[204:205], v33 offset:49152
    v_mfma_f32_16x16x32_bf16 v[148:151], a[108:111], a[168:171], v[148:151]
    ds_read_b64_tr_b16 a[206:207], v33 offset:51200
    v_mfma_f32_16x16x32_bf16 v[152:155], a[104:107], a[172:175], v[152:155]
    buffer_load_dwordx4 a[60:63], v43, s[52:55], s83 offen sc1
    s_add_u32 s83, s83, 4096
    s_cmp_eq_u32 s83, s85
    s_cselect_b32 s83, s84, s83
    v_mfma_f32_16x16x32_bf16 v[156:159], a[108:111], a[172:175], v[156:159]
    s_waitcnt lgkmcnt(4)
    v_mfma_f32_16x16x32_bf16 v[128:131], a[112:115], a[192:195], v[128:131]
    ds_read_b64_tr_b16 a[160:161], v30 offset:53248
    ds_read_b64_tr_b16 a[162:163], v30 offset:55296
    v_mfma_f32_16x16x32_bf16 v[132:135], a[116:119], a[192:195], v[132:135]
    ds_read_b64_tr_b16 a[164:165], v31 offset:53248
    v_mfma_f32_16x16x32_bf16 v[136:139], a[112:115], a[196:199], v[136:139]
    ds_read_b64_tr_b16 a[166:167], v31 offset:55296
    buffer_load_dwordx4 a[64:67], v36, s[52:55], s83 offen sc1
    v_mfma_f32_16x16x32_bf16 v[140:143], a[116:119], a[196:199], v[140:143]
    ds_read_b64_tr_b16 a[168:169], v32 offset:53248
    ds_read_b64_tr_b16 a[170:171], v32 offset:55296
    s_waitcnt lgkmcnt(6)
    v_mfma_f32_16x16x32_bf16 v[144:147], a[112:115], a[200:203], v[144:147]
    ds_read_b64_tr_b16 a[172:173], v33 offset:53248
    v_mfma_f32_16x16x32_bf16 v[148:151], a[116:119], a[200:203], v[148:151]
    ds_read_b64_tr_b16 a[174:175], v33 offset:55296
    v_mfma_f32_16x16x32_bf16 v[152:155], a[112:115], a[204:207], v[152:155]
    buffer_load_dwordx4 a[68:71], v37, s[52:55], s83 offen sc1
    v_mfma_f32_16x16x32_bf16 v[156:159], a[116:119], a[204:207], v[156:159]
    s_waitcnt vmcnt(20)
    s_barrier
    s_cmp_lg_u32 s5, 0
    s_cbranch_scc1 L_nosend_31
    v_add_u32 v5, 96, v3
    s_lshl_b32 s11, s4, 2
    s_add_u32 s11, s11, 768
    s_mov_b64 exec, 0xff00
    buffer_store_dword v5, v4, s[52:55], s11 offen sc1
    s_mov_b64 exec, -1
L_nosend_31:
    s_waitcnt lgkmcnt(4)
    v_mfma_f32_16x16x32_bf16 v[128:131], a[120:123], a[160:163], v[128:131]
    v_add_u32 v30, 61440, v30
    v_add_u32 v31, 61440, v31
    v_add_u32 v32, 61440, v32
    v_add_u32 v33, 61440, v33
    v_mfma_f32_16x16x32_bf16 v[132:135], a[124:127], a[160:163], v[132:135]
    ds_read_b64_tr_b16 a[192:193], v30 offset:0
    ds_read_b64_tr_b16 a[194:195], v30 offset:2048
    ds_read_b64_tr_b16 a[196:197], v31 offset:0
    buffer_load_dwordx4 a[72:75], v38, s[52:55], s83 offen sc1
    v_mfma_f32_16x16x32_bf16 v[136:139], a[120:123], a[164:167], v[136:139]
    ds_read_b64_tr_b16 a[198:199], v31 offset:2048
    ds_read_b64_tr_b16 a[200:201], v32 offset:0
    ds_read_b64_tr_b16 a[202:203], v32 offset:2048
    v_mfma_f32_16x16x32_bf16 v[140:143], a[124:127], a[164:167], v[140:143]
    ds_read_b64_tr_b16 a[204:205], v33 offset:0
    ds_read_b64_tr_b16 a[206:207], v33 offset:2048
    ds_read_b64_tr_b16 a[208:209], v30 offset:16384
    ds_read_b64_tr_b16 a[210:211], v30 offset:18432
    s_waitcnt lgkmcnt(10)
    v_mfma_f32_16x16x32_bf16 v[144:147], a[120:123], a[168:171], v[144:147]
    ds_read_b64_tr_b16 a[212:213], v31 offset:16384
    ds_read_b64_tr_b16 a[214:215], v31 offset:18432
    ds_read_b64_tr_b16 a[216:217], v32 offset:16384
    buffer_load_dwordx4 a[76:79], v39, s[52:55], s83 offen sc1
    v_mfma_f32_16x16x32_bf16 v[148:151], a[124:127], a[168:171], v[148:151]
    ds_read_b64_tr_b16 a[218:219], v32 offset:18432
    ds_read_b64_tr_b16 a[220:221], v33 offset:16384
    ds_read_b64_tr_b16 a[222:223], v33 offset:18432
    v_mfma_f32_16x16x32_bf16 v[152:155], a[120:123], a[172:175], v[152:155]
    buffer_load_dwordx4 v20, s[64:67], s81 offen offset:0 lds
    v_mfma_f32_16x16x32_bf16 v[156:159], a[124:127], a[172:175], v[156:159]
    s_waitcnt vmcnt(21) lgkmcnt(8)
    v_mfma_f32_16x16x32_bf16 v[128:131], a[0:3], a[192:195], v[128:131]
    ds_read_b64_tr_b16 a[160:161], v30 offset:4096
    v_mfma_f32_16x16x32_bf16 v[132:135], a[4:7], a[192:195], v[132:135]
    ds_read_b64_tr_b16 a[162:163], v30 offset:6144
    v_mfma_f32_16x16x32_bf16 v[136:139], a[0:3], a[196:199], v[136:139]
    buffer_load_dwordx4 v21, s[64:67], s81 offen offset:1024 lds
    v_mfma_f32_16x16x32_bf16 v[140:143], a[4:7], a[196:199], v[140:143]
    ds_read_b64_tr_b16 a[164:165], v31 offset:4096
    v_mfma_f32_16x16x32_bf16 v[144:147], a[0:3], a[200:203], v[144:147]
    ds_read_b64_tr_b16 a[166:167], v31 offset:6144
    v_mfma_f32_16x16x32_bf16 v[148:151], a[4:7], a[200:203], v[148:151]
    v_mfma_f32_16x16x32_bf16 v[152:155], a[0:3], a[204:207], v[152:155]
    ds_read_b64_tr_b16 a[168:169], v32 offset:4096
    buffer_load_dwordx4 v22, s[64:67], s81 offen offset:2048 lds
    v_mfma_f32_16x16x32_bf16 v[156:159], a[4:7], a[204:207], v[156:159]
    ds_read_b64_tr_b16 a[170:171], v32 offset:6144
    s_waitcnt lgkmcnt(6)
    v_mfma_f32_16x16x32_bf16 v[160:163], a[0:3], a[208:211], v[160:163]
    v_mfma_f32_16x16x32_bf16 v[164:167], a[4:7], a[208:211], v[164:167]
    ds_read_b64_tr_b16 a[172:173], v33 offset:4096
    v_mfma_f32_16x16x32_bf16 v[168:171], a[0:3], a[212:215], v[168:171]
    ds_read_b64_tr_b16 a[174:175], v33 offset:6144
    buffer_load_dwordx4 v23, s[64:67], s81 offen offset:3072 lds
    s_add_u32 m0, s15, 122880
    v_mfma_f32_16x16x32_bf16 v[172:175], a[4:7], a[212:215], v[172:175]
    v_mfma_f32_16x16x32_bf16 v[176:179], a[0:3], a[216:219], v[176:179]
    v_mfma_f32_16x16x32_bf16 v[180:183], a[4:7], a[216:219], v[180:183]
    v_mfma_f32_16x16x32_bf16 v[184:187], a[0:3], a[220:223], v[184:187]
    buffer_load_dwordx4 v24, s[64:67], s81 offen offset:0 lds
    s_add_u32 s81, s81, 573440
    s_sub_u32 s14, s81, 1966080
    s_cselect_b32 s81, s81, s14
    s_add_u32 m0, s87, 143360
    v_mfma_f32_16x16x32_bf16 v[188:191], a[4:7], a[220:223], v[188:191]
    s_waitcnt vmcnt(23) lgkmcnt(4)
    v_mfma_f32_16x16x32_bf16 v[128:131], a[8:11], a[160:163], v[128:131]
    ds_read_b64_tr_b16 a[192:193], v30 offset:8192
    ds_read_b64_tr_b16 a[194:195], v30 offset:10240
    v_mfma_f32_16x16x32_bf16 v[132:135], a[12:15], a[160:163], v[132:135]
    ds_read_b64_tr_b16 a[196:197], v31 offset:8192
    v_mfma_f32_16x16x32_bf16 v[136:139], a[8:11], a[164:167], v[136:139]
    ds_read_b64_tr_b16 a[198:199], v31 offset:10240
    buffer_load_dwordx4 a[80:83], v40, s[52:55], s83 offen sc1
    v_mfma_f32_16x16x32_bf16 v[140:143], a[12:15], a[164:167], v[140:143]
    ds_read_b64_tr_b16 a[200:201], v32 offset:8192
    ds_read_b64_tr_b16 a[202:203], v32 offset:10240
    s_waitcnt lgkmcnt(6)
    v_mfma_f32_16x16x32_bf16 v[144:147], a[8:11], a[168:171], v[144:147]
    ds_read_b64_tr_b16 a[204:205], v33 offset:8192
    v_mfma_f32_16x16x32_bf16 v[148:151], a[12:15], a[168:171], v[148:151]
    ds_read_b64_tr_b16 a[206:207], v33 offset:10240
    v_mfma_f32_16x16x32_bf16 v[152:155], a[8:11], a[172:175], v[152:155]
    buffer_load_dwordx4 a[84:87], v41, s[52:55], s83 offen sc1
    v_mfma_f32_16x16x32_bf16 v[156:159], a[12:15], a[172:175], v[156:159]
    s_waitcnt vmcnt(23) lgkmcnt(4)
    v_mfma_f32_16x16x32_bf16 v[128:131], a[16:19], a[192:195], v[128:131]
    ds_read_b64_tr_b16 a[160:161], v30 offset:12288
    ds_read_b64_tr_b16 a[162:163], v30 offset:14336
    v_mfma_f32_16x16x32_bf16 v[132:135], a[20:23], a[192:195], v[132:135]
    ds_read_b64_tr_b16 a[164:165], v31 offset:12288
    buffer_load_dwordx4 a[88:91], v42, s[52:55], s83 offen sc1
    v_mfma_f32_16x16x32_bf16 v[136:139], a[16:19], a[196:199], v[136:139]
    ds_read_b64_tr_b16 a[166:167], v31 offset:14336
    v_mfma_f32_16x16x32_bf16 v[140:143], a[20:23], a[196:199], v[140:143]
    ds_read_b64_tr_b16 a[168:169], v32 offset:12288
    ds_read_b64_tr_b16 a[170:171], v32 offset:14336
    s_waitcnt lgkmcnt(6)
    v_mfma_f32_16x16x32_bf16 v[144:147], a[16:19], a[200:203], v[144:147]
    ds_read_b64_tr_b16 a[172:173], v33 offset:12288
    buffer_load_dwordx4 a[92:95], v43, s[52:55], s83 offen sc1
    s_add_u32 s83, s83, 4096
    s_cmp_eq_u32 s83, s85
    s_cselect_b32 s83, s84, s83
    v_mfma_f32_16x16x32_bf16 v[148:151], a[20:23], a[200:203], v[148:151]
    ds_read_b64_tr_b16 a[174:175], v33 offset:14336
    v_mfma_f32_16x16x32_bf16 v[152:155], a[16:19], a[204:207], v[152:155]
    buffer_load_dwordx4 a[96:99], v36, s[52:55], s83 offen sc1
    v_mfma_f32_16x16x32_bf16 v[156:159], a[20:23], a[204:207], v[156:159]
    s_barrier
    s_waitcnt vmcnt(24) lgkmcnt(4)
    v_mfma_f32_16x16x32_bf16 v[128:131], a[24:27], a[160:163], v[128:131]
    ds_read_b64_tr_b16 a[192:193], v30 offset:20480
    ds_read_b64_tr_b16 a[194:195], v30 offset:22528
    ds_read_b64_tr_b16 a[196:197], v31 offset:20480
    v_mfma_f32_16x16x32_bf16 v[132:135], a[28:31], a[160:163], v[132:135]
    ds_read_b64_tr_b16 a[198:199], v31 offset:22528
    ds_read_b64_tr_b16 a[200:201], v32 offset:20480
    ds_read_b64_tr_b16 a[202:203], v32 offset:22528
    v_mfma_f32_16x16x32_bf16 v[136:139], a[24:27], a[164:167], v[136:139]
    ds_read_b64_tr_b16 a[204:205], v33 offset:20480
    ds_read_b64_tr_b16 a[206:207], v33 offset:22528
    buffer_load_dwordx4 a[100:103], v37, s[52:55], s83 offen sc1
    v_mfma_f32_16x16x32_bf16 v[140:143], a[28:31], a[164:167], v[140:143]
    ds_read_b64_tr_b16 a[208:209], v30 offset:36864
    ds_read_b64_tr_b16 a[210:211], v30 offset:38912
    ds_read_b64_tr_b16 a[212:213], v31 offset:36864
    s_waitcnt lgkmcnt(11)
    v_mfma_f32_16x16x32_bf16 v[144:147], a[24:27], a[168:171], v[144:147]
    ds_read_b64_tr_b16 a[214:215], v31 offset:38912
    ds_read_b64_tr_b16 a[216:217], v32 offset:36864
    ds_read_b64_tr_b16 a[218:219], v32 offset:38912
    v_mfma_f32_16x16x32_bf16 v[148:151], a[28:31], a[168:171], v[148:151]
    ds_read_b64_tr_b16 a[220:221], v33 offset:36864
    ds_read_b64_tr_b16 a[222:223], v33 offset:38912
    v_mfma_f32_16x16x32_bf16 v[152:155], a[24:27], a[172:175], v[152:155]
    buffer_load_dwordx4 a[104:107], v38, s[52:55], s83 offen sc1
    v_mfma_f32_16x16x32_bf16 v[156:159], a[28:31], a[172:175], v[156:159]
    s_waitcnt vmcnt(24) lgkmcnt(8)
    v_mfma_f32_16x16x32_bf16 v[128:131], a[32:35], a[192:195], v[128:131]
    ds_read_b64_tr_b16 a[160:161], v30 offset:24576
    v_mfma_f32_16x16x32_bf16 v[132:135], a[36:39], a[192:195], v[132:135]
    ds_read_b64_tr_b16 a[162:163], v30 offset:26624
    buffer_load_dwordx4 a[108:111], v39, s[52:55], s83 offen sc1
    v_mfma_f32_16x16x32_bf16 v[136:139], a[32:35], a[196:199], v[136:139]
    v_mfma_f32_16x16x32_bf16 v[140:143], a[36:39], a[196:199], v[140:143]
    ds_read_b64_tr_b16 a[164:165], v31 offset:24576
    v_mfma_f32_16x16x32_bf16 v[144:147], a[32:35], a[200:203], v[144:147]
    ds_read_b64_tr_b16 a[166:167], v31 offset:26624
    buffer_load_dwordx4 v20, s[64:67], s81 offen offset:0 lds
    v_mfma_f32_16x16x32_bf16 v[148:151], a[36:39], a[200:203], v[148:151]
    v_mfma_f32_16x16x32_bf16 v[152:155], a[32:35], a[204:207], v[152:155]
    ds_read_b64_tr_b16 a[168:169], v32 offset:24576
    v_mfma_f32_16x16x32_bf16 v[156:159], a[36:39], a[204:207], v[156:159]
    ds_read_b64_tr_b16 a[170:171], v32 offset:26624
    s_waitcnt lgkmcnt(6)
    v_mfma_f32_16x16x32_bf16 v[160:163], a[32:35], a[208:211], v[160:163]
    buffer_load_dwordx4 v21, s[64:67], s81 offen offset:1024 lds
    v_mfma_f32_16x16x32_bf16 v[164:167], a[36:39], a[208:211], v[164:167]
    ds_read_b64_tr_b16 a[172:173], v33 offset:24576
    v_mfma_f32_16x16x32_bf16 v[168:171], a[32:35], a[212:215], v[168:171]
    ds_read_b64_tr_b16 a[174:175], v33 offset:26624
    v_mfma_f32_16x16x32_bf16 v[172:175], a[36:39], a[212:215], v[172:175]
    buffer_load_dwordx4 v22, s[64:67], s81 offen offset:2048 lds
    v_mfma_f32_16x16x32_bf16 v[176:179], a[32:35], a[216:219], v[176:179]
    v_mfma_f32_16x16x32_bf16 v[180:183], a[36:39], a[216:219], v[180:183]
    v_mfma_f32_16x16x32_bf16 v[184:187], a[32:35], a[220:223], v[184:187]
    buffer_load_dwordx4 v23, s[64:67], s81 offen offset:3072 lds
    s_add_u32 m0, s15, 143360
    v_mfma_f32_16x16x32_bf16 v[188:191], a[36:39], a[220:223], v[188:191]
    s_waitcnt vmcnt(27) lgkmcnt(4)
    v_mfma_f32_16x16x32_bf16 v[128:131], a[40:43], a[160:163], v[128:131]
    ds_read_b64_tr_b16 a[192:193], v30 offset:28672
    ds_read_b64_tr_b16 a[194:195], v30 offset:30720
    v_mfma_f32_16x16x32_bf16 v[132:135], a[44:47], a[160:163], v[132:135]
    ds_read_b64_tr_b16 a[196:197], v31 offset:28672
    v_mfma_f32_16x16x32_bf16 v[136:139], a[40:43], a[164:167], v[136:139]
    ds_read_b64_tr_b16 a[198:199], v31 offset:30720
    v_and_b32 v11, 7, v1
    v_lshlrev_b32 v11, 2, v11
    s_add_u32 s46, s9, 768
    buffer_load_dword v10, v11, s[52:55], s46 offen sc1
    v_mfma_f32_16x16x32_bf16 v[140:143], a[44:47], a[164:167], v[140:143]
    ds_read_b64_tr_b16 a[200:201], v32 offset:28672
    ds_read_b64_tr_b16 a[202:203], v32 offset:30720
    s_waitcnt lgkmcnt(6)
    v_mfma_f32_16x16x32_bf16 v[144:147], a[40:43], a[168:171], v[144:147]
    ds_read_b64_tr_b16 a[204:205], v33 offset:28672
    v_mfma_f32_16x16x32_bf16 v[148:151], a[44:47], a[168:171], v[148:151]
    ds_read_b64_tr_b16 a[206:207], v33 offset:30720
    v_mfma_f32_16x16x32_bf16 v[152:155], a[40:43], a[172:175], v[152:155]
    buffer_load_dwordx4 v24, s[64:67], s81 offen offset:0 lds
    s_add_u32 s81, s81, 491520
    s_sub_u32 s14, s81, 1966080
    s_cselect_b32 s81, s81, s14
    s_add_u32 m0, s87, 0
    v_mfma_f32_16x16x32_bf16 v[156:159], a[44:47], a[172:175], v[156:159]
    s_waitcnt vmcnt(25) lgkmcnt(4)
    v_mfma_f32_16x16x32_bf16 v[128:131], a[48:51], a[192:195], v[128:131]
    ds_read_b64_tr_b16 a[160:161], v30 offset:32768
    ds_read_b64_tr_b16 a[162:163], v30 offset:34816
    v_mfma_f32_16x16x32_bf16 v[132:135], a[52:55], a[192:195], v[132:135]
    ds_read_b64_tr_b16 a[164:165], v31 offset:32768
    v_mfma_f32_16x16x32_bf16 v[136:139], a[48:51], a[196:199], v[136:139]
    ds_read_b64_tr_b16 a[166:167], v31 offset:34816
    buffer_load_dwordx4 a[112:115], v40, s[52:55], s83 offen sc1
    v_mfma_f32_16x16x32_bf16 v[140:143], a[52:55], a[196:199], v[140:143]
    ds_read_b64_tr_b16 a[168:169], v32 offset:32768
    ds_read_b64_tr_b16 a[170:171], v32 offset:34816
    s_waitcnt lgkmcnt(6)
    v_mfma_f32_16x16x32_bf16 v[144:147], a[48:51], a[200:203], v[144:147]
    ds_read_b64_tr_b16 a[172:173], v33 offset:32768
    v_mfma_f32_16x16x32_bf16 v[148:151], a[52:55], a[200:203], v[148:151]
    ds_read_b64_tr_b16 a[174:175], v33 offset:34816
    v_mfma_f32_16x16x32_bf16 v[152:155], a[48:51], a[204:207], v[152:155]
    buffer_load_dwordx4 a[116:119], v41, s[52:55], s83 offen sc1
    v_mfma_f32_16x16x32_bf16 v[156:159], a[52:55], a[204:207], v[156:159]
    s_barrier
    s_waitcnt vmcnt(25) lgkmcnt(4)
    v_mfma_f32_16x16x32_bf16 v[128:131], a[56:59], a[160:163], v[128:131]
    ds_read_b64_tr_b16 a[192:193], v30 offset:40960
    ds_read_b64_tr_b16 a[194:195], v30 offset:43008
    ds_read_b64_tr_b16 a[196:197], v31 offset:40960
    v_mfma_f32_16x16x32_bf16 v[132:135], a[60:63], a[160:163], v[132:135]
    ds_read_b64_tr_b16 a[198:199], v31 offset:43008
    ds_read_b64_tr_b16 a[200:201], v32 offset:40960
    ds_read_b64_tr_b16 a[202:203], v32 offset:43008
    buffer_load_dwordx4 a[120:123], v42, s[52:55], s83 offen sc1
    v_mfma_f32_16x16x32_bf16 v[136:139], a[56:59], a[164:167], v[136:139]
    ds_read_b64_tr_b16 a[204:205], v33 offset:40960
    ds_read_b64_tr_b16 a[206:207], v33 offset:43008
    v_mfma_f32_16x16x32_bf16 v[140:143], a[60:63], a[164:167], v[140:143]
    ds_read_b64_tr_b16 a[208:209], v30 offset:57344
    ds_read_b64_tr_b16 a[210:211], v30 offset:59392
    ds_read_b64_tr_b16 a[212:213], v31 offset:57344
    s_waitcnt lgkmcnt(11)
    v_mfma_f32_16x16x32_bf16 v[144:147], a[56:59], a[168:171], v[144:147]
    ds_read_b64_tr_b16 a[214:215], v31 offset:59392
    ds_read_b64_tr_b16 a[216:217], v32 offset:57344
    ds_read_b64_tr_b16 a[218:219], v32 offset:59392
    buffer_load_dwordx4 a[124:127], v43, s[52:55], s83 offen sc1
    s_add_u32 s83, s83, 4096
    s_cmp_eq_u32 s83, s85
    s_cselect_b32 s83, s84, s83
    v_mfma_f32_16x16x32_bf16 v[148:151], a[60:63], a[168:171], v[148:151]
    ds_read_b64_tr_b16 a[220:221], v33 offset:57344
    ds_read_b64_tr_b16 a[222:223], v33 offset:59392
    v_mfma_f32_16x16x32_bf16 v[152:155], a[56:59], a[172:175], v[152:155]
    buffer_load_dwordx4 v20, s[64:67], s81 offen offset:0 lds
    v_mfma_f32_16x16x32_bf16 v[156:159], a[60:63], a[172:175], v[156:159]
    s_waitcnt vmcnt(26) lgkmcnt(8)
    v_mfma_f32_16x16x32_bf16 v[128:131], a[64:67], a[192:195], v[128:131]
    ds_read_b64_tr_b16 a[160:161], v30 offset:45056
    v_mfma_f32_16x16x32_bf16 v[132:135], a[68:71], a[192:195], v[132:135]
    ds_read_b64_tr_b16 a[162:163], v30 offset:47104
    v_mfma_f32_16x16x32_bf16 v[136:139], a[64:67], a[196:199], v[136:139]
    buffer_load_dwordx4 v21, s[64:67], s81 offen offset:1024 lds
    v_mfma_f32_16x16x32_bf16 v[140:143], a[68:71], a[196:199], v[140:143]
    ds_read_b64_tr_b16 a[164:165], v31 offset:45056
    v_mfma_f32_16x16x32_bf16 v[144:147], a[64:67], a[200:203], v[144:147]
    ds_read_b64_tr_b16 a[166:167], v31 offset:47104
    v_mfma_f32_16x16x32_bf16 v[148:151], a[68:71], a[200:203], v[148:151]
    v_mfma_f32_16x16x32_bf16 v[152:155], a[64:67], a[204:207], v[152:155]
    ds_read_b64_tr_b16 a[168:169], v32 offset:45056
    buffer_load_dwordx4 v22, s[64:67], s81 offen offset:2048 lds
    v_mfma_f32_16x16x32_bf16 v[156:159], a[68:71], a[204:207], v[156:159]
    ds_read_b64_tr_b16 a[170:171], v32 offset:47104
    s_waitcnt lgkmcnt(6)
    v_mfma_f32_16x16x32_bf16 v[160:163], a[64:67], a[208:211], v[160:163]
    v_mfma_f32_16x16x32_bf16 v[164:167], a[68:71], a[208:211], v[164:167]
    ds_read_b64_tr_b16 a[172:173], v33 offset:45056
    v_mfma_f32_16x16x32_bf16 v[168:171], a[64:67], a[212:215], v[168:171]
    ds_read_b64_tr_b16 a[174:175], v33 offset:47104
    buffer_load_dwordx4 v23, s[64:67], s81 offen offset:3072 lds
    s_add_u32 m0, s15, 0
    v_mfma_f32_16x16x32_bf16 v[172:175], a[68:71], a[212:215], v[172:175]
    v_mfma_f32_16x16x32_bf16 v[176:179], a[64:67], a[216:219], v[176:179]
    v_mfma_f32_16x16x32_bf16 v[180:183], a[68:71], a[216:219], v[180:183]
    v_mfma_f32_16x16x32_bf16 v[184:187], a[64:67], a[220:223], v[184:187]
    buffer_load_dwordx4 v24, s[64:67], s81 offen offset:0 lds
    s_add_u32 s81, s81, 491520
    s_sub_u32 s14, s81, 1966080
    s_cselect_b32 s81, s81, s14
    s_add_u32 m0, s87, 20480
    v_mfma_f32_16x16x32_bf16 v[188:191], a[68:71], a[220:223], v[188:191]
    s_waitcnt vmcnt(28) lgkmcnt(4)
    v_mfma_f32_16x16x32_bf16 v[128:131], a[72:75], a[160:163], v[128:131]
    ds_read_b64_tr_b16 a[192:193], v30 offset:49152
    ds_read_b64_tr_b16 a[194:195], v30 offset:51200
    v_mfma_f32_16x16x32_bf16 v[132:135], a[76:79], a[160:163], v[132:135]
    ds_read_b64_tr_b16 a[196:197], v31 offset:49152
    v_mfma_f32_16x16x32_bf16 v[136:139], a[72:75], a[164:167], v[136:139]
    ds_read_b64_tr_b16 a[198:199], v31 offset:51200
    buffer_load_dwordx4 v20, s[64:67], s81 offen offset:0 lds
    v_mfma_f32_16x16x32_bf16 v[140:143], a[76:79], a[164:167], v[140:143]
    ds_read_b64_tr_b16 a[200:201], v32 offset:49152
    ds_read_b64_tr_b16 a[202:203], v32 offset:51200
    s_waitcnt lgkmcnt(6)
    v_mfma_f32_16x16x32_bf16 v[144:147], a[72:75], a[168:171], v[144:147]
    ds_read_b64_tr_b16 a[204:205], v33 offset:49152
    v_mfma_f32_16x16x32_bf16 v[148:151], a[76:79], a[168:171], v[148:151]
    ds_read_b64_tr_b16 a[206:207], v33 offset:51200
    v_mfma_f32_16x16x32_bf16 v[152:155], a[72:75], a[172:175], v[152:155]
    buffer_load_dwordx4 v21, s[64:67], s81 offen offset:1024 lds
    v_mfma_f32_16x16x32_bf16 v[156:159], a[76:79], a[172:175], v[156:159]
    s_add_u32 s12, s7, 96
    s_waitcnt vmcnt(12)
    v_cmp_eq_u32 vcc, s12, v10
    s_nop 0
    s_cmp_eq_u64 vcc, exec
    s_cbranch_scc1 L_ready_32
    v_and_b32 v11, 7, v1
    v_lshlrev_b32 v11, 2, v11
    s_add_u32 s11, s9, 768
    s_add_u32 s12, s7, 96
L_poll_33:
    buffer_load_dword v10, v11, s[52:55], s11 offen sc1
    s_cmp_eq_u32 s10, 0
    s_waitcnt vmcnt(0)
    s_cbranch_scc1 L_polled_34
    s_sub_u32 s10, s10, 1
    v_cmp_eq_u32 vcc, s12, v10
    s_nop 0
    s_cmp_eq_u64 vcc, exec
    s_cbranch_scc0 L_poll_33
L_polled_34:
L_ready_32:
    s_waitcnt lgkmcnt(4)
    v_mfma_f32_16x16x32_bf16 v[128:131], a[80:83], a[192:195], v[128:131]
    ds_read_b64_tr_b16 a[160:161], v30 offset:53248
    ds_read_b64_tr_b16 a[162:163], v30 offset:55296
    v_mfma_f32_16x16x32_bf16 v[132:135], a[84:87], a[192:195], v[132:135]
    ds_read_b64_tr_b16 a[164:165], v31 offset:53248
    s_add_u32 s84, s89, 32768
    s_add_u32 s85, s84, 16384
    s_add_u32 s83, s91, s84
    buffer_load_dwordx4 a[0:3], v36, s[52:55], s83 offen sc1
    v_mfma_f32_16x16x32_bf16 v[136:139], a[80:83], a[196:199], v[136:139]
    ds_read_b64_tr_b16 a[166:167], v31 offset:55296
    v_mfma_f32_16x16x32_bf16 v[140:143], a[84:87], a[196:199], v[140:143]
    ds_read_b64_tr_b16 a[168:169], v32 offset:53248
    ds_read_b64_tr_b16 a[170:171], v32 offset:55296
    s_waitcnt lgkmcnt(6)
    v_mfma_f32_16x16x32_bf16 v[144:147], a[80:83], a[200:203], v[144:147]
    ds_read_b64_tr_b16 a[172:173], v33 offset:53248
    buffer_load_dwordx4 a[4:7], v37, s[52:55], s83 offen sc1
    v_mfma_f32_16x16x32_bf16 v[148:151], a[84:87], a[200:203], v[148:151]
    ds_read_b64_tr_b16 a[174:175], v33 offset:55296
    v_mfma_f32_16x16x32_bf16 v[152:155], a[80:83], a[204:207], v[152:155]
    buffer_load_dwordx4 a[8:11], v38, s[52:55], s83 offen sc1
    v_mfma_f32_16x16x32_bf16 v[156:159], a[84:87], a[204:207], v[156:159]
    s_barrier
    s_waitcnt lgkmcnt(4)
    v_mfma_f32_16x16x32_bf16 v[128:131], a[88:91], a[160:163], v[128:131]
    v_add_u32 v30, 61440, v30
    v_add_u32 v31, 61440, v31
    v_add_u32 v32, 61440, v32
    v_add_u32 v33, 61440, v33
    v_mfma_f32_16x16x32_bf16 v[132:135], a[92:95], a[160:163], v[132:135]
    ds_read_b64_tr_b16 a[192:193], v30 offset:0
    ds_read_b64_tr_b16 a[194:195], v30 offset:2048
    ds_read_b64_tr_b16 a[196:197], v31 offset:0
    v_mfma_f32_16x16x32_bf16 v[136:139], a[88:91], a[164:167], v[136:139]
    ds_read_b64_tr_b16 a[198:199], v31 offset:2048
    ds_read_b64_tr_b16 a[200:201], v32 offset:0
    ds_read_b64_tr_b16 a[202:203], v32 offset:2048
    buffer_load_dwordx4 a[12:15], v39, s[52:55], s83 offen sc1
    v_mfma_f32_16x16x32_bf16 v[140:143], a[92:95], a[164:167], v[140:143]
    ds_read_b64_tr_b16 a[204:205], v33 offset:0
    ds_read_b64_tr_b16 a[206:207], v33 offset:2048
    ds_read_b64_tr_b16 a[208:209], v30 offset:16384
    ds_read_b64_tr_b16 a[210:211], v30 offset:18432
    s_waitcnt lgkmcnt(10)
    v_mfma_f32_16x16x32_bf16 v[144:147], a[88:91], a[168:171], v[144:147]
    ds_read_b64_tr_b16 a[212:213], v31 offset:16384
    ds_read_b64_tr_b16 a[214:215], v31 offset:18432
    ds_read_b64_tr_b16 a[216:217], v32 offset:16384
    v_mfma_f32_16x16x32_bf16 v[148:151], a[92:95], a[168:171], v[148:151]
    ds_read_b64_tr_b16 a[218:219], v32 offset:18432
    ds_read_b64_tr_b16 a[220:221], v33 offset:16384
    ds_read_b64_tr_b16 a[222:223], v33 offset:18432
    v_mfma_f32_16x16x32_bf16 v[152:155], a[88:91], a[172:175], v[152:155]
    buffer_load_dwordx4 a[16:19], v40, s[52:55], s83 offen sc1
    v_mfma_f32_16x16x32_bf16 v[156:159], a[92:95], a[172:175], v[156:159]
    s_waitcnt lgkmcnt(8)
    v_mfma_f32_16x16x32_bf16 v[128:131], a[96:99], a[192:195], v[128:131]
    ds_read_b64_tr_b16 a[160:161], v30 offset:4096
    v_mfma_f32_16x16x32_bf16 v[132:135], a[100:103], a[192:195], v[132:135]
    ds_read_b64_tr_b16 a[162:163], v30 offset:6144
    buffer_load_dwordx4 a[20:23], v41, s[52:55], s83 offen sc1
    v_mfma_f32_16x16x32_bf16 v[136:139], a[96:99], a[196:199], v[136:139]
    v_mfma_f32_16x16x32_bf16 v[140:143], a[100:103], a[196:199], v[140:143]
    ds_read_b64_tr_b16 a[164:165], v31 offset:4096
    v_mfma_f32_16x16x32_bf16 v[144:147], a[96:99], a[200:203], v[144:147]
    ds_read_b64_tr_b16 a[166:167], v31 offset:6144
    buffer_load_dwordx4 a[24:27], v42, s[52:55], s83 offen sc1
    v_mfma_f32_16x16x32_bf16 v[148:151], a[100:103], a[200:203], v[148:151]
    v_mfma_f32_16x16x32_bf16 v[152:155], a[96:99], a[204:207], v[152:155]
    ds_read_b64_tr_b16 a[168:169], v32 offset:4096
    v_mfma_f32_16x16x32_bf16 v[156:159], a[100:103], a[204:207], v[156:159]
    ds_read_b64_tr_b16 a[170:171], v32 offset:6144
    s_waitcnt lgkmcnt(6)
    v_mfma_f32_16x16x32_bf16 v[160:163], a[96:99], a[208:211], v[160:163]
    buffer_load_dwordx4 a[28:31], v43, s[52:55], s83 offen sc1
    s_add_u32 s83, s83, 4096
    s_cmp_eq_u32 s83, s85
    s_cselect_b32 s83, s84, s83
    v_mfma_f32_16x16x32_bf16 v[164:167], a[100:103], a[208:211], v[164:167]
    ds_read_b64_tr_b16 a[172:173], v33 offset:4096
    v_mfma_f32_16x16x32_bf16 v[168:171], a[96:99], a[212:215], v[168:171]
    ds_read_b64_tr_b16 a[174:175], v33 offset:6144
    v_mfma_f32_16x16x32_bf16 v[172:175], a[100:103], a[212:215], v[172:175]
    buffer_load_dwordx4 a[32:35], v36, s[52:55], s83 offen sc1
    v_mfma_f32_16x16x32_bf16 v[176:179], a[96:99], a[216:219], v[176:179]
    v_mfma_f32_16x16x32_bf16 v[180:183], a[100:103], a[216:219], v[180:183]
    v_mfma_f32_16x16x32_bf16 v[184:187], a[96:99], a[220:223], v[184:187]
    buffer_load_dwordx4 a[36:39], v37, s[52:55], s83 offen sc1
    v_mfma_f32_16x16x32_bf16 v[188:191], a[100:103], a[220:223], v[188:191]
    s_waitcnt lgkmcnt(4)
    v_mfma_f32_16x16x32_bf16 v[128:131], a[104:107], a[160:163], v[128:131]
    ds_read_b64_tr_b16 a[192:193], v30 offset:8192
    ds_read_b64_tr_b16 a[194:195], v30 offset:10240
    v_mfma_f32_16x16x32_bf16 v[132:135], a[108:111], a[160:163], v[132:135]
    ds_read_b64_tr_b16 a[196:197], v31 offset:8192
    v_mfma_f32_16x16x32_bf16 v[136:139], a[104:107], a[164:167], v[136:139]
    ds_read_b64_tr_b16 a[198:199], v31 offset:10240
    buffer_load_dwordx4 a[40:43], v38, s[52:55], s83 offen sc1
    v_mfma_f32_16x16x32_bf16 v[140:143], a[108:111], a[164:167], v[140:143]
    ds_read_b64_tr_b16 a[200:201], v32 offset:8192
    ds_read_b64_tr_b16 a[202:203], v32 offset:10240
    s_waitcnt lgkmcnt(6)
    v_mfma_f32_16x16x32_bf16 v[144:147], a[104:107], a[168:171], v[144:147]
    ds_read_b64_tr_b16 a[204:205], v33 offset:8192
    v_mfma_f32_16x16x32_bf16 v[148:151], a[108:111], a[168:171], v[148:151]
    ds_read_b64_tr_b16 a[206:207], v33 offset:10240
    v_mfma_f32_16x16x32_bf16 v[152:155], a[104:107], a[172:175], v[152:155]
    buffer_load_dwordx4 a[44:47], v39, s[52:55], s83 offen sc1
    v_mfma_f32_16x16x32_bf16 v[156:159], a[108:111], a[172:175], v[156:159]
    s_lshl_b32 s11, s3, 18
    s_lshl_b32 s12, s5, 13
    s_add_u32 s11, s11, s12
    s_add_u32 s11, s11, 19922944
    s_lshl_b32 s96, s4, 15
    s_add_u32 s96, s96, s11
    s_and_b32 s97, s4, 4
    s_lshl_b32 s97, s97, 15
    s_add_u32 s97, s97, s11
    s_and_b32 s12, s4, 3
    s_lshl_b32 s12, s12, 10
    s_add_u32 s97, s97, s12
    s_add_u32 s97, s97, 4096
    s_and_b32 s88, s4, 3
    s_and_b32 s12, s4, 4
    s_lshl_b32 s92, 15, s12
    s_mov_b32 s93, 0
    s_waitcnt vmcnt(21) lgkmcnt(4)
    v_mfma_f32_16x16x32_bf16 v[128:131], a[112:115], a[192:195], v[128:131]
    ds_read_b64_tr_b16 a[160:161], v30 offset:12288
    ds_read_b64_tr_b16 a[162:163], v30 offset:14336
    v_mfma_f32_16x16x32_bf16 v[132:135], a[116:119], a[192:195], v[132:135]
    ds_read_b64_tr_b16 a[164:165], v31 offset:12288
    v_mfma_f32_16x16x32_bf16 v[136:139], a[112:115], a[196:199], v[136:139]
    ds_read_b64_tr_b16 a[166:167], v31 offset:14336
    buffer_load_dwordx4 v22, s[64:67], s81 offen offset:2048 lds
    v_mfma_f32_16x16x32_bf16 v[140:143], a[116:119], a[196:199], v[140:143]
    ds_read_b64_tr_b16 a[168:169], v32 offset:12288
    ds_read_b64_tr_b16 a[170:171], v32 offset:14336
    s_waitcnt lgkmcnt(6)
    v_mfma_f32_16x16x32_bf16 v[144:147], a[112:115], a[200:203], v[144:147]
    ds_read_b64_tr_b16 a[172:173], v33 offset:12288
    v_mfma_f32_16x16x32_bf16 v[148:151], a[116:119], a[200:203], v[148:151]
    ds_read_b64_tr_b16 a[174:175], v33 offset:14336
    v_mfma_f32_16x16x32_bf16 v[152:155], a[112:115], a[204:207], v[152:155]
    buffer_load_dwordx4 v23, s[64:67], s81 offen offset:3072 lds
    s_add_u32 m0, s15, 20480
    v_mfma_f32_16x16x32_bf16 v[156:159], a[116:119], a[204:207], v[156:159]
    s_barrier
    s_waitcnt vmcnt(21) lgkmcnt(4)
    v_mfma_f32_16x16x32_bf16 v[128:131], a[120:123], a[160:163], v[128:131]
    ds_read_b64_tr_b16 a[192:193], v30 offset:20480
    ds_read_b64_tr_b16 a[194:195], v30 offset:22528
    ds_read_b64_tr_b16 a[196:197], v31 offset:20480
    v_mfma_f32_16x16x32_bf16 v[132:135], a[124:127], a[160:163], v[132:135]
    ds_read_b64_tr_b16 a[198:199], v31 offset:22528
    ds_read_b64_tr_b16 a[200:201], v32 offset:20480
    ds_read_b64_tr_b16 a[202:203], v32 offset:22528
    buffer_load_dwordx4 v24, s[64:67], s81 offen offset:0 lds
    s_add_u32 s81, s81, 491520
    s_sub_u32 s14, s81, 1966080
    s_cselect_b32 s81, s81, s14
    s_add_u32 m0, s87, 40960
    v_mfma_f32_16x16x32_bf16 v[136:139], a[120:123], a[164:167], v[136:139]
    ds_read_b64_tr_b16 a[204:205], v33 offset:20480
    ds_read_b64_tr_b16 a[206:207], v33 offset:22528
    v_mfma_f32_16x16x32_bf16 v[140:143], a[124:127], a[164:167], v[140:143]
    ds_read_b64_tr_b16 a[208:209], v30 offset:36864
    ds_read_b64_tr_b16 a[210:211], v30 offset:38912
    ds_read_b64_tr_b16 a[212:213], v31 offset:36864
    s_waitcnt lgkmcnt(11)
    v_mfma_f32_16x16x32_bf16 v[144:147], a[120:123], a[168:171], v[144:147]
    ds_read_b64_tr_b16 a[214:215], v31 offset:38912
    ds_read_b64_tr_b16 a[216:217], v32 offset:36864
    ds_read_b64_tr_b16 a[218:219], v32 offset:38912
    buffer_load_dwordx4 v20, s[64:67], s81 offen offset:0 lds
    v_mfma_f32_16x16x32_bf16 v[148:151], a[124:127], a[168:171], v[148:151]
    ds_read_b64_tr_b16 a[220:221], v33 offset:36864
    ds_read_b64_tr_b16 a[222:223], v33 offset:38912
    v_mfma_f32_16x16x32_bf16 v[152:155], a[120:123], a[172:175], v[152:155]
    buffer_load_dwordx4 v21, s[64:67], s81 offen offset:1024 lds
    v_mfma_f32_16x16x32_bf16 v[156:159], a[124:127], a[172:175], v[156:159]
    s_waitcnt vmcnt(15) lgkmcnt(8)
    v_mfma_f32_16x16x32_bf16 v[128:131], a[0:3], a[192:195], v[128:131]
    ds_read_b64_tr_b16 a[160:161], v30 offset:24576
    v_mfma_f32_16x16x32_bf16 v[132:135], a[4:7], a[192:195], v[132:135]
    ds_read_b64_tr_b16 a[162:163], v30 offset:26624
    v_mfma_f32_16x16x32_bf16 v[136:139], a[0:3], a[196:199], v[136:139]
    buffer_load_dwordx4 v22, s[64:67], s81 offen offset:2048 lds
    v_mfma_f32_16x16x32_bf16 v[140:143], a[4:7], a[196:199], v[140:143]
    ds_read_b64_tr_b16 a[164:165], v31 offset:24576
    v_mfma_f32_16x16x32_bf16 v[144:147], a[0:3], a[200:203], v[144:147]
    ds_read_b64_tr_b16 a[166:167], v31 offset:26624
    v_mfma_f32_16x16x32_bf16 v[148:151], a[4:7], a[200:203], v[148:151]
    v_mfma_f32_16x16x32_bf16 v[152:155], a[0:3], a[204:207], v[152:155]
    ds_read_b64_tr_b16 a[168:169], v32 offset:24576
    buffer_load_dwordx4 v23, s[64:67], s81 offen offset:3072 lds
    s_add_u32 m0, s15, 40960
    v_mfma_f32_16x16x32_bf16 v[156:159], a[4:7], a[204:207], v[156:159]
    ds_read_b64_tr_b16 a[170:171], v32 offset:26624
    s_waitcnt lgkmcnt(6)
    v_mfma_f32_16x16x32_bf16 v[160:163], a[0:3], a[208:211], v[160:163]
    v_mfma_f32_16x16x32_bf16 v[164:167], a[4:7], a[208:211], v[164:167]
    ds_read_b64_tr_b16 a[172:173], v33 offset:24576
    v_mfma_f32_16x16x32_bf16 v[168:171], a[0:3], a[212:215], v[168:171]
    ds_read_b64_tr_b16 a[174:175], v33 offset:26624
    buffer_load_dwordx4 v24, s[64:67], s81 offen offset:0 lds
    s_add_u32 s81, s81, 573440
    s_sub_u32 s14, s81, 1966080
    s_cselect_b32 s81, s81, s14
    v_mfma_f32_16x16x32_bf16 v[172:175], a[4:7], a[212:215], v[172:175]
    v_mfma_f32_16x16x32_bf16 v[176:179], a[0:3], a[216:219], v[176:179]
    v_mfma_f32_16x16x32_bf16 v[180:183], a[4:7], a[216:219], v[180:183]
    v_mfma_f32_16x16x32_bf16 v[184:187], a[0:3], a[220:223], v[184:187]
    buffer_load_dwordx4 a[48:51], v40, s[52:55], s83 offen sc1
    v_mfma_f32_16x16x32_bf16 v[188:191], a[4:7], a[220:223], v[188:191]
    s_waitcnt vmcnt(17) lgkmcnt(4)
    v_mfma_f32_16x16x32_bf16 v[128:131], a[8:11], a[160:163], v[128:131]
    ds_read_b64_tr_b16 a[192:193], v30 offset:28672
    ds_read_b64_tr_b16 a[194:195], v30 offset:30720
    v_mfma_f32_16x16x32_bf16 v[132:135], a[12:15], a[160:163], v[132:135]
    ds_read_b64_tr_b16 a[196:197], v31 offset:28672
    v_mfma_f32_16x16x32_bf16 v[136:139], a[8:11], a[164:167], v[136:139]
    ds_read_b64_tr_b16 a[198:199], v31 offset:30720
    buffer_load_dwordx4 a[52:55], v41, s[52:55], s83 offen sc1
    v_mfma_f32_16x16x32_bf16 v[140:143], a[12:15], a[164:167], v[140:143]
    ds_read_b64_tr_b16 a[200:201], v32 offset:28672
    ds_read_b64_tr_b16 a[202:203], v32 offset:30720
    s_waitcnt lgkmcnt(6)
    v_mfma_f32_16x16x32_bf16 v[144:147], a[8:11], a[168:171], v[144:147]
    ds_read_b64_tr_b16 a[204:205], v33 offset:28672
    v_mfma_f32_16x16x32_bf16 v[148:151], a[12:15], a[168:171], v[148:151]
    ds_read_b64_tr_b16 a[206:207], v33 offset:30720
    v_mfma_f32_16x16x32_bf16 v[152:155], a[8:11], a[172:175], v[152:155]
    buffer_load_dwordx4 a[56:59], v42, s[52:55], s83 offen sc1
    v_mfma_f32_16x16x32_bf16 v[156:159], a[12:15], a[172:175], v[156:159]
    s_waitcnt vmcnt(17) lgkmcnt(4)
    v_mfma_f32_16x16x32_bf16 v[128:131], a[16:19], a[192:195], v[128:131]
    ds_read_b64_tr_b16 a[160:161], v30 offset:32768
    ds_read_b64_tr_b16 a[162:163], v30 offset:34816
    v_mfma_f32_16x16x32_bf16 v[132:135], a[20:23], a[192:195], v[132:135]
    ds_read_b64_tr_b16 a[164:165], v31 offset:32768
    buffer_load_dwordx4 a[60:63], v43, s[52:55], s83 offen sc1
    s_add_u32 s83, s83, 4096
    s_cmp_eq_u32 s83, s85
    s_cselect_b32 s83, s84, s83
    v_mfma_f32_16x16x32_bf16 v[136:139], a[16:19], a[196:199], v[136:139]
    ds_read_b64_tr_b16 a[166:167], v31 offset:34816
    v_mfma_f32_16x16x32_bf16 v[140:143], a[20:23], a[196:199], v[140:143]
    ds_read_b64_tr_b16 a[168:169], v32 offset:32768
    ds_read_b64_tr_b16 a[170:171], v32 offset:34816
    s_waitcnt lgkmcnt(6)
    v_mfma_f32_16x16x32_bf16 v[144:147], a[16:19], a[200:203], v[144:147]
    ds_read_b64_tr_b16 a[172:173], v33 offset:32768
    buffer_load_dwordx4 a[64:67], v36, s[52:55], s83 offen sc1
    v_mfma_f32_16x16x32_bf16 v[148:151], a[20:23], a[200:203], v[148:151]
    ds_read_b64_tr_b16 a[174:175], v33 offset:34816
    v_mfma_f32_16x16x32_bf16 v[152:155], a[16:19], a[204:207], v[152:155]
    buffer_load_dwordx4 a[68:71], v37, s[52:55], s83 offen sc1
    v_mfma_f32_16x16x32_bf16 v[156:159], a[20:23], a[204:207], v[156:159]
    s_barrier
    s_waitcnt vmcnt(18) lgkmcnt(4)
    v_mfma_f32_16x16x32_bf16 v[128:131], a[24:27], a[160:163], v[128:131]
    v_add_u32 v30, 4294844416, v30
    v_add_u32 v31, 4294844416, v31
    v_add_u32 v32, 4294844416, v32
    v_add_u32 v33, 4294844416, v33
    v_mfma_f32_16x16x32_bf16 v[132:135], a[28:31], a[160:163], v[132:135]
    ds_read_b64_tr_b16 a[192:193], v30 offset:0
    ds_read_b64_tr_b16 a[194:195], v30 offset:2048
    ds_read_b64_tr_b16 a[196:197], v31 offset:0
    v_mfma_f32_16x16x32_bf16 v[136:139], a[24:27], a[164:167], v[136:139]
    ds_read_b64_tr_b16 a[198:199], v31 offset:2048
    ds_read_b64_tr_b16 a[200:201], v32 offset:0
    ds_read_b64_tr_b16 a[202:203], v32 offset:2048
    buffer_load_dwordx4 a[72:75], v38, s[52:55], s83 offen sc1
    v_mfma_f32_16x16x32_bf16 v[140:143], a[28:31], a[164:167], v[140:143]
    ds_read_b64_tr_b16 a[204:205], v33 offset:0
    ds_read_b64_tr_b16 a[206:207], v33 offset:2048
    ds_read_b64_tr_b16 a[208:209], v30 offset:16384
    ds_read_b64_tr_b16 a[210:211], v30 offset:18432
    s_waitcnt lgkmcnt(10)
    v_mfma_f32_16x16x32_bf16 v[144:147], a[24:27], a[168:171], v[144:147]
    ds_read_b64_tr_b16 a[212:213], v31 offset:16384
    ds_read_b64_tr_b16 a[214:215], v31 offset:18432
    ds_read_b64_tr_b16 a[216:217], v32 offset:16384
    v_mfma_f32_16x16x32_bf16 v[148:151], a[28:31], a[168:171], v[148:151]
    ds_read_b64_tr_b16 a[218:219], v32 offset:18432
    ds_read_b64_tr_b16 a[220:221], v33 offset:16384
    ds_read_b64_tr_b16 a[222:223], v33 offset:18432
    v_mfma_f32_16x16x32_bf16 v[152:155], a[24:27], a[172:175], v[152:155]
    buffer_load_dwordx4 a[76:79], v39, s[52:55], s83 offen sc1
    v_mfma_f32_16x16x32_bf16 v[156:159], a[28:31], a[172:175], v[156:159]
    s_waitcnt vmcnt(18) lgkmcnt(8)
    v_mfma_f32_16x16x32_bf16 v[128:131], a[32:35], a[192:195], v[128:131]
    ds_read_b64_tr_b16 a[160:161], v30 offset:4096
    v_mfma_f32_16x16x32_bf16 v[132:135], a[36:39], a[192:195], v[132:135]
    ds_read_b64_tr_b16 a[162:163], v30 offset:6144
    buffer_load_dwordx4 a[80:83], v40, s[52:55], s83 offen sc1
    v_mfma_f32_16x16x32_bf16 v[136:139], a[32:35], a[196:199], v[136:139]
    v_mfma_f32_16x16x32_bf16 v[140:143], a[36:39], a[196:199], v[140:143]
    ds_read_b64_tr_b16 a[164:165], v31 offset:4096
    v_mfma_f32_16x16x32_bf16 v[144:147], a[32:35], a[200:203], v[144:147]
    ds_read_b64_tr_b16 a[166:167], v31 offset:6144
    buffer_load_dwordx4 a[84:87], v41, s[52:55], s83 offen sc1
    v_mfma_f32_16x16x32_bf16 v[148:151], a[36:39], a[200:203], v[148:151]
    v_mfma_f32_16x16x32_bf16 v[152:155], a[32:35], a[204:207], v[152:155]
    ds_read_b64_tr_b16 a[168:169], v32 offset:4096
    v_mfma_f32_16x16x32_bf16 v[156:159], a[36:39], a[204:207], v[156:159]
    ds_read_b64_tr_b16 a[170:171], v32 offset:6144
    s_waitcnt lgkmcnt(6)
    v_mfma_f32_16x16x32_bf16 v[160:163], a[32:35], a[208:211], v[160:163]
    buffer_load_dwordx4 a[88:91], v42, s[52:55], s83 offen sc1
    v_mfma_f32_16x16x32_bf16 v[164:167], a[36:39], a[208:211], v[164:167]
    ds_read_b64_tr_b16 a[172:173], v33 offset:4096
    v_mfma_f32_16x16x32_bf16 v[168:171], a[32:35], a[212:215], v[168:171]
    ds_read_b64_tr_b16 a[174:175], v33 offset:6144
    v_mfma_f32_16x16x32_bf16 v[172:175], a[36:39], a[212:215], v[172:175]
    buffer_load_dwordx4 a[92:95], v43, s[52:55], s83 offen sc1
    s_add_u32 s83, s83, 4096
    s_cmp_eq_u32 s83, s85
    s_cselect_b32 s83, s84, s83
    v_mfma_f32_16x16x32_bf16 v[176:179], a[32:35], a[216:219], v[176:179]
    v_mfma_f32_16x16x32_bf16 v[180:183], a[36:39], a[216:219], v[180:183]
    v_mfma_f32_16x16x32_bf16 v[184:187], a[32:35], a[220:223], v[184:187]
    buffer_load_dwordx4 a[96:99], v36, s[52:55], s83 offen sc1
    v_mfma_f32_16x16x32_bf16 v[188:191], a[36:39], a[220:223], v[188:191]
    s_waitcnt vmcnt(21) lgkmcnt(4)
    v_mfma_f32_16x16x32_bf16 v[128:131], a[40:43], a[160:163], v[128:131]
    ds_read_b64_tr_b16 a[192:193], v30 offset:8192
    ds_read_b64_tr_b16 a[194:195], v30 offset:10240
    v_mfma_f32_16x16x32_bf16 v[132:135], a[44:47], a[160:163], v[132:135]
    ds_read_b64_tr_b16 a[196:197], v31 offset:8192
    v_mfma_f32_16x16x32_bf16 v[136:139], a[40:43], a[164:167], v[136:139]
    ds_read_b64_tr_b16 a[198:199], v31 offset:10240
    buffer_load_dwordx4 a[100:103], v37, s[52:55], s83 offen sc1
    v_mfma_f32_16x16x32_bf16 v[140:143], a[44:47], a[164:167], v[140:143]
    ds_read_b64_tr_b16 a[200:201], v32 offset:8192
    ds_read_b64_tr_b16 a[202:203], v32 offset:10240
    s_waitcnt lgkmcnt(6)
    v_mfma_f32_16x16x32_bf16 v[144:147], a[40:43], a[168:171], v[144:147]
    ds_read_b64_tr_b16 a[204:205], v33 offset:8192
    v_mfma_f32_16x16x32_bf16 v[148:151], a[44:47], a[168:171], v[148:151]
    ds_read_b64_tr_b16 a[206:207], v33 offset:10240
    v_mfma_f32_16x16x32_bf16 v[152:155], a[40:43], a[172:175], v[152:155]
    buffer_load_dwordx4 a[104:107], v38, s[52:55], s83 offen sc1
    v_mfma_f32_16x16x32_bf16 v[156:159], a[44:47], a[172:175], v[156:159]
    s_waitcnt vmcnt(13) lgkmcnt(4)
    v_mfma_f32_16x16x32_bf16 v[128:131], a[48:51], a[192:195], v[128:131]
    ds_read_b64_tr_b16 a[160:161], v30 offset:12288
    ds_read_b64_tr_b16 a[162:163], v30 offset:14336
    v_mfma_f32_16x16x32_bf16 v[132:135], a[52:55], a[192:195], v[132:135]
    ds_read_b64_tr_b16 a[164:165], v31 offset:12288
    v_mfma_f32_16x16x32_bf16 v[136:139], a[48:51], a[196:199], v[136:139]
    ds_read_b64_tr_b16 a[166:167], v31 offset:14336
    buffer_load_dwordx4 a[108:111], v39, s[52:55], s83 offen sc1
    v_mfma_f32_16x16x32_bf16 v[140:143], a[52:55], a[196:199], v[140:143]
    ds_read_b64_tr_b16 a[168:169], v32 offset:12288
    ds_read_b64_tr_b16 a[170:171], v32 offset:14336
    s_waitcnt lgkmcnt(6)
    v_mfma_f32_16x16x32_bf16 v[144:147], a[48:51], a[200:203], v[144:147]
    ds_read_b64_tr_b16 a[172:173], v33 offset:12288
    v_mfma_f32_16x16x32_bf16 v[148:151], a[52:55], a[200:203], v[148:151]
    ds_read_b64_tr_b16 a[174:175], v33 offset:14336
    v_mfma_f32_16x16x32_bf16 v[152:155], a[48:51], a[204:207], v[152:155]
    buffer_load_dwordx4 a[112:115], v40, s[52:55], s83 offen sc1
    v_mfma_f32_16x16x32_bf16 v[156:159], a[52:55], a[204:207], v[156:159]
    s_barrier
    s_waitcnt vmcnt(13) lgkmcnt(4)
    v_mfma_f32_16x16x32_bf16 v[128:131], a[56:59], a[160:163], v[128:131]
    ds_read_b64_tr_b16 a[192:193], v30 offset:36864
    ds_read_b64_tr_b16 a[194:195], v30 offset:38912
    v_mfma_f32_16x16x32_bf16 v[132:135], a[60:63], a[160:163], v[132:135]
    ds_read_b64_tr_b16 a[196:197], v31 offset:36864
    buffer_load_dwordx4 a[116:119], v41, s[52:55], s83 offen sc1
    v_mfma_f32_16x16x32_bf16 v[136:139], a[56:59], a[164:167], v[136:139]
    ds_read_b64_tr_b16 a[198:199], v31 offset:38912
    v_mfma_f32_16x16x32_bf16 v[140:143], a[60:63], a[164:167], v[140:143]
    ds_read_b64_tr_b16 a[200:201], v32 offset:36864
    ds_read_b64_tr_b16 a[202:203], v32 offset:38912
    s_waitcnt lgkmcnt(6)
    v_mfma_f32_16x16x32_bf16 v[144:147], a[56:59], a[168:171], v[144:147]
    ds_read_b64_tr_b16 a[204:205], v33 offset:36864
    buffer_load_dwordx4 a[120:123], v42, s[52:55], s83 offen sc1
    v_mfma_f32_16x16x32_bf16 v[148:151], a[60:63], a[168:171], v[148:151]
    ds_read_b64_tr_b16 a[206:207], v33 offset:38912
    v_mfma_f32_16x16x32_bf16 v[152:155], a[56:59], a[172:175], v[152:155]
    buffer_load_dwordx4 a[124:127], v43, s[52:55], s83 offen sc1
    s_add_u32 s83, s83, 4096
    s_cmp_eq_u32 s83, s85
    s_cselect_b32 s83, s84, s83
    v_mfma_f32_16x16x32_bf16 v[156:159], a[60:63], a[172:175], v[156:159]
    s_waitcnt vmcnt(14) lgkmcnt(4)
    v_mfma_f32_16x16x32_bf16 v[160:163], a[64:67], a[192:195], v[160:163]
    ds_read_b64_tr_b16 a[160:161], v30 offset:57344
    ds_read_b64_tr_b16 a[162:163], v30 offset:59392
    v_mfma_f32_16x16x32_bf16 v[164:167], a[68:71], a[192:195], v[164:167]
    ds_read_b64_tr_b16 a[164:165], v31 offset:57344
    v_mfma_f32_16x16x32_bf16 v[168:171], a[64:67], a[196:199], v[168:171]
    ds_read_b64_tr_b16 a[166:167], v31 offset:59392
    v_mfma_f32_16x16x32_bf16 v[172:175], a[68:71], a[196:199], v[172:175]
    ds_read_b64_tr_b16 a[168:169], v32 offset:57344
    ds_read_b64_tr_b16 a[170:171], v32 offset:59392
    s_waitcnt lgkmcnt(6)
    v_mfma_f32_16x16x32_bf16 v[176:179], a[64:67], a[200:203], v[176:179]
    ds_read_b64_tr_b16 a[172:173], v33 offset:57344
    v_mfma_f32_16x16x32_bf16 v[180:183], a[68:71], a[200:203], v[180:183]
    ds_read_b64_tr_b16 a[174:175], v33 offset:59392
    v_mfma_f32_16x16x32_bf16 v[184:187], a[64:67], a[204:207], v[184:187]
    v_mfma_f32_16x16x32_bf16 v[188:191], a[68:71], a[204:207], v[188:191]
    s_waitcnt vmcnt(6) lgkmcnt(4)
    v_mfma_f32_16x16x32_bf16 v[160:163], a[96:99], a[160:163], v[160:163]
    ds_read_b64_tr_b16 a[192:193], v30 offset:20480
    ds_read_b64_tr_b16 a[194:195], v30 offset:22528
    v_mfma_f32_16x16x32_bf16 v[164:167], a[100:103], a[160:163], v[164:167]
    ds_read_b64_tr_b16 a[196:197], v30 offset:24576
    v_mfma_f32_16x16x32_bf16 v[168:171], a[96:99], a[164:167], v[168:171]
    ds_read_b64_tr_b16 a[198:199], v30 offset:26624
    v_mfma_f32_16x16x32_bf16 v[172:175], a[100:103], a[164:167], v[172:175]
    ds_read_b64_tr_b16 a[200:201], v30 offset:28672
    ds_read_b64_tr_b16 a[202:203], v30 offset:30720
    s_waitcnt lgkmcnt(6)
    v_mfma_f32_16x16x32_bf16 v[176:179], a[96:99], a[168:171], v[176:179]
    ds_read_b64_tr_b16 a[204:205], v30 offset:32768
    v_mfma_f32_16x16x32_bf16 v[180:183], a[100:103], a[168:171], v[180:183]
    ds_read_b64_tr_b16 a[206:207], v30 offset:34816
    v_mfma_f32_16x16x32_bf16 v[184:187], a[96:99], a[172:175], v[184:187]
    v_mfma_f32_16x16x32_bf16 v[188:191], a[100:103], a[172:175], v[188:191]
    s_waitcnt lgkmcnt(4)
    v_mfma_f32_16x16x32_bf16 v[128:131], a[64:67], a[192:195], v[128:131]
    ds_read_b64_tr_b16 a[160:161], v30 offset:40960
    ds_read_b64_tr_b16 a[162:163], v30 offset:43008
    v_cvt_pk_bf16_f32 v192, v160, v161
    v_mfma_f32_16x16x32_bf16 v[132:135], a[68:71], a[192:195], v[132:135]
    ds_read_b64_tr_b16 a[164:165], v30 offset:45056
    v_cvt_pk_bf16_f32 v193, v162, v163
    v_mfma_f32_16x16x32_bf16 v[128:131], a[72:75], a[196:199], v[128:131]
    ds_read_b64_tr_b16 a[166:167], v30 offset:47104
    v_cvt_pk_bf16_f32 v194, v164, v165
    v_mfma_f32_16x16x32_bf16 v[132:135], a[76:79], a[196:199], v[132:135]
    ds_read_b64_tr_b16 a[168:169], v30 offset:49152
    ds_read_b64_tr_b16 a[170:171], v30 offset:51200
    v_cvt_pk_bf16_f32 v195, v166, v167
    buffer_store_dwordx4 v[192:195], v2, s[52:55], s97 offen sc1
    s_add_u32 s97, s97, 32768
    s_waitcnt lgkmcnt(6)
    v_mfma_f32_16x16x32_bf16 v[128:131], a[80:83], a[200:203], v[128:131]
    ds_read_b64_tr_b16 a[172:173], v30 offset:53248
    v_cvt_pk_bf16_f32 v196, v168, v169
    v_mfma_f32_16x16x32_bf16 v[132:135], a[84:87], a[200:203], v[132:135]
    ds_read_b64_tr_b16 a[174:175], v30 offset:55296
    v_cvt_pk_bf16_f32 v197, v170, v171
    v_mfma_f32_16x16x32_bf16 v[128:131], a[88:91], a[204:207], v[128:131]
    v_cvt_pk_bf16_f32 v198, v172, v173
    v_mfma_f32_16x16x32_bf16 v[132:135], a[92:95], a[204:207], v[132:135]
    v_cvt_pk_bf16_f32 v199, v174, v175
    buffer_store_dwordx4 v[196:199], v2, s[52:55], s97 offen sc1
    s_add_u32 s97, s97, 32768
    s_waitcnt vmcnt(6) lgkmcnt(4)
    v_mfma_f32_16x16x32_bf16 v[128:131], a[96:99], a[160:163], v[128:131]
    ds_read_b64_tr_b16 a[192:193], v31 offset:20480
    ds_read_b64_tr_b16 a[194:195], v31 offset:22528
    v_cvt_pk_bf16_f32 v200, v176, v177
    v_mfma_f32_16x16x32_bf16 v[132:135], a[100:103], a[160:163], v[132:135]
    ds_read_b64_tr_b16 a[196:197], v31 offset:24576
    v_cvt_pk_bf16_f32 v201, v178, v179
    v_mfma_f32_16x16x32_bf16 v[128:131], a[104:107], a[164:167], v[128:131]
    ds_read_b64_tr_b16 a[198:199], v31 offset:26624
    v_cvt_pk_bf16_f32 v202, v180, v181
    v_mfma_f32_16x16x32_bf16 v[132:135], a[108:111], a[164:167], v[132:135]
    ds_read_b64_tr_b16 a[200:201], v31 offset:28672
    ds_read_b64_tr_b16 a[202:203], v31 offset:30720
    v_cvt_pk_bf16_f32 v203, v182, v183
    buffer_store_dwordx4 v[200:203], v2, s[52:55], s97 offen sc1
    s_add_u32 s97, s97, 32768
    s_waitcnt vmcnt(3) lgkmcnt(6)
    v_mfma_f32_16x16x32_bf16 v[128:131], a[112:115], a[168:171], v[128:131]
    ds_read_b64_tr_b16 a[204:205], v31 offset:32768
    v_cvt_pk_bf16_f32 v204, v184, v185
    v_mfma_f32_16x16x32_bf16 v[132:135], a[116:119], a[168:171], v[132:135]
    ds_read_b64_tr_b16 a[206:207], v31 offset:34816
    v_cvt_pk_bf16_f32 v205, v186, v187
    v_mfma_f32_16x16x32_bf16 v[128:131], a[120:123], a[172:175], v[128:131]
    v_cvt_pk_bf16_f32 v206, v188, v189
    v_mfma_f32_16x16x32_bf16 v[132:135], a[124:127], a[172:175], v[132:135]
    v_cvt_pk_bf16_f32 v207, v190, v191
    buffer_store_dwordx4 v[204:207], v2, s[52:55], s97 offen sc1
    s_add_u32 s97, s97, 32768
    s_waitcnt lgkmcnt(4)
    v_mfma_f32_16x16x32_bf16 v[136:139], a[64:67], a[192:195], v[136:139]
    ds_read_b64_tr_b16 a[160:161], v31 offset:40960
    ds_read_b64_tr_b16 a[162:163], v31 offset:43008
    v_cvt_pk_bf16_f32 v192, v128, v129
    v_mfma_f32_16x16x32_bf16 v[140:143], a[68:71], a[192:195], v[140:143]
    ds_read_b64_tr_b16 a[164:165], v31 offset:45056
    v_mfma_f32_16x16x32_bf16 v[136:139], a[72:75], a[196:199], v[136:139]
    ds_read_b64_tr_b16 a[166:167], v31 offset:47104
    v_cvt_pk_bf16_f32 v193, v130, v131
    v_mfma_f32_16x16x32_bf16 v[140:143], a[76:79], a[196:199], v[140:143]
    ds_read_b64_tr_b16 a[168:169], v31 offset:49152
    ds_read_b64_tr_b16 a[170:171], v31 offset:51200
    s_waitcnt lgkmcnt(6)
    v_mfma_f32_16x16x32_bf16 v[136:139], a[80:83], a[200:203], v[136:139]
    ds_read_b64_tr_b16 a[172:173], v31 offset:53248
    v_cvt_pk_bf16_f32 v194, v132, v133
    v_mfma_f32_16x16x32_bf16 v[140:143], a[84:87], a[200:203], v[140:143]
    ds_read_b64_tr_b16 a[174:175], v31 offset:55296
    v_mfma_f32_16x16x32_bf16 v[136:139], a[88:91], a[204:207], v[136:139]
    v_cvt_pk_bf16_f32 v195, v134, v135
    buffer_store_dwordx4 v[192:195], v2, s[52:55], s96 offen offset:0 sc1
    v_mfma_f32_16x16x32_bf16 v[140:143], a[92:95], a[204:207], v[140:143]
    s_waitcnt lgkmcnt(4)
    v_mfma_f32_16x16x32_bf16 v[136:139], a[96:99], a[160:163], v[136:139]
    ds_read_b64_tr_b16 a[192:193], v32 offset:20480
    ds_read_b64_tr_b16 a[194:195], v32 offset:22528
    v_mfma_f32_16x16x32_bf16 v[140:143], a[100:103], a[160:163], v[140:143]
    ds_read_b64_tr_b16 a[196:197], v32 offset:24576
    v_mfma_f32_16x16x32_bf16 v[136:139], a[104:107], a[164:167], v[136:139]
    ds_read_b64_tr_b16 a[198:199], v32 offset:26624
    v_mfma_f32_16x16x32_bf16 v[140:143], a[108:111], a[164:167], v[140:143]
    ds_read_b64_tr_b16 a[200:201], v32 offset:28672
    ds_read_b64_tr_b16 a[202:203], v32 offset:30720
    s_waitcnt lgkmcnt(6)
    v_mfma_f32_16x16x32_bf16 v[136:139], a[112:115], a[168:171], v[136:139]
    ds_read_b64_tr_b16 a[204:205], v32 offset:32768
    v_mfma_f32_16x16x32_bf16 v[140:143], a[116:119], a[168:171], v[140:143]
    ds_read_b64_tr_b16 a[206:207], v32 offset:34816
    v_mfma_f32_16x16x32_bf16 v[136:139], a[120:123], a[172:175], v[136:139]
    v_mfma_f32_16x16x32_bf16 v[140:143], a[124:127], a[172:175], v[140:143]
    s_waitcnt lgkmcnt(4)
    v_mfma_f32_16x16x32_bf16 v[144:147], a[64:67], a[192:195], v[144:147]
    ds_read_b64_tr_b16 a[160:161], v32 offset:40960
    ds_read_b64_tr_b16 a[162:163], v32 offset:43008
    s_nop 2
    v_cvt_pk_bf16_f32 v196, v136, v137
    v_mfma_f32_16x16x32_bf16 v[148:151], a[68:71], a[192:195], v[148:151]
    ds_read_b64_tr_b16 a[164:165], v32 offset:45056
    v_mfma_f32_16x16x32_bf16 v[144:147], a[72:75], a[196:199], v[144:147]
    ds_read_b64_tr_b16 a[166:167], v32 offset:47104
    v_cvt_pk_bf16_f32 v197, v138, v139
    v_mfma_f32_16x16x32_bf16 v[148:151], a[76:79], a[196:199], v[148:151]
    ds_read_b64_tr_b16 a[168:169], v32 offset:49152
    ds_read_b64_tr_b16 a[170:171], v32 offset:51200
    s_waitcnt lgkmcnt(6)
    v_mfma_f32_16x16x32_bf16 v[144:147], a[80:83], a[200:203], v[144:147]
    ds_read_b64_tr_b16 a[172:173], v32 offset:53248
    v_cvt_pk_bf16_f32 v198, v140, v141
    v_mfma_f32_16x16x32_bf16 v[148:151], a[84:87], a[200:203], v[148:151]
    ds_read_b64_tr_b16 a[174:175], v32 offset:55296
    v_mfma_f32_16x16x32_bf16 v[144:147], a[88:91], a[204:207], v[144:147]
    v_cvt_pk_bf16_f32 v199, v142, v143
    buffer_store_dwordx4 v[196:199], v2, s[52:55], s96 offen offset:1024 sc1
    v_mfma_f32_16x16x32_bf16 v[148:151], a[92:95], a[204:207], v[148:151]
    s_waitcnt lgkmcnt(4)
    v_mfma_f32_16x16x32_bf16 v[144:147], a[96:99], a[160:163], v[144:147]
    ds_read_b64_tr_b16 a[192:193], v33 offset:20480
    ds_read_b64_tr_b16 a[194:195], v33 offset:22528
    v_mfma_f32_16x16x32_bf16 v[148:151], a[100:103], a[160:163], v[148:151]
    ds_read_b64_tr_b16 a[196:197], v33 offset:24576
    v_mfma_f32_16x16x32_bf16 v[144:147], a[104:107], a[164:167], v[144:147]
    ds_read_b64_tr_b16 a[198:199], v33 offset:26624
    v_mfma_f32_16x16x32_bf16 v[148:151], a[108:111], a[164:167], v[148:151]
    ds_read_b64_tr_b16 a[200:201], v33 offset:28672
    ds_read_b64_tr_b16 a[202:203], v33 offset:30720
    s_waitcnt lgkmcnt(6)
    v_mfma_f32_16x16x32_bf16 v[144:147], a[112:115], a[168:171], v[144:147]
    ds_read_b64_tr_b16 a[204:205], v33 offset:32768
    v_mfma_f32_16x16x32_bf16 v[148:151], a[116:119], a[168:171], v[148:151]
    ds_read_b64_tr_b16 a[206:207], v33 offset:34816
    v_mfma_f32_16x16x32_bf16 v[144:147], a[120:123], a[172:175], v[144:147]
    v_mfma_f32_16x16x32_bf16 v[148:151], a[124:127], a[172:175], v[148:151]
    s_waitcnt lgkmcnt(4)
    v_mfma_f32_16x16x32_bf16 v[152:155], a[64:67], a[192:195], v[152:155]
    ds_read_b64_tr_b16 a[160:161], v33 offset:40960
    ds_read_b64_tr_b16 a[162:163], v33 offset:43008
    s_nop 2
    v_cvt_pk_bf16_f32 v200, v144, v145
    v_mfma_f32_16x16x32_bf16 v[156:159], a[68:71], a[192:195], v[156:159]
    ds_read_b64_tr_b16 a[164:165], v33 offset:45056
    v_mfma_f32_16x16x32_bf16 v[152:155], a[72:75], a[196:199], v[152:155]
    ds_read_b64_tr_b16 a[166:167], v33 offset:47104
    v_cvt_pk_bf16_f32 v201, v146, v147
    v_mfma_f32_16x16x32_bf16 v[156:159], a[76:79], a[196:199], v[156:159]
    ds_read_b64_tr_b16 a[168:169], v33 offset:49152
    ds_read_b64_tr_b16 a[170:171], v33 offset:51200
    s_waitcnt lgkmcnt(6)
    v_mfma_f32_16x16x32_bf16 v[152:155], a[80:83], a[200:203], v[152:155]
    ds_read_b64_tr_b16 a[172:173], v33 offset:53248
    v_cvt_pk_bf16_f32 v202, v148, v149
    v_mfma_f32_16x16x32_bf16 v[156:159], a[84:87], a[200:203], v[156:159]
    ds_read_b64_tr_b16 a[174:175], v33 offset:55296
    v_mfma_f32_16x16x32_bf16 v[152:155], a[88:91], a[204:207], v[152:155]
    v_cvt_pk_bf16_f32 v203, v150, v151
    buffer_store_dwordx4 v[200:203], v2, s[52:55], s96 offen offset:2048 sc1
    v_mfma_f32_16x16x32_bf16 v[156:159], a[92:95], a[204:207], v[156:159]
    s_waitcnt lgkmcnt(4)
    v_mfma_f32_16x16x32_bf16 v[152:155], a[96:99], a[160:163], v[152:155]
    v_mfma_f32_16x16x32_bf16 v[156:159], a[100:103], a[160:163], v[156:159]
    v_mfma_f32_16x16x32_bf16 v[152:155], a[104:107], a[164:167], v[152:155]
    v_mfma_f32_16x16x32_bf16 v[156:159], a[108:111], a[164:167], v[156:159]
    s_waitcnt lgkmcnt(0)
    v_mfma_f32_16x16x32_bf16 v[152:155], a[112:115], a[168:171], v[152:155]
    v_mfma_f32_16x16x32_bf16 v[156:159], a[116:119], a[168:171], v[156:159]
    v_mfma_f32_16x16x32_bf16 v[152:155], a[120:123], a[172:175], v[152:155]
    v_mfma_f32_16x16x32_bf16 v[156:159], a[124:127], a[172:175], v[156:159]
    s_nop 6
    v_cvt_pk_bf16_f32 v204, v152, v153
    v_cvt_pk_bf16_f32 v205, v154, v155
    v_cvt_pk_bf16_f32 v206, v156, v157
    v_cvt_pk_bf16_f32 v207, v158, v159
    buffer_store_dwordx4 v[204:207], v2, s[52:55], s96 offen offset:3072 sc1
    s_waitcnt vmcnt(0) lgkmcnt(0)
    v_add_u32 v5, 64, v3
    s_lshl_b32 s11, s5, 2
    s_add_u32 s11, s11, s88
    s_lshl_b32 s11, s11, 2
    s_add_u32 s11, s11, 512
    s_mov_b64 exec, s[92:93]
    buffer_store_dword v5, v4, s[52:55], s11 offen sc1
    s_mov_b64 exec, -1
    s_barrier
    s_cmp_lg_u32 s5, 0
    s_cbranch_scc1 L_nobump_35
    s_add_u32 s11, s7, 0x100
    v_mov_b32 v12, s11
    v_mov_b32 v13, 0
    s_mov_b64 exec, 1
    buffer_store_dword v12, v13, s[52:55], s9 offen sc1
    s_mov_b64 exec, -1
L_nobump_35:
    s_endpgm
L_end:
    s_endpgm
.section .rodata,"a"
.p2align 6
.amdhsa_kernel parallel_sum__ssm_conv_s5__dense_activation_relu__prompt_kernel
  .amdhsa_next_free_vgpr 512
  .amdhsa_next_free_sgpr 102
  .amdhsa_accum_offset 256
  .amdhsa_group_segment_fixed_size 0
  .amdhsa_kernarg_size 120
  .amdhsa_user_sgpr_count 2
  .amdhsa_user_sgpr_kernarg_segment_ptr 1
  .amdhsa_system_sgpr_workgroup_id_x 1
  .amdhsa_float_denorm_mode_32 3
.end_amdhsa_kernel
```
